```python
import torch

def _softmax(x, axis=-1):
    return torch.softmax(x, dim=axis)

def _gelu(x):
    return torch.nn.functional.gelu(x, approximate='tanh')

def _silu(x):
    return torch.nn.functional.silu(x)

def _sigmoid(x):
    return torch.sigmoid(x)

def _layernorm(x, axis=-1, eps=1e-05):
    m = x.mean(dim=axis, keepdim=True)
    v = x.var(dim=axis, keepdim=True, unbiased=False)
    return (x - m) / torch.sqrt(v + eps)

def _scatter_add(tgt, idx, src, axis=0):
    return tgt.clone().index_add_(axis, idx, src)

def _segment_sum(src, seg, n):
    out = torch.zeros((n,) + src.shape[1:], dtype=src.dtype)
    return out.index_add_(0, seg, src)

def _pad(x, pw):
    flat = tuple((v for pair in reversed(pw) for v in pair))
    return torch.nn.functional.pad(x, flat)
kernel_name = 'adaLN_cond__sliding_block__swiglu_ffn__prompt'

def setup_inputs():

    _w = lambda a: (lambda t: t.to(torch.bfloat16) if t.is_floating_point() else t)(torch.as_tensor(a))

    def _A_setup():
        B, S, D = (1, 2048, 640)
        return {'x': _w((lambda *s: torch.randn(*s, dtype=torch.bfloat16) * 0.05)(B, S, D)), 'wqkv': _w((lambda *s: torch.randn(*s, dtype=torch.bfloat16) * 0.05)(D, 3 * D)), 'wo': _w((lambda *s: torch.randn(*s, dtype=torch.bfloat16) * 0.05)(D, D))}
    _A_in = _A_setup()

    def _B_setup():
        B, S, D, F = (1, 2048, 640, 1728)
        return {'x': _w((lambda *s: torch.randn(*s, dtype=torch.bfloat16) * 0.05)(B, S, D)), 'w_gate': _w((lambda *s: torch.randn(*s, dtype=torch.bfloat16) * 0.05)(D, F)), 'w_up': _w((lambda *s: torch.randn(*s, dtype=torch.bfloat16) * 0.05)(D, F)), 'w_down': _w((lambda *s: torch.randn(*s, dtype=torch.bfloat16) * 0.05)(F, D))}
    _B_in = _B_setup()
    return {'A_x': _A_in['x'], 'A_wqkv': _A_in['wqkv'], 'A_wo': _A_in['wo'], 'B_x': _B_in['x'], 'B_w_gate': _B_in['w_gate'], 'B_w_up': _B_in['w_up'], 'B_w_down': _B_in['w_down'], 'c': _w((lambda *s: torch.randn(*s, dtype=torch.bfloat16) * 0.1)(1, 640) * 8.0), 'w_mod': _w((lambda *s: torch.randn(*s, dtype=torch.bfloat16) * 0.1)(640, 6 * 640) * 640 ** (-0.5) * 8.0)}

def reference(A_x, A_wqkv, A_wo, B_x, B_w_gate, B_w_up, B_w_down, c, w_mod):

    def _A_ref(x, wqkv, wo):
        B, S, D = x.shape
        H = 32
        Dh = D // H
        W = 256
        qkv = (lambda x, *d: x.permute(*d))((x @ wqkv).reshape(B, S, 3, H, Dh), 2, 0, 3, 1, 4)
        q, k, v = (qkv[0], qkv[1], qkv[2])
        scores = torch.einsum('bhqd,bhkd->bhqk', q, k) * Dh ** (-0.5)
        idx = torch.arange(S)
        mask = (idx[:, None] - idx[None, :] >= 0) & (idx[:, None] - idx[None, :] < W)
        scores = torch.where(mask[None, None], scores, -1000000000.0)
        p = _softmax(scores, axis=-1)
        o = torch.einsum('bhqk,bhkd->bhqd', p, v)
        return (lambda x, *d: x.permute(*d))(o, 0, 2, 1, 3).reshape(B, S, D) @ wo

    def _B_ref(x, w_gate, w_up, w_down):
        g = _silu(x @ w_gate)
        u = x @ w_up
        return g * u @ w_down
    x = A_x
    mod = (_silu(c) @ w_mod).reshape(c.shape[0], 6, 1, -1)
    sa, ca, ga, sb, cb, gb = (mod[:, 0].clone(), mod[:, 1].clone(), mod[:, 2].clone(), mod[:, 3].clone(), mod[:, 4].clone(), mod[:, 5].clone())
    h = _layernorm(x, axis=-1) * (1 + ca) + sa
    x = x + ga * _A_ref(h, A_wqkv, A_wo)
    h = _layernorm(x, axis=-1) * (1 + cb) + sb
    x = x + gb * _B_ref(h, B_w_gate, B_w_up, B_w_down)
    return x
```

```asm
; @launch grid=(256,1,1) block=(256,1,1) lds=162304
.amdgcn_target "amdgcn-amd-amdhsa--gfx950"
.text
.globl adaLN_cond__sliding_block__swiglu_ffn__prompt_kernel
.p2align 8
.type adaLN_cond__sliding_block__swiglu_ffn__prompt_kernel,@function
adaLN_cond__sliding_block__swiglu_ffn__prompt_kernel:
    s_load_dwordx16 s[16:31], s[0:1], 0
    s_load_dwordx8 s[32:39], s[0:1], 64
    s_cmp_ge_u32 s2, 256
    s_cbranch_scc1 Lk_end
    s_getpc_b64 s[64:65]
L0_pc:
    s_mov_b32 s66, Lcode_end-L0_pc
    s_mov_b32 s67, 0x20000
    s_lshr_b32 s48, s2, 3
    s_lshl_b32 s48, s48, 11
    v_lshlrev_b32_e64 v3, 3, v0
    buffer_load_dwordx2 v[102:103], v3, s[64:67], s48 offen
    v_lshrrev_b32 v3, 6, v0
    v_and_b32 v1, 63, v0
    v_readfirstlane_b32 s40, v3
    v_lshlrev_b32_e64 v2, 4, v1
    s_and_b32 s48, s2, 3
    s_mul_i32 s48, s48, 160
    v_lshrrev_b32_e64 v87, 3, v0
    v_mad_u32_u24 v87, v87, 5, s48
    v_mul_u32_u24 v88, 7680, v87
    v_and_b32 v4, 7, v0
    v_lshl_add_u32 v88, v4, 4, v88
    v_lshlrev_b32_e64 v87, 1, v87
    v_and_b32_e64 v3, -4, v87
    s_lshr_b32 s42, s2, 2
    s_lshl_b32 s42, s42, 7
    s_cmp_lt_u32 s2, 240
    s_cselect_b32 s42, s42, 0x10000000
    s_mul_i32 s44, s40, 5120
    s_waitcnt lgkmcnt(0)
    s_mov_b32 s64, s30
    s_mov_b32 s65, s31
    s_mov_b32 s66, 0x500
    s_mov_b32 s67, 0x20000
    buffer_load_dwordx3 v[130:132], v3, s[64:67], 0 offen
    s_mov_b32 s60, s32
    s_mov_b32 s61, s33
    s_mov_b32 s62, 0x4b0000
    s_mov_b32 s63, 0x20000
    buffer_load_dwordx4 v[104:107], v88, s[60:63], s42 offen
    s_add_u32 s42, s42, 7680
    buffer_load_dwordx4 v[108:111], v88, s[60:63], s42 offen
    s_add_u32 s42, s42, 7680
    buffer_load_dwordx4 v[112:115], v88, s[60:63], s42 offen
    s_add_u32 s42, s42, 7680
    buffer_load_dwordx4 v[116:119], v88, s[60:63], s42 offen
    s_add_u32 s42, s42, 7680
    buffer_load_dwordx4 v[120:123], v88, s[60:63], s42 offen
    s_mov_b32 s12, s16
    s_mov_b32 s13, s17
    s_mov_b32 s14, 0x280000
    s_mov_b32 s15, 0x20000
    s_load_dword s45, s[38:39], 0x1f000
    v_lshrrev_b32 v3, 5, v0
    v_mul_u32_u24 v89, 1280, v3
    v_lshlrev_b32 v134, 3, v3
    v_and_b32 v4, 31, v0
    v_lshl_add_u32 v89, v4, 4, v89
    s_and_b32 s68, s2, 7
    s_lshl_b32 s68, s68, 5
    s_lshr_b32 s70, s2, 3
    s_add_u32 s68, s68, s70
    s_mul_i32 s70, s68, 10240
    v_mov_b32 v98, 0
    v_mov_b32 v99, 0
    v_mov_b32 v100, 0
    v_mov_b32_e64 v101, 0
    buffer_load_dwordx4 v[90:93], v89, s[12:15], s70 offen
    buffer_load_dwordx4 v[94:97], v89, s[12:15], s70 offen offset:512
    s_mov_b32 exec_lo, 0xffff
    s_mov_b32 exec_hi, 0xffff
    buffer_load_dwordx4 v[98:101], v89, s[12:15], s70 offen offset:1024
    s_mov_b64 exec, -1
    v_add_u32 v3, 0, v1
    v_mul_u32_u24 v4, 3277, v3
    v_lshrrev_b32_e64 v4, 16, v4
    v_mul_u32_u24 v82, 3520, v4
    v_lshl_add_u32 v82, v3, 4, v82
    v_add_u32_e64 v3, 64, v1
    v_mul_u32_u24 v4, 3277, v3
    v_lshrrev_b32_e64 v4, 16, v4
    v_mul_u32_u24 v83, 3520, v4
    v_lshl_add_u32 v83, v3, 4, v83
    v_add_u32 v3, 128, v1
    v_mul_u32_u24 v4, 3277, v3
    v_lshrrev_b32_e64 v4, 16, v4
    v_mul_u32_u24 v84, 3520, v4
    v_lshl_add_u32 v84, v3, 4, v84
    v_add_u32 v3, 192, v1
    v_mul_u32_u24 v4, 3277, v3
    v_lshrrev_b32_e64 v4, 16, v4
    v_mul_u32_u24 v85, 3520, v4
    v_lshl_add_u32 v85, v3, 4, v85
    v_add_u32 v3, 256, v1
    v_mul_u32_u24 v4, 3277, v3
    v_lshrrev_b32_e64 v4, 16, v4
    v_mul_u32_u24 v86, 3520, v4
    v_lshl_add_u32 v86, v3, 4, v86
    s_sub_u32 s46, s2, 96
    s_lshr_b32 s71, s46, 2
    s_mul_i32 s71, s71, 61440
    s_mul_i32 s49, s40, 1280
    s_add_u32 s71, s71, s49
    s_and_b32 s49, s46, 3
    s_mul_i32 s49, s49, 320
    s_add_u32 s71, s71, s49
    s_cmp_ge_u32 s2, 96
    s_cselect_b32 s71, s71, 0x10000000
    s_add_u32 s72, s44, 102400
    s_cmp_lt_u32 s40, 3
    s_cselect_b32 s71, s71, 0x10000000
    s_cselect_b32 s72, s72, 0
    s_mov_b32 s60, s18
    s_mov_b32 s61, s19
    s_mov_b32 s62, 0x258000
    s_mov_b32 s63, 0x20000
    s_add_u32 m0, s72, 0
    s_nop 0
    buffer_load_dwordx4 v82, s[60:63], s71 offen lds
    s_add_u32 m0, s72, 1024
    s_nop 0
    buffer_load_dwordx4 v83, s[60:63], s71 offen lds
    s_add_u32 m0, s72, 2048
    s_nop 0
    buffer_load_dwordx4 v84, s[60:63], s71 offen lds
    s_add_u32 m0, s72, 3072
    s_nop 0
    buffer_load_dwordx4 v85, s[60:63], s71 offen lds
    s_add_u32 m0, s72, 4096
    s_nop 0
    buffer_load_dwordx4 v86, s[60:63], s71 offen lds
    s_bfe_u32 s50, s2, 0x20001
    s_lshl_b32 s50, s50, 1
    s_lshr_b32 s41, s2, 7
    s_add_u32 s50, s50, s41
    s_lshl_b32 s41, s50, 3
    s_add_u32 s52, s41, s40
    s_sub_u32 s53, s41, s40
    s_add_u32 s53, s53, 7
    s_mul_i32 s52, s52, 40960
    s_mul_i32 s53, s53, 40960
    s_lshl_b32 s54, s40, 14
    s_add_u32 s54, s54, 36864
    v_lshrrev_b32 v3, 3, v1
    v_mul_u32_u24 v77, 1280, v3
    v_lshrrev_b32 v3, 4, v1
    v_and_b32 v4, 7, v1
    v_xor_b32 v3, v3, v4
    v_xor_b32_e64 v4, 4, v3
    v_lshl_add_u32 v74, v3, 4, v77
    v_lshl_add_u32 v75, v4, 4, v77
    v_add_u32 v76, 18432, v74
    v_add_u32 v77, 27648, v75
    v_add_u32 v75, 9216, v75
    s_mov_b32 s8, s38
    s_mov_b32 s9, s39
    s_mov_b32 s10, 0x3000000
    s_mov_b32 s11, 0x20000
    v_and_b32 v3, 7, v0
    v_lshlrev_b32 v135, 5, v3
    v_bfe_u32 v4, v0, 4, 2
    v_lshl_add_u32 v135, v4, 3, v135
    v_lshrrev_b32 v4, 6, v0
    v_lshl_add_u32 v135, v4, 8, v135
    v_lshlrev_b32 v7, 2, v1
    v_lshlrev_b32_e64 v69, 3, v1
    s_lshr_b32 s49, s2, 2
    s_and_b32 s48, s2, 3
    s_lshl_b32 s69, s49, 8
    s_mul_i32 s46, s48, 15360
    s_add_u32 s69, s69, s46
    s_sub_u32 s46, s2, 80
    s_cmp_lt_u32 s46, 160
    s_cselect_b32 s69, s69, 0x10000000
    s_lshl_b32 s59, s49, 9
    s_mul_i32 s48, s48, 10240
    s_add_u32 s59, s59, s48
    s_add_u32 s59, s59, 0x90000
    s_cmp_lt_u32 s2, 80
    s_cselect_b32 s59, s59, 0x10000000
    s_cmp_eq_u32 s40, 0
    s_cselect_b32 s59, s59, 0x10000000
    s_cselect_b32 s69, s69, 0x10000000
    s_waitcnt lgkmcnt(0)
    s_mul_i32 s45, s45, 0x9e3779b1
    s_add_u32 s45, s45, 0x7f4a7c15
    v_mov_b32_e64 v6, s45
    s_cmp_ge_u32 s2, 248
    s_cselect_b32 s49, 20480, 0
    s_cmp_lt_u32 s2, 216
    s_cselect_b64 s[74:75], -1, 0
    v_lshrrev_b32 v4, 3, v1
    v_mul_u32_u24 v176, 3456, v4
    v_and_b32 v4, 7, v1
    v_lshl_add_u32 v176, v4, 4, v176
    v_add_u32 v3, 0, v1
    v_mul_u32_u24 v4, 1639, v3
    v_lshrrev_b32 v4, 16, v4
    v_mul_u32_u24 v82, 640, v4
    v_lshl_add_u32 v82, v3, 4, v82
    v_add_u32 v3, 0, v176
    v_cndmask_b32 v179, v82, v3, s[74:75]
    v_add_u32 v3, 64, v1
    v_mul_u32_u24 v4, 1639, v3
    v_lshrrev_b32 v4, 16, v4
    v_mul_u32_u24 v83, 640, v4
    v_lshl_add_u32 v83, v3, 4, v83
    v_add_u32 v3, 27648, v176
    v_cndmask_b32 v180, v83, v3, s[74:75]
    v_add_u32 v3, 128, v1
    v_mul_u32_u24 v4, 1639, v3
    v_lshrrev_b32 v4, 16, v4
    v_mul_u32_u24 v84, 640, v4
    v_lshl_add_u32 v84, v3, 4, v84
    v_lshrrev_b32 v4, 2, v4
    v_mad_u32_u24 v4, v4, s49, v84
    v_add_u32 v3, 55296, v176
    v_cndmask_b32 v181, v4, v3, s[74:75]
    v_add_u32 v3, 192, v1
    v_mul_u32_u24 v4, 1639, v3
    v_lshrrev_b32 v4, 16, v4
    v_mul_u32_u24 v85, 640, v4
    v_lshl_add_u32 v85, v3, 4, v85
    v_lshrrev_b32 v4, 2, v4
    v_mad_u32_u24 v4, v4, s49, v85
    v_add_u32 v3, 82944, v176
    v_cndmask_b32 v182, v4, v3, s[74:75]
    v_add_u32 v3, 256, v1
    v_mul_u32_u24 v4, 1639, v3
    v_lshrrev_b32 v4, 16, v4
    v_mul_u32_u24 v86, 640, v4
    v_lshl_add_u32 v86, v3, 4, v86
    v_lshrrev_b32 v4, 2, v4
    v_mad_u32_u24 v4, v4, s49, v86
    v_add_u32 v3, 110592, v176
    v_cndmask_b32 v183, v4, v3, s[74:75]
    s_mov_b32 s64, s28
    s_mov_b32 s65, s29
    s_mov_b32 s66, 0x21c000
    s_mov_b32 s67, 0x20000
    s_add_u32 s41, s2, 12
    s_and_b32 s41, s41, 255
    s_lshr_b32 s48, s41, 1
    s_and_b32 s49, s2, 1
    s_lshl_b32 s46, s49, 2
    s_add_u32 s46, s46, s40
    s_mul_i32 s49, s49, 640
    s_mul_i32 s79, s46, 54
    s_add_u32 s79, s79, s48
    s_mul_i32 s79, s79, 5120
    s_add_u32 s79, s79, 0x1400000
    s_lshl_b32 s48, s48, 2
    s_add_u32 s48, s48, s40
    s_mul_i32 s48, s48, 10240
    s_add_u32 s81, s48, s49
    s_cmp_lt_u32 s41, 108
    s_cselect_b32 s81, s81, 0x10000000
    s_cselect_b32 s79, s79, 0x10000000
    s_sub_u32 s48, s2, 216
    s_lshr_b32 s48, s48, 1
    s_mul_i32 s78, s46, 20
    s_add_u32 s78, s78, s48
    s_mul_i32 s78, s78, 5120
    s_add_u32 s78, s78, 0x1300000
    s_lshr_b32 s41, s40, 1
    s_mul_i32 s41, s41, 4
    s_lshl_b32 s42, s40, 3
    s_add_u32 s41, s41, s42
    s_mul_i32 s42, s48, 40
    s_add_u32 s41, s41, s42
    s_lshl_b32 s42, s42, 2
    s_mul_i32 s46, s40, 40
    s_add_u32 s42, s42, s46
    s_sub_u32 s42, s42, 2544
    s_cmp_lt_u32 s48, 16
    s_cselect_b32 s41, s41, s42
    s_mul_i32 s41, s41, 1280
    s_add_u32 s80, s41, s49
    s_mov_b32 s62, 0xc8000
    s_cmp_lt_u32 s40, 2
    s_cselect_b32 s41, s24, s26
    s_cselect_b32 s42, s25, s27
    s_cmp_lt_u32 s2, 216
    s_cselect_b32 s60, s41, s20
    s_cselect_b32 s61, s42, s21
    s_cselect_b32 s62, 0x21c000, s62
    s_and_b32 s49, s40, 1
    s_mul_i32 s49, s49, 138240
    s_and_b32 s46, s2, 7
    s_mul_i32 s48, s46, 276480
    s_add_u32 s48, s48, s49
    s_lshr_b32 s49, s2, 3
    s_lshl_b32 s41, s49, 7
    s_add_u32 s41, s48, s41
    s_cmp_lt_u32 s2, 216
    s_cselect_b32 s80, s41, s80
    s_waitcnt vmcnt(13)
    v_alignbyte_b32 v130, v131, v130, v87
    v_alignbyte_b32 v131, v132, v131, v87
    v_alignbyte_b32 v132, v132, v132, v87
    v_lshlrev_b32 v124, 16, v130
    v_and_b32 v125, 0xffff0000, v130
    v_lshlrev_b32 v126, 16, v131
    v_and_b32 v127, 0xffff0000, v131
    v_lshlrev_b32_e64 v128, 16, v132
    v_mul_f32 v140, 0xbfb8aa3b, v124
    v_mul_f32 v141, 0xbfb8aa3b, v125
    v_mul_f32 v142, 0xbfb8aa3b, v126
    v_mul_f32 v143, 0xbfb8aa3b, v127
    v_mul_f32 v144, 0xbfb8aa3b, v128
    v_exp_f32 v140, v140
    v_exp_f32 v141, v141
    v_exp_f32 v142, v142
    v_exp_f32 v143, v143
    v_exp_f32 v144, v144
    v_add_f32 v140, 1.0, v140
    v_add_f32 v141, 1.0, v141
    v_add_f32 v142, 1.0, v142
    v_add_f32 v143, 1.0, v143
    v_add_f32 v144, 1.0, v144
    v_rcp_f32 v140, v140
    v_rcp_f32 v141, v141
    v_rcp_f32 v142, v142
    v_rcp_f32 v143, v143
    v_rcp_f32 v144, v144
    v_mul_f32 v140, v124, v140
    v_mul_f32 v141, v125, v141
    v_mul_f32 v142, v126, v142
    v_mul_f32 v143, v127, v143
    v_mul_f32 v144, v128, v144
    v_cvt_pk_bf16_f32 v140, v140, 0
    v_cvt_pk_bf16_f32 v141, v141, 0
    v_cvt_pk_bf16_f32 v142, v142, 0
    v_cvt_pk_bf16_f32 v143, v143, 0
    v_cvt_pk_bf16_f32 v144, v144, 0
    v_lshlrev_b32 v145, 16, v140
    v_lshlrev_b32 v146, 16, v141
    v_lshlrev_b32 v147, 16, v142
    v_lshlrev_b32 v148, 16, v143
    v_lshlrev_b32 v149, 16, v144
    s_waitcnt vmcnt(12)
    v_dot2_f32_bf16 v150, v104, v140, 0
    v_dot2_f32_bf16 v151, v104, v145, 0
    v_dot2_f32_bf16 v152, v105, v140, 0
    v_dot2_f32_bf16 v153, v105, v145, 0
    v_dot2_f32_bf16 v154, v106, v140, 0
    v_dot2_f32_bf16 v155, v106, v145, 0
    v_dot2_f32_bf16 v156, v107, v140, 0
    v_dot2_f32_bf16 v157, v107, v145, 0
    s_waitcnt vmcnt(11)
    v_dot2_f32_bf16 v150, v108, v141, v150
    v_dot2_f32_bf16 v151, v108, v146, v151
    v_dot2_f32_bf16 v152, v109, v141, v152
    v_dot2_f32_bf16 v153, v109, v146, v153
    v_dot2_f32_bf16 v154, v110, v141, v154
    v_dot2_f32_bf16 v155, v110, v146, v155
    v_dot2_f32_bf16 v156, v111, v141, v156
    v_dot2_f32_bf16 v157, v111, v146, v157
    s_waitcnt vmcnt(10)
    v_dot2_f32_bf16 v150, v112, v142, v150
    v_dot2_f32_bf16 v151, v112, v147, v151
    v_dot2_f32_bf16 v152, v113, v142, v152
    v_dot2_f32_bf16 v153, v113, v147, v153
    v_dot2_f32_bf16 v154, v114, v142, v154
    v_dot2_f32_bf16 v155, v114, v147, v155
    v_dot2_f32_bf16 v156, v115, v142, v156
    v_dot2_f32_bf16 v157, v115, v147, v157
    s_waitcnt vmcnt(9)
    v_dot2_f32_bf16 v150, v116, v143, v150
    v_dot2_f32_bf16 v151, v116, v148, v151
    v_dot2_f32_bf16 v152, v117, v143, v152
    v_dot2_f32_bf16 v153, v117, v148, v153
    v_dot2_f32_bf16 v154, v118, v143, v154
    v_dot2_f32_bf16 v155, v118, v148, v155
    v_dot2_f32_bf16 v156, v119, v143, v156
    v_dot2_f32_bf16 v157, v119, v148, v157
    s_waitcnt vmcnt(8)
    v_dot2_f32_bf16 v150, v120, v144, v150
    v_dot2_f32_bf16 v151, v120, v149, v151
    v_dot2_f32_bf16 v152, v121, v144, v152
    v_dot2_f32_bf16 v153, v121, v149, v153
    v_dot2_f32_bf16 v154, v122, v144, v154
    v_dot2_f32_bf16 v155, v122, v149, v155
    v_dot2_f32_bf16 v156, v123, v144, v156
    v_dot2_f32_bf16 v157, v123, v149, v157
    v_permlane32_swap_b32 v150, v154
    v_permlane32_swap_b32 v151, v155
    v_permlane32_swap_b32 v152, v156
    v_permlane32_swap_b32 v153, v157
    v_add_f32 v150, v150, v154
    v_add_f32 v151, v151, v155
    v_add_f32 v152, v152, v156
    v_add_f32 v153, v153, v157
    s_nop 0
    v_permlane16_swap_b32 v150, v152
    v_permlane16_swap_b32 v151, v153
    v_add_f32 v150, v150, v152
    v_add_f32 v151, v151, v153
    s_nop 0
    v_add_f32 v150, v150, v150 row_ror:8 row_mask:0xf bank_mask:0xf
    v_add_f32 v151, v151, v151 row_ror:8 row_mask:0xf bank_mask:0xf
    ds_write_b64 v135, v[150:151] offset:35584
    s_waitcnt lgkmcnt(0)
    s_barrier
    ds_read_b32 v150, v7 offset:35584
    ds_read_b32 v151, v7 offset:35840
    ds_read_b32 v152, v7 offset:36096
    ds_read_b32 v153, v7 offset:36352
    s_waitcnt lgkmcnt(2)
    v_add_f32 v150, v150, v151
    s_waitcnt lgkmcnt(0)
    v_add_f32 v152, v152, v153
    v_add_f32 v150, v150, v152
    v_mov_b32 v151, v6
    buffer_store_dwordx2 v[150:151], v69, s[8:11], s59 offen sc1
    buffer_store_dword v150, v7, s[8:11], s69 offen sc1
    v_and_b32 v3, 31, v1
    v_lshlrev_b32 v81, 7, v3
    v_add_u32 v81, s54, v81
    v_bfe_u32 v3, v1, 1, 3
    v_lshrrev_b32 v4, 5, v1
    s_add_u32 m0, s54, 0
    s_add_u32 s43, s52, 0
    buffer_load_dwordx4 v74, s[12:15], s43 offen offset:0 lds
    v_xor_b32 v3, v3, v4
    v_xor_b32 v4, 0, v3
    v_lshl_add_u32 v78, v4, 4, v81
    v_xor_b32_e64 v4, 2, v3
    buffer_load_dwordx4 v75, s[12:15], s43 offen offset:1024 lds
    v_lshl_add_u32 v79, v4, 4, v81
    v_xor_b32 v4, 4, v3
    v_lshl_add_u32 v80, v4, 4, v81
    v_xor_b32 v4, 6, v3
    buffer_load_dwordx4 v76, s[12:15], s43 offen offset:2048 lds
    v_lshl_add_u32 v81, v4, 4, v81
    v_mov_b32 v129, 0x3f803f80
    v_add_u32 v5, 4096, v2
    v_bfe_u32 v174, v1, 4, 1
    v_and_b32_e64 v3, 3, v1
    buffer_load_dwordx4 v77, s[12:15], s43 offen offset:3072 lds
    v_lshl_add_u32 v174, v174, 2, v3
    v_lshlrev_b32_e64 v174, 2, v174
    v_lshrrev_b32 v175, 5, v1
    v_bfe_u32 v3, v1, 2, 2
    s_add_u32 m0, s54, 4096
    s_add_u32 s43, s53, 0
    buffer_load_dwordx4 v74, s[12:15], s43 offen offset:0 lds
    v_lshl_add_u32 v175, v175, 3, v3
    v_mul_u32_u24 v175, 320, v175
    s_mul_i32 s48, s40, 80
    s_add_u32 s48, s48, 102400
    buffer_load_dwordx4 v75, s[12:15], s43 offen offset:1024 lds
    v_add_u32_e64 v175, s48, v175
    s_mov_b32 s48, 0x11200000
    v_bfe_u32 v3, s48, v174, 4
    s_mov_b32 s48, 0x10443210
    v_bfe_u32 v4, s48, v174, 4
    buffer_load_dwordx4 v76, s[12:15], s43 offen offset:2048 lds
    v_mul_u32_u24 v3, 5120, v3
    v_lshl_add_u32 v3, v4, 3, v3
    v_add_u32_e64 v177, v3, v175
    s_mov_b32 s48, 0x22221111
    buffer_load_dwordx4 v77, s[12:15], s43 offen offset:3072 lds
    v_bfe_u32 v3, s48, v174, 4
    s_mov_b32 s48, 0x31204432
    v_bfe_u32 v4, s48, v174, 4
    v_mul_u32_u24 v3, 5120, v3
    s_add_u32 m0, s54, 8192
    s_add_u32 s43, s52, 128
    buffer_load_dwordx4 v74, s[12:15], s43 offen offset:0 lds
    v_lshl_add_u32 v3, v4, 3, v3
    v_add_u32_e64 v178, v3, v175
    s_sub_u32 s46, s2, 96
    s_and_b32 s55, s46, 3
    buffer_load_dwordx4 v75, s[12:15], s43 offen offset:1024 lds
    s_lshl_b32 s55, s55, 2
    s_add_u32 s55, s55, s40
    s_mul_i32 s55, s55, 163840
    s_lshr_b32 s49, s46, 2
    s_lshl_b32 s49, s49, 11
    buffer_load_dwordx4 v76, s[12:15], s43 offen offset:2048 lds
    s_add_u32 s55, s55, s49
    s_add_u32 s55, s55, 0x400000
    s_cmp_ge_u32 s2, 96
    s_cselect_b32 s55, s55, 0x10000000
    s_add_u32 s58, s55, 81920
    buffer_load_dwordx4 v77, s[12:15], s43 offen offset:3072 lds
    s_lshl_b32 s68, s68, 7
    s_add_u32 s68, s68, 0x80000
    s_cmp_eq_u32 s40, 0
    s_cselect_b32 s68, s68, 0x10000000
    s_mov_b32 s56, 0
    s_waitcnt vmcnt(8)
    ds_read_b128 a[0:3], v78 offset:0
    ds_read_b128 a[4:7], v79 offset:0
    ds_read_b128 a[8:11], v80 offset:0
    ds_read_b128 a[12:15], v81 offset:0
    s_mov_b32 s57, -1
    v_bfe_u32 v3, v1, 3, 2
    v_mul_u32_u24 v184, 10240, v3
    v_and_b32_e64 v4, 7, v1
    v_lshl_add_u32 v184, v4, 4, v184
    s_add_u32 m0, s54, 12288
    s_add_u32 s43, s53, 128
    buffer_load_dwordx4 v74, s[12:15], s43 offen offset:0 lds
    v_add_u32 v3, 5120, v184
    v_cndmask_b32 v184, v3, v184, s[56:57]
    s_lshl_b32 s48, s40, 6
    s_add_u32 s48, s48, 34816
    buffer_load_dwordx4 v75, s[12:15], s43 offen offset:1024 lds
    v_lshrrev_b32_e64 v3, 5, v1
    v_lshl_add_u32 v186, v3, 4, s48
    v_lshl_add_u32 v185, v3, 5, s48
    v_lshl_add_u32 v185, v4, 2, v185
    buffer_load_dwordx4 v76, s[12:15], s43 offen offset:2048 lds
    v_cndmask_b32 v188, 1.0, 0, s[56:57]
    s_sub_u32 s46, s2, 96
    s_lshr_b32 s49, s46, 2
    s_lshl_b32 s73, s49, 7
    s_add_u32 s73, s73, 0x90000
    buffer_load_dwordx4 v77, s[12:15], s43 offen offset:3072 lds
    s_and_b32 s76, s46, 3
    s_lshl_b32 s76, s76, 2
    s_add_u32 s76, s76, s40
    s_mul_i32 s76, s76, 80
    s_add_u32 m0, s44, 118784
    s_nop 0
    buffer_load_dwordx4 v179, s[60:63], s80 offen lds
    s_add_u32 s76, s76, s49
    s_lshl_b32 s76, s76, 9
    s_add_u32 s76, s76, 0x100000
    s_lshl_b32 s77, s2, 2
    s_add_u32 m0, s44, 119808
    s_nop 0
    buffer_load_dwordx4 v180, s[60:63], s80 offen lds
    s_add_u32 s77, s77, s40
    s_lshl_b32 s77, s77, 7
    s_add_u32 s77, s77, 0xc0000
    s_cmp_ge_u32 s2, 96
    s_cselect_b32 s73, s73, 0x10000000
    s_cselect_b32 s76, s76, 0x10000000
    s_cselect_b32 s77, s77, 0x10000000
    s_add_u32 m0, s44, 120832
    s_nop 0
    buffer_load_dwordx4 v181, s[60:63], s80 offen lds
    buffer_load_dwordx4 v[190:193], v184, s[8:11], s73 offen sc1
    v_dot2_f32_bf16 v136, v90, v129, 0
    v_dot2_f32_bf16 v137, v90, v90, 0
    v_dot2_f32_bf16 v136, v91, v129, v136
    v_dot2_f32_bf16 v137, v91, v91, v137
    v_dot2_f32_bf16 v136, v92, v129, v136
    v_dot2_f32_bf16 v137, v92, v92, v137
    s_waitcnt vmcnt(12)
    ds_read_b128 a[16:19], v78 offset:4096
    ds_read_b128 a[20:23], v79 offset:4096
    ds_read_b128 a[24:27], v80 offset:4096
    ds_read_b128 a[28:31], v81 offset:4096
    v_dot2_f32_bf16 v136, v93, v129, v136
    v_dot2_f32_bf16 v137, v93, v93, v137
    v_dot2_f32_bf16 v136, v94, v129, v136
    v_dot2_f32_bf16 v137, v94, v94, v137
    v_dot2_f32_bf16 v136, v95, v129, v136
    v_dot2_f32_bf16 v137, v95, v95, v137
    s_waitcnt lgkmcnt(4)
    s_add_u32 m0, s54, 0
    s_add_u32 s43, s52, 256
    buffer_load_dwordx4 v74, s[12:15], s43 offen offset:0 lds
    v_dot2_f32_bf16 v136, v96, v129, v136
    v_dot2_f32_bf16 v137, v96, v96, v137
    v_dot2_f32_bf16 v136, v97, v129, v136
    v_dot2_f32_bf16 v137, v97, v97, v137
    v_dot2_f32_bf16 v136, v98, v129, v136
    buffer_load_dwordx4 v75, s[12:15], s43 offen offset:1024 lds
    v_dot2_f32_bf16 v137, v98, v98, v137
    v_dot2_f32_bf16 v136, v99, v129, v136
    v_dot2_f32_bf16 v137, v99, v99, v137
    v_dot2_f32_bf16 v136, v100, v129, v136
    v_dot2_f32_bf16 v137, v100, v100, v137
    v_dot2_f32_bf16 v136, v101, v129, v136
    buffer_load_dwordx4 v76, s[12:15], s43 offen offset:2048 lds
    v_dot2_f32_bf16 v137, v101, v101, v137
    s_nop 1
    v_add_f32 v136, v136, v136 row_ror:8 row_mask:0xf bank_mask:0xf
    v_add_f32 v137, v137, v137 row_ror:8 row_mask:0xf bank_mask:0xf
    s_nop 0
    v_add_f32 v136, v136, v136 row_ror:4 row_mask:0xf bank_mask:0xf
    v_add_f32 v137, v137, v137 row_ror:4 row_mask:0xf bank_mask:0xf
    buffer_load_dwordx4 v77, s[12:15], s43 offen offset:3072 lds
    v_add_f32 v136, v136, v136 row_ror:2 row_mask:0xf bank_mask:0xf
    v_add_f32 v137, v137, v137 row_ror:2 row_mask:0xf bank_mask:0xf
    s_nop 0
    v_add_f32 v136, v136, v136 row_ror:1 row_mask:0xf bank_mask:0xf
    v_add_f32 v137, v137, v137 row_ror:1 row_mask:0xf bank_mask:0xf
    v_mov_b32 v138, v136
    s_add_u32 m0, s44, 121856
    s_nop 0
    buffer_load_dwordx4 v182, s[60:63], s80 offen lds
    v_mov_b32_e64 v139, v137
    v_permlane16_swap_b32 v136, v138
    s_nop 0
    v_permlane16_swap_b32 v137, v139
    v_add_f32_e64 v136, v136, v138
    v_add_f32_e64 v139, v137, v139
    v_mul_f32 v136, 0xbacccccd, v136
    s_add_u32 m0, s44, 122880
    s_nop 0
    buffer_load_dwordx4 v183, s[60:63], s80 offen lds
    v_mov_b32 v137, 0x3727c5ac
    v_fmac_f32 v137, 0x3acccccd, v139
    v_fma_f32 v137, -v136, v136, v137
    v_max_f32 v137, 0x3727c5ac, v137
    ds_write_b64 v134, v[136:137] offset:35328
    s_add_u32 m0, s44, 139264
    s_nop 0
    buffer_load_dwordx4 v82, s[64:67], s81 offen lds
    s_waitcnt lgkmcnt(0)
    s_barrier
    ds_read_b64_tr_b16 v[158:159], v177 offset:0
    ds_read_b64_tr_b16 v[160:161], v177 offset:1280
    ds_read_b64_tr_b16 v[162:163], v178 offset:0
    ds_read_b64_tr_b16 v[164:165], v178 offset:1280
    ds_read_b64_tr_b16 v[166:167], v177 offset:40
    ds_read_b64_tr_b16 v[168:169], v177 offset:1320
    ds_read_b64_tr_b16 v[170:171], v178 offset:40
    ds_read_b64_tr_b16 v[172:173], v178 offset:1320
    ds_read_b32 v189, v7 offset:35328
    s_waitcnt vmcnt(7)
    s_cmp_lt_u32 s2, 96
    s_cbranch_scc1 L0_k1
    v_cmp_ne_u32 vcc, s45, v191
    v_cmp_ne_u32 s[74:75], s45, v193
    s_nop 0
    s_or_b64 vcc, vcc, s[74:75]
    s_cbranch_scc1 Ls_T
Lr_T:
    v_add_f32 v190, v190, v190 row_ror:8 row_mask:0xf bank_mask:0xf
    v_add_f32 v192, v192, v192 row_ror:8 row_mask:0xf bank_mask:0xf
    v_mov_b32 v191, v190
    v_mov_b32_e64 v193, v192
    s_nop 0
    v_permlane16_swap_b32 v190, v191
    v_permlane16_swap_b32 v192, v193
    v_add_f32_e64 v190, v190, v191
    v_add_f32_e64 v192, v192, v193
    v_cvt_pk_bf16_f32 v191, v190, v192
    v_lshlrev_b32 v190, 16, v191
    v_and_b32 v192, 0xffff0000, v191
    v_add_f32_e64 v190, v190, v188
    v_add_f32_e64 v192, v192, v188
    v_cvt_pk_bf16_f32 v191, v190, v192
    ds_write_b32 v185, v191
    ds_read_b128 v[194:197], v186
    ds_read_b128 v[206:209], v186 offset:32
    s_waitcnt lgkmcnt(1)
    v_and_b32 v198, 0xffff, v194
    v_and_b32 v199, 0xffff0000, v194
    v_and_b32 v200, 0xffff, v195
    v_and_b32 v201, 0xffff0000, v195
    v_and_b32 v202, 0xffff, v196
    v_and_b32 v203, 0xffff0000, v196
    v_and_b32 v204, 0xffff, v197
    v_and_b32 v205, 0xffff0000, v197
    v_dot2_f32_bf16 v210, v158, v198, 0
    v_dot2_f32_bf16 v211, v158, v199, 0
    v_dot2_f32_bf16 v212, v159, v200, 0
    v_dot2_f32_bf16 v213, v159, v201, 0
    v_dot2_f32_bf16 v214, v160, v202, 0
    v_dot2_f32_bf16 v215, v160, v203, 0
    v_dot2_f32_bf16 v216, v161, v204, 0
    v_dot2_f32_bf16 v217, v161, v205, 0
    v_cvt_pk_bf16_f32 v218, v210, v211
    v_cvt_pk_bf16_f32 v219, v212, v213
    v_cvt_pk_bf16_f32 v220, v214, v215
    v_cvt_pk_bf16_f32 v221, v216, v217
    v_dot2_f32_bf16 v210, v162, v198, 0
    v_dot2_f32_bf16 v211, v162, v199, 0
    v_dot2_f32_bf16 v212, v163, v200, 0
    v_dot2_f32_bf16 v213, v163, v201, 0
    v_dot2_f32_bf16 v214, v164, v202, 0
    v_dot2_f32_bf16 v215, v164, v203, 0
    v_dot2_f32_bf16 v216, v165, v204, 0
    v_dot2_f32_bf16 v217, v165, v205, 0
    v_cvt_pk_bf16_f32 v222, v210, v211
    v_cvt_pk_bf16_f32 v223, v212, v213
    v_cvt_pk_bf16_f32 v224, v214, v215
    v_cvt_pk_bf16_f32 v225, v216, v217
    v_dot2_f32_bf16 v210, v166, v198, 0
    v_dot2_f32_bf16 v211, v166, v199, 0
    v_dot2_f32_bf16 v212, v167, v200, 0
    v_dot2_f32_bf16 v213, v167, v201, 0
    v_dot2_f32_bf16 v214, v168, v202, 0
    v_dot2_f32_bf16 v215, v168, v203, 0
    v_dot2_f32_bf16 v216, v169, v204, 0
    v_dot2_f32_bf16 v217, v169, v205, 0
    v_cvt_pk_bf16_f32 v226, v210, v211
    v_cvt_pk_bf16_f32 v227, v212, v213
    v_cvt_pk_bf16_f32 v228, v214, v215
    v_cvt_pk_bf16_f32 v229, v216, v217
    v_dot2_f32_bf16 v210, v170, v198, 0
    v_dot2_f32_bf16 v211, v170, v199, 0
    v_dot2_f32_bf16 v212, v171, v200, 0
    v_dot2_f32_bf16 v213, v171, v201, 0
    v_dot2_f32_bf16 v214, v172, v202, 0
    v_dot2_f32_bf16 v215, v172, v203, 0
    v_dot2_f32_bf16 v216, v173, v204, 0
    v_dot2_f32_bf16 v217, v173, v205, 0
    v_cvt_pk_bf16_f32 v230, v210, v211
    v_cvt_pk_bf16_f32 v231, v212, v213
    v_cvt_pk_bf16_f32 v232, v214, v215
    v_cvt_pk_bf16_f32 v233, v216, v217
L0_k1:
    s_waitcnt lgkmcnt(0)
    buffer_store_dwordx4 v[218:221], v2, s[8:11], s55 offen offset:0 sc1
    buffer_store_dwordx4 v[222:225], v2, s[8:11], s55 offen offset:1024 sc1
    buffer_store_dwordx4 v[226:229], v2, s[8:11], s58 offen offset:0 sc1
    buffer_store_dwordx4 v[230:233], v2, s[8:11], s58 offen offset:1024 sc1
    s_cmp_lt_u32 s2, 96
    s_cbranch_scc1 L0_k2
    v_dot2_f32_bf16 v210, v218, v129, 0
    v_dot2_f32_bf16 v211, v158, v206, 0
    v_dot2_f32_bf16 v212, v222, v129, 0
    v_dot2_f32_bf16 v213, v162, v206, 0
    v_dot2_f32_bf16 v214, v226, v129, 0
    v_dot2_f32_bf16 v215, v166, v206, 0
    v_dot2_f32_bf16 v216, v230, v129, 0
    v_dot2_f32_bf16 v217, v170, v206, 0
    v_dot2_f32_bf16 v210, v219, v129, v210
    v_dot2_f32_bf16 v211, v159, v207, v211
    v_dot2_f32_bf16 v212, v223, v129, v212
    v_dot2_f32_bf16 v213, v163, v207, v213
    v_dot2_f32_bf16 v214, v227, v129, v214
    v_dot2_f32_bf16 v215, v167, v207, v215
    v_dot2_f32_bf16 v216, v231, v129, v216
    v_dot2_f32_bf16 v217, v171, v207, v217
    v_dot2_f32_bf16 v210, v220, v129, v210
    v_dot2_f32_bf16 v211, v160, v208, v211
    v_dot2_f32_bf16 v212, v224, v129, v212
    v_dot2_f32_bf16 v213, v164, v208, v213
    v_dot2_f32_bf16 v214, v228, v129, v214
    v_dot2_f32_bf16 v215, v168, v208, v215
    v_dot2_f32_bf16 v216, v232, v129, v216
    v_dot2_f32_bf16 v217, v172, v208, v217
    v_dot2_f32_bf16 v210, v221, v129, v210
    v_dot2_f32_bf16 v211, v161, v209, v211
    v_dot2_f32_bf16 v212, v225, v129, v212
    v_dot2_f32_bf16 v213, v165, v209, v213
    v_dot2_f32_bf16 v214, v229, v129, v214
    v_dot2_f32_bf16 v215, v169, v209, v215
    v_dot2_f32_bf16 v216, v233, v129, v216
    v_dot2_f32_bf16 v217, v173, v209, v217
    v_permlane32_swap_b32 v210, v212
    v_permlane32_swap_b32 v211, v213
    v_permlane32_swap_b32 v214, v216
    v_permlane32_swap_b32 v215, v217
    v_pk_add_f32 v[210:211], v[210:211], v[212:213]
    v_pk_add_f32 v[214:215], v[214:215], v[216:217]
L0_k2:
    buffer_store_dwordx2 v[210:211], v69, s[8:11], s76 offen sc1
    s_add_u32 s76, s76, 20480
    buffer_store_dwordx2 v[214:215], v69, s[8:11], s76 offen sc1
    s_mov_b32 exec_hi, 0
    buffer_store_dword v189, v7, s[8:11], s68 offen sc1
    s_mov_b32 exec_hi, -1
    s_lshr_b32 s49, s2, 3
    s_and_b32 s46, s2, 7
    s_lshl_b32 s48, s49, 2
    s_add_u32 s48, s48, s40
    ds_read_b128 a[32:35], v78 offset:8192
    ds_read_b128 a[36:39], v79 offset:8192
    ds_read_b128 a[40:43], v80 offset:8192
    ds_read_b128 a[44:47], v81 offset:8192
    s_mul_i32 s41, s48, 9363
    s_lshr_b32 s41, s41, 16
    s_mul_i32 s49, s41, 7
    s_sub_u32 s42, s48, s49
    s_add_u32 m0, s54, 4096
    s_add_u32 s43, s53, 256
    buffer_load_dwordx4 v74, s[12:15], s43 offen offset:0 lds
    s_sub_u32 s49, s42, 1
    s_min_u32 s49, s49, 6
    s_bitcmp1_b32 s41, 0
    s_cselect_b32 s42, s49, s42
    buffer_load_dwordx4 v75, s[12:15], s43 offen offset:1024 lds
    s_sub_u32 s48, s48, 12
    s_mul_i32 s49, s48, 10923
    s_lshr_b32 s49, s49, 16
    s_mul_i32 s82, s49, 6
    buffer_load_dwordx4 v76, s[12:15], s43 offen offset:2048 lds
    s_sub_u32 s82, s48, s82
    s_cmp_ge_u32 s41, 12
    s_cselect_b32 s41, s49, s41
    s_cselect_b32 s42, s82, s42
    s_mul_i32 s48, s46, 15
    s_add_u32 s48, s48, s42
    buffer_load_dwordx4 v77, s[12:15], s43 offen offset:3072 lds
    s_mul_i32 s49, s42, 40
    s_mul_i32 s46, s46, 5
    s_add_u32 s49, s49, s46
    s_add_u32 m0, s44, 140288
    s_nop 0
    buffer_load_dwordx4 v83, s[64:67], s81 offen lds
    s_cmp_lt_u32 s42, 3
    s_cselect_b32 s48, s48, s49
    s_cselect_b32 s82, 3, 1
    s_mul_i32 s41, s41, 280
    s_add_u32 s48, s48, s41
    s_lshl_b32 s48, s48, 10
    s_add_u32 m0, s44, 141312
    s_nop 0
    buffer_load_dwordx4 v84, s[64:67], s81 offen lds
    s_add_u32 s48, s48, 0x1700000
    s_cmp_lt_u32 s2, 216
    s_cselect_b32 s78, s48, s78
    s_cselect_b32 s82, s82, 1
    s_lshl_b32 s82, s82, 10
    s_add_u32 m0, s44, 142336
    s_nop 0
    buffer_load_dwordx4 v85, s[64:67], s81 offen lds
    s_waitcnt vmcnt(7)
    s_mov_b32 exec_hi, 0
    buffer_store_dword v6, v7, s[8:11], s77 offen offset:0 sc1
    s_mov_b64 exec, -1
    s_lshl_b32 s47, s2, 4
    s_add_u32 s47, s47, 0x2f90000
    s_cmp_eq_u32 s40, 0
    s_cselect_b32 s47, s47, 0x10000000
    s_mov_b64 exec, 0xf
    buffer_store_dword v6, v7, s[8:11], s47 offen sc1
    s_mov_b64 exec, -1
    v_lshrrev_b32 v3, 5, v1
    v_bfe_u32 v4, v1, 2, 2
    v_lshl_add_u32 v3, v3, 3, v4
    v_lshlrev_b32_e64 v62, 7, v3
    v_bfe_u32 v3, v1, 4, 1
    v_mul_u32_u24 v3, 10240, v3
    v_add_u32 v62, v62, v3
    v_and_b32 v3, 1, v1
    v_lshl_add_u32 v62, v3, 4, v62
    ds_read_b128 a[48:51], v78 offset:12288
    ds_read_b128 a[52:55], v79 offset:12288
    ds_read_b128 a[56:59], v80 offset:12288
    ds_read_b128 a[60:63], v81 offset:12288
    v_bfe_u32 v3, v1, 1, 1
    v_lshl_add_u32 v62, v3, 3, v62
    s_lshl_b32 s48, s40, 5
    s_add_u32 s48, s48, 118784
    v_add_u32 v62, s48, v62
    v_lshrrev_b32 v64, 4, v1
    v_lshl_add_u32 v64, v64, 3, v4
    v_mul_u32_u24 v64, 640, v64
    s_waitcnt lgkmcnt(4)
    s_add_u32 m0, s54, 8192
    s_add_u32 s43, s52, 384
    buffer_load_dwordx4 v74, s[12:15], s43 offen offset:0 lds
    s_mul_i32 s48, s40, 160
    s_add_u32 s48, s48, 118784
    v_add_u32_e64 v64, s48, v64
    v_and_b32_e64 v3, 3, v1
    v_lshl_add_u32 v63, v3, 4, v64
    v_lshl_add_u32 v64, v3, 3, v64
    s_and_b32 s51, s2, 1
    s_lshl_b32 s51, s51, 4
    buffer_load_dwordx4 v75, s[12:15], s43 offen offset:1024 lds
    s_bfe_u32 s48, s2, 0x40003
    s_add_u32 s51, s51, s48
    s_lshl_b32 s84, s40, 4
    s_lshr_b32 s49, s51, 1
    s_add_u32 s84, s84, s49
    s_lshl_b32 s84, s84, 7
    s_add_u32 s84, s84, 0xcc000
    v_lshlrev_b32_e64 v10, 13, v1
    buffer_load_dwordx4 v76, s[12:15], s43 offen offset:2048 lds
    s_mul_i32 s83, s51, 81920
    s_lshl_b32 s85, s40, 11
    s_add_u32 s83, s83, s85
    s_add_u32 s83, s83, 0x400000
    s_mul_i32 s86, s51, 40
    s_add_u32 s86, s86, s40
    s_lshl_b32 s86, s86, 9
    s_add_u32 s86, s86, 0x100000
    buffer_load_dwordx4 v77, s[12:15], s43 offen offset:3072 lds
    v_min_u32 v68, 99, v0
    v_mul_u32_u24 v67, 3277, v68
    v_lshrrev_b32_e64 v67, 16, v67
    v_lshlrev_b32_e64 v66, 2, v67
    s_mov_b32 s58, 0x34542
    v_bfe_u32 v65, s58, v66, 4
    v_mul_u32_u24 v65, 2560, v65
    v_lshl_add_u32 v65, v68, 4, v65
    s_add_u32 m0, s44, 143360
    s_nop 0
    buffer_load_dwordx4 v86, s[64:67], s81 offen lds
    v_mul_u32_u24 v66, 320, v67
    v_sub_u32 v65, v65, v66
    s_bfe_u32 s58, s2, 0x10001
    s_lshl_b32 s58, s58, 2
    s_bfe_u32 s68, s2, 0x20003
    s_add_u32 s58, s58, s68
    v_mov_b32 v66, s58
    s_and_b32 s58, s2, 7
    ds_read_b128 a[64:67], v78 offset:0
    ds_read_b128 a[68:71], v79 offset:0
    ds_read_b128 a[72:75], v80 offset:0
    ds_read_b128 a[76:79], v81 offset:0
    v_mov_b32_e64 v3, s58
    v_cmp_lt_u32 s[74:75], 59, v68
    s_nop 1
    v_cndmask_b32 v66, v66, v3, s[74:75]
    v_mul_u32_u24 v66, 320, v66
    v_add_u32 v65, v65, v66
    v_and_b32 v67, 1, v67
    v_cvt_f32_u32_e64 v67, v67
    v_lshlrev_b32_e64 v66, 4, v68
    s_waitcnt lgkmcnt(4)
    s_add_u32 m0, s54, 12288
    s_add_u32 s43, s53, 384
    buffer_load_dwordx4 v74, s[12:15], s43 offen offset:0 lds
    v_add_u32 v66, 159744, v66
    v_lshlrev_b32_e64 v68, 3, v68
    v_add_u32 v68, 161344, v68
    v_bfe_u32 v71, v1, 3, 2
    v_lshlrev_b32_e64 v71, 7, v71
    v_and_b32_e64 v70, 7, v1
    v_lshl_add_u32 v71, v70, 3, v71
    v_and_b32_e64 v70, 1, v1
    v_mul_u32_u24 v70, 160, v70
    buffer_load_dwordx4 v75, s[12:15], s43 offen offset:1024 lds
    v_lshrrev_b32_e64 v3, 5, v1
    v_lshl_add_u32 v70, v3, 4, v70
    v_add_u32 v70, 161824, v70
    s_lshl_b32 s42, s50, 3
    s_add_u32 s68, s42, s40
    s_lshl_b32 s68, s68, 9
    s_add_u32 s68, s68, 0x80000
    s_sub_u32 s69, s42, s40
    buffer_load_dwordx4 v76, s[12:15], s43 offen offset:2048 lds
    s_lshl_b32 s69, s69, 9
    s_add_u32 s69, s69, 0x80e00
    s_mul_i32 s58, s58, 108
    s_lshr_b32 s42, s2, 3
    s_lshl_b32 s42, s42, 2
    s_add_u32 s58, s58, s42
    s_add_u32 s58, s58, s40
    s_lshl_b32 s58, s58, 8
    buffer_load_dwordx4 v77, s[12:15], s43 offen offset:3072 lds
    s_add_u32 s58, s58, 0x40000
    s_cmp_lt_u32 s2, 216
    s_cselect_b32 s58, s58, 0x10000000
    s_mov_b32 s70, 0x10000000
    s_or_b32 s42, s2, s40
    s_cmp_eq_u32 s42, 0
    s_cselect_b32 s70, 0x1f000, s70
    s_mov_b32 s59, 0x07060302
    s_lshl_b32 s0, s50, 5
    s_add_u32 s0, s0, s51
    s_waitcnt vmcnt(14)
    ds_read_b128 a[80:83], v78 offset:4096
    ds_read_b128 a[84:87], v79 offset:4096
    ds_read_b128 a[88:91], v80 offset:4096
    ds_read_b128 a[92:95], v81 offset:4096
    s_lshl_b32 s0, s0, 2
    s_add_u32 s0, s0, s40
    s_lshl_b32 s1, s0, 7
    s_add_u32 s1, s1, 0x2f00000
    s_mul_i32 s0, s0, 5120
    s_add_u32 s0, s0, 0x2400000
    s_and_b32 s16, s2, 1
    s_lshl_b32 s16, s16, 3
    s_waitcnt lgkmcnt(4)
    s_add_u32 m0, s54, 0
    s_add_u32 s43, s52, 512
    buffer_load_dwordx4 v74, s[12:15], s43 offen offset:0 lds
    s_lshr_b32 s42, s2, 5
    s_add_u32 s16, s16, s42
    s_bfe_u32 s17, s2, 0x20001
    s_lshl_b32 s17, s17, 2
    s_bfe_u32 s42, s2, 0x20003
    s_add_u32 s17, s17, s42
    s_and_b32 s18, s17, 7
    s_lshr_b32 s42, s17, 3
    buffer_load_dwordx4 v75, s[12:15], s43 offen offset:1024 lds
    s_lshl_b32 s19, s16, 1
    s_add_u32 s19, s19, s42
    s_lshl_b32 s22, s18, 2
    s_add_u32 s22, s22, s40
    s_mul_i32 s22, s22, 25600
    s_add_u32 s22, s22, 0x1300000
    s_mul_i32 s24, s40, 25600
    s_mul_i32 s20, s17, 7
    buffer_load_dwordx4 v76, s[12:15], s43 offen offset:2048 lds
    s_add_u32 s20, s20, 1
    s_lshr_b32 s20, s20, 1
    s_mul_i32 s42, s17, 3
    s_add_u32 s42, s42, 6
    s_min_u32 s20, s20, s42
    s_lshl_b32 s20, s20, 1
    s_mul_i32 s21, s17, 286720
    s_add_u32 s21, s21, s44
    buffer_load_dwordx4 v77, s[12:15], s43 offen offset:3072 lds
    s_add_u32 s21, s21, 0x1700000
    s_mul_i32 s23, s18, 276480
    s_add_u32 s23, s23, 0x1400000
    s_mul_i32 s3, s19, 221184
    s_add_u32 s3, s3, 0x1c00000
    s_add_u32 s42, s40, 0
    s_mul_i32 s31, s42, 7
    s_add_u32 s31, s31, 1
    s_waitcnt vmcnt(9)
    ds_read_b128 a[96:99], v78 offset:8192
    ds_read_b128 a[100:103], v79 offset:8192
    ds_read_b128 a[104:107], v80 offset:8192
    ds_read_b128 a[108:111], v81 offset:8192
    s_lshr_b32 s31, s31, 1
    s_mul_i32 s49, s42, 3
    s_add_u32 s49, s49, 6
    s_min_u32 s31, s31, s49
    s_mul_i32 s25, s31, 5120
    s_add_u32 s25, s25, s23
    s_lshl_b32 s31, s31, 10
    s_add_u32 s31, s31, s3
    s_add_u32 s42, s40, 4
    s_waitcnt lgkmcnt(4)
    s_add_u32 m0, s54, 4096
    s_add_u32 s43, s53, 512
    buffer_load_dwordx4 v74, s[12:15], s43 offen offset:0 lds
    s_mul_i32 s32, s42, 7
    s_add_u32 s32, s32, 1
    s_lshr_b32 s32, s32, 1
    s_mul_i32 s49, s42, 3
    s_add_u32 s49, s49, 6
    s_min_u32 s32, s32, s49
    s_mul_i32 s26, s32, 5120
    s_add_u32 s26, s26, s23
    buffer_load_dwordx4 v75, s[12:15], s43 offen offset:1024 lds
    s_lshl_b32 s32, s32, 10
    s_add_u32 s32, s32, s3
    s_add_u32 s42, s40, 8
    s_mul_i32 s33, s42, 7
    s_add_u32 s33, s33, 1
    s_lshr_b32 s33, s33, 1
    s_mul_i32 s49, s42, 3
    s_add_u32 s49, s49, 6
    buffer_load_dwordx4 v76, s[12:15], s43 offen offset:2048 lds
    s_min_u32 s33, s33, s49
    s_mul_i32 s27, s33, 5120
    s_add_u32 s27, s27, s23
    s_lshl_b32 s33, s33, 10
    s_add_u32 s33, s33, s3
    s_add_u32 s42, s40, 12
    s_mul_i32 s36, s42, 7
    s_add_u32 s36, s36, 1
    buffer_load_dwordx4 v77, s[12:15], s43 offen offset:3072 lds
    s_lshr_b32 s36, s36, 1
    s_mul_i32 s49, s42, 3
    s_add_u32 s49, s49, 6
    s_min_u32 s36, s36, s49
    s_mul_i32 s28, s36, 5120
    s_add_u32 s28, s28, s23
    s_lshl_b32 s36, s36, 10
    s_add_u32 s36, s36, s3
    s_waitcnt vmcnt(8)
    ds_read_b128 a[112:115], v78 offset:12288
    ds_read_b128 a[116:119], v79 offset:12288
    ds_read_b128 a[120:123], v80 offset:12288
    ds_read_b128 a[124:127], v81 offset:12288
    s_mul_i32 s37, s40, 7
    s_add_u32 s37, s37, 3
    s_mul_i32 s29, s37, 5120
    s_add_u32 s29, s29, s23
    s_lshl_b32 s37, s37, 10
    s_add_u32 s37, s37, s3
    s_and_b32 s55, s40, 1
    s_mul_i32 s55, s55, 7
    s_waitcnt lgkmcnt(4)
    s_add_u32 m0, s54, 8192
    s_add_u32 s43, s52, 640
    buffer_load_dwordx4 v74, s[12:15], s43 offen offset:0 lds
    s_add_u32 s55, s55, 31
    s_mul_i32 s30, s55, 5120
    s_add_u32 s30, s30, s23
    s_lshl_b32 s55, s55, 10
    s_add_u32 s55, s55, s3
    s_lshl_b32 s71, s2, 2
    s_add_u32 s71, s71, s40
    s_lshl_b32 s71, s71, 7
    buffer_load_dwordx4 v75, s[12:15], s43 offen offset:1024 lds
    s_add_u32 s71, s71, 0xe0000
    s_mov_b32 s72, 0xe0000
    v_lshrrev_b32 v3, 3, v1
    v_add_u32 v3, s20, v3
    v_lshrrev_b32 v4, 2, v3
    v_lshlrev_b32 v4, 5, v4
    v_and_b32 v3, 3, v3
    v_add_u32 v4, v4, v3
    buffer_load_dwordx4 v76, s[12:15], s43 offen offset:2048 lds
    v_and_b32_e64 v3, 7, v1
    v_lshl_add_u32 v73, v3, 2, v4
    s_mul_i32 s42, s40, 40
    s_add_u32 s42, s42, s18
    s_add_u32 s42, s42, 608
    v_lshl_add_u32 v4, v1, 3, s42
    v_cndmask_b32 v73, v73, v4, s[56:57]
    v_lshlrev_b32_e64 v73, 7, v73
    buffer_load_dwordx4 v77, s[12:15], s43 offen offset:3072 lds
    s_nop 0
    s_mov_b64 exec, 0x3ff
    buffer_load_dword v8, v10, s[8:11], s84 offen offset:0 sc1
    s_mov_b64 exec, -1
    s_nop 0
    s_waitcnt vmcnt(9)
    ds_read_b128 a[128:131], v78 offset:0
    ds_read_b128 a[132:135], v79 offset:0
    ds_read_b128 a[136:139], v80 offset:0
    ds_read_b128 a[140:143], v81 offset:0
    s_waitcnt lgkmcnt(4)
    s_add_u32 m0, s54, 12288
    s_add_u32 s43, s53, 640
    buffer_load_dwordx4 v74, s[12:15], s43 offen offset:0 lds
    buffer_load_dwordx4 v75, s[12:15], s43 offen offset:1024 lds
    buffer_load_dwordx4 v76, s[12:15], s43 offen offset:2048 lds
    buffer_load_dwordx4 v77, s[12:15], s43 offen offset:3072 lds
    s_waitcnt vmcnt(4)
    v_cmp_ne_u32_e64 vcc, s45, v8
    s_nop 0
    s_and_b32 vcc_lo, vcc_lo, 0x3ff
    s_cbranch_scc1 Ls_A
Lr_A:
    s_add_u32 m0, s85, 0
    s_add_u32 s41, s83, 0
    buffer_load_dwordx4 v2, s[8:11], s41 offen offset:0 sc1 lds
    s_add_u32 m0, s85, 0
    s_nop 0
    buffer_load_dwordx4 v2, s[8:11], s41 offen offset:1024 sc1 lds
    s_add_u32 m0, s85, 8192
    s_add_u32 s41, s83, 8192
    buffer_load_dwordx4 v2, s[8:11], s41 offen offset:0 sc1 lds
    s_add_u32 m0, s85, 8192
    s_nop 0
    buffer_load_dwordx4 v2, s[8:11], s41 offen offset:1024 sc1 lds
    s_add_u32 m0, s85, 16384
    s_add_u32 s41, s83, 16384
    buffer_load_dwordx4 v2, s[8:11], s41 offen offset:0 sc1 lds
    s_add_u32 m0, s85, 16384
    s_nop 0
    buffer_load_dwordx4 v2, s[8:11], s41 offen offset:1024 sc1 lds
    s_add_u32 m0, s85, 24576
    s_add_u32 s41, s83, 24576
    buffer_load_dwordx4 v2, s[8:11], s41 offen offset:0 sc1 lds
    s_add_u32 m0, s85, 24576
    s_nop 0
    buffer_load_dwordx4 v2, s[8:11], s41 offen offset:1024 sc1 lds
    s_nop 0
    ds_read_b128 a[144:147], v78 offset:4096
    ds_read_b128 a[148:151], v79 offset:4096
    ds_read_b128 a[152:155], v80 offset:4096
    ds_read_b128 a[156:159], v81 offset:4096
    s_waitcnt lgkmcnt(4)
    s_add_u32 m0, s54, 0
    s_add_u32 s43, s52, 768
    buffer_load_dwordx4 v74, s[12:15], s43 offen offset:0 lds
    buffer_load_dwordx4 v75, s[12:15], s43 offen offset:1024 lds
    buffer_load_dwordx4 v76, s[12:15], s43 offen offset:2048 lds
    buffer_load_dwordx4 v77, s[12:15], s43 offen offset:3072 lds
    s_waitcnt vmcnt(10)
    s_barrier
    ds_read_b128 v[216:219], v2 offset:0
    ds_read_b128 v[220:223], v2 offset:1024
    ds_read_b128 v[224:227], v2 offset:2048
    ds_read_b128 v[228:231], v2 offset:3072
    v_lshlrev_b32 v10, 4, v0
    s_mov_b32 s84, 0x2f90000
    s_waitcnt lgkmcnt(2)
    v_mfma_f32_32x32x16_bf16 v[140:155], v[216:219], a[0:3], 0
    ds_read_b128 v[232:235], v2 offset:4096
    ds_read_b128 a[160:163], v78 offset:8192
    v_mfma_f32_32x32x16_bf16 v[156:171], v[220:223], a[0:3], 0
    ds_read_b128 v[236:239], v2 offset:5120
    s_mov_b32 exec_hi, 0xffffffff
    buffer_load_dword v8, v10, s[8:11], s84 offen offset:0 sc1
    s_mov_b64 exec, -1
    v_mfma_f32_32x32x16_bf16 v[184:199], v[216:219], a[16:19], 0
    ds_read_b128 a[164:167], v79 offset:8192
    ds_read_b128 a[168:171], v80 offset:8192
    s_mul_i32 s87, s40, 3584
    s_sub_u32 s94, 127488, s87
    s_add_u32 s87, s87, 102400
    v_add_u32_e64 v11, s87, v2
    v_mfma_f32_32x32x16_bf16 v[200:215], v[220:223], a[16:19], 0
    ds_read_b128 a[172:175], v81 offset:8192
    s_add_u32 m0, s54, 4096
    s_add_u32 s43, s53, 768
    buffer_load_dwordx4 v74, s[12:15], s43 offen offset:0 lds
    s_waitcnt lgkmcnt(6)
    v_mfma_f32_32x32x16_bf16 v[140:155], v[224:227], a[4:7], v[140:155]
    ds_read_b128 v[216:219], v2 offset:6144
    s_add_u32 m0, s54, 4096
    s_nop 0
    buffer_load_dwordx4 v75, s[12:15], s43 offen offset:1024 lds
    v_mfma_f32_32x32x16_bf16 v[156:171], v[228:231], a[4:7], v[156:171]
    ds_read_b128 v[220:223], v2 offset:7168
    v_add_u32 v28, s94, v2
    v_and_b32 v4, 31, v1
    v_mul_u32_u24_e64 v72, 48, v4
    v_add_u32 v72, 2048, v72
    v_mov_b32 v31, s87
    v_mfma_f32_32x32x16_bf16 v[184:199], v[224:227], a[20:23], v[184:199]
    s_add_u32 m0, s54, 4096
    s_nop 0
    buffer_load_dwordx4 v76, s[12:15], s43 offen offset:2048 lds
    v_mfma_f32_32x32x16_bf16 v[200:215], v[228:231], a[20:23], v[200:215]
    v_mov_b32 v33, s94
    v_cndmask_b32 v32, v31, v33, s[56:57]
    v_cndmask_b32 v34, v33, v31, s[56:57]
    v_lshl_add_u32 v31, v4, 4, v32
    v_lshl_add_u32 v33, v4, 4, v34
    s_waitcnt lgkmcnt(5)
    v_mfma_f32_32x32x16_bf16 v[140:155], v[232:235], a[8:11], v[140:155]
    s_waitcnt vmcnt(12)
    s_barrier
    ds_read_b128 v[224:227], v2 offset:8192
    v_add_u32_e64 v32, v32, v72
    v_add_u32_e64 v34, v34, v72
    v_add_u32 v45, 40, v72
    v_mfma_f32_32x32x16_bf16 v[156:171], v[236:239], a[8:11], v[156:171]
    ds_read_b128 v[228:231], v2 offset:9216
    s_cmp_lt_u32 s2, 216
    s_cbranch_scc0 L1_d
    ds_read_b64_tr_b16 a[192:193], v62 offset:0
    ds_read_b64_tr_b16 a[194:195], v62 offset:512
    ds_read_b64_tr_b16 a[196:197], v62 offset:2048
    ds_read_b64_tr_b16 a[198:199], v62 offset:2560
    ds_read_b64_tr_b16 a[200:201], v62 offset:4096
    ds_read_b64_tr_b16 a[202:203], v62 offset:4608
    ds_read_b64_tr_b16 a[204:205], v62 offset:6144
    ds_read_b64_tr_b16 a[206:207], v62 offset:6656
    ds_read_b64_tr_b16 a[208:209], v62 offset:8192
    ds_read_b64_tr_b16 a[210:211], v62 offset:8704
L1_e:
    v_mfma_f32_32x32x16_bf16 v[184:199], v[232:235], a[24:27], v[184:199]
    s_add_u32 m0, s54, 4096
    s_nop 0
    buffer_load_dwordx4 v77, s[12:15], s43 offen offset:3072 lds
    v_mfma_f32_32x32x16_bf16 v[200:215], v[236:239], a[24:27], v[200:215]
    ds_read_b64_tr_b16 a[212:213], v63 offset:20480
    ds_read_b64_tr_b16 a[214:215], v63 offset:23040
    v_add_u32 v30, 1024, v2
    v_cndmask_b32 v45, v45, v30, s[56:57]
    s_mul_i32 s48, s40, 14336
    s_waitcnt lgkmcnt(14)
    v_mfma_f32_32x32x16_bf16 v[140:155], v[216:219], a[12:15], v[140:155]
    ds_read_b128 v[232:235], v2 offset:10240
    ds_read_b128 a[176:179], v78 offset:12288
    s_add_u32 s48, s48, 102400
    v_add_u32_e64 v45, s48, v45
    s_lshr_b32 s48, s40, 1
    s_or_b32 s48, s48, s50
    v_mfma_f32_32x32x16_bf16 v[156:171], v[220:223], a[12:15], v[156:171]
    ds_read_b128 v[236:239], v2 offset:11264
    ds_read_b128 a[180:183], v79 offset:12288
    s_cmp_eq_u32 s48, 0
    s_cselect_b32 s48, 0xf149, 0
    v_mov_b32 v61, s48
    v_mov_b32 v60, 0x3f80
    v_mfma_f32_32x32x16_bf16 v[184:199], v[216:219], a[28:31], v[184:199]
    ds_read_b128 a[184:187], v80 offset:12288
    ds_read_b128 a[188:191], v81 offset:12288
    v_cndmask_b32 v60, v60, v61, s[56:57]
    v_mov_b32_e64 v61, 0
    v_lshrrev_b32_e64 v4, 5, v1
    v_lshl_add_u32 v72, v4, 4, v72
    v_mfma_f32_32x32x16_bf16 v[200:215], v[220:223], a[28:31], v[200:215]
    s_add_u32 m0, s54, 8192
    s_add_u32 s43, s52, 896
    buffer_load_dwordx4 v74, s[12:15], s43 offen offset:0 lds
    s_waitcnt lgkmcnt(15)
    v_mfma_f32_32x32x16_bf16 v[140:155], v[224:227], a[32:35], v[140:155]
    ds_read_b128 v[216:219], v2 offset:12288
    buffer_store_dwordx4 a[192:195], v2, s[8:11], s78 offen sc1
    s_add_u32 s78, s78, s82
    v_mfma_f32_32x32x16_bf16 v[156:171], v[228:231], a[32:35], v[156:171]
    ds_read_b128 v[220:223], v2 offset:13312
    s_add_u32 m0, s54, 8192
    s_nop 0
    buffer_load_dwordx4 v75, s[12:15], s43 offen offset:1024 lds
    v_mfma_f32_32x32x16_bf16 v[184:199], v[224:227], a[48:51], v[184:199]
    ds_read_b64_tr_b16 a[216:217], v63 offset:20488
    s_add_u32 m0, s54, 8192
    s_nop 0
    buffer_load_dwordx4 v76, s[12:15], s43 offen offset:2048 lds
    v_mfma_f32_32x32x16_bf16 v[200:215], v[228:231], a[48:51], v[200:215]
    ds_read_b64_tr_b16 a[218:219], v63 offset:23048
    ds_read_b64_tr_b16 a[220:221], v63 offset:20544
    v_add_u32_e64 v29, s87, v72
    v_add_u32 v30, s94, v72
    v_bfe_u32 v3, v1, 2, 2
    s_waitcnt lgkmcnt(8)
    v_mfma_f32_32x32x16_bf16 v[140:155], v[232:235], a[36:39], v[140:155]
    ds_read_b128 v[224:227], v2 offset:14336
    ds_read_b64_tr_b16 a[222:223], v63 offset:23104
    v_lshl_add_u32 v3, v4, 2, v3
    v_mul_u32_u24_e64 v72, 48, v3
    v_bfe_u32 v3, v1, 4, 1
    v_and_b32 v4, 3, v1
    v_mfma_f32_32x32x16_bf16 v[156:171], v[236:239], a[36:39], v[156:171]
    ds_read_b128 v[228:231], v2 offset:15360
    s_add_u32 m0, s54, 8192
    s_nop 0
    buffer_load_dwordx4 v77, s[12:15], s43 offen offset:3072 lds
    v_mfma_f32_32x32x16_bf16 v[184:199], v[232:235], a[52:55], v[184:199]
    ds_read_b64_tr_b16 a[224:225], v63 offset:20552
    ds_read_b64_tr_b16 a[226:227], v63 offset:23112
    s_waitcnt vmcnt(9)
    v_cmp_ne_u32_e64 vcc, s45, v8
    s_nop 0
    s_and_b32 vcc_hi, vcc_hi, 0xffffffff
    s_or_b32 vcc_lo, vcc_lo, vcc_hi
    s_cbranch_scc1 Ls_S
Lr_S:
    v_mfma_f32_32x32x16_bf16 v[200:215], v[236:239], a[52:55], v[200:215]
    buffer_store_dwordx4 a[196:199], v2, s[8:11], s78 offen sc1
    s_add_u32 s78, s78, s82
    s_waitcnt lgkmcnt(8)
    v_mfma_f32_32x32x16_bf16 v[140:155], v[216:219], a[40:43], v[140:155]
    s_barrier
    ds_read_b128 v[232:235], v2 offset:16384
    ds_read_b128 a[232:235], v78 offset:0
    v_lshl_add_u32 v3, v3, 2, v4
    v_lshlrev_b32_e64 v3, 2, v3
    v_mfma_f32_32x32x16_bf16 v[156:171], v[220:223], a[40:43], v[156:171]
    ds_read_b128 v[236:239], v2 offset:17408
    ds_read_b128 a[236:239], v79 offset:0
    s_mov_b32 s48, 0x55543120
    v_bfe_u32 v3, s48, v3, 4
    v_lshl_add_u32 v72, v3, 3, v72
    v_add_u32 v72, 2048, v72
    v_mfma_f32_32x32x16_bf16 v[184:199], v[216:219], a[56:59], v[184:199]
    s_add_u32 m0, s85, 0
    s_add_u32 s41, s83, 32768
    buffer_load_dwordx4 v2, s[8:11], s41 offen offset:0 sc1 lds
    v_mfma_f32_32x32x16_bf16 v[200:215], v[220:223], a[56:59], v[200:215]
    ds_read_b128 a[240:243], v80 offset:0
    v_add_u32 v39, s87, v72
    s_sub_u32 s48, s40, 1
    s_sub_u32 s49, 0, s40
    s_waitcnt lgkmcnt(7)
    v_mfma_f32_32x32x16_bf16 v[140:155], v[224:227], a[44:47], v[140:155]
    ds_read_b128 v[216:219], v2 offset:18432
    s_mov_b32 s84, 0
    buffer_load_dwordx4 v[88:91], v65, s[8:11], s84 offen sc1
    v_mfma_f32_32x32x16_bf16 v[156:171], v[228:231], a[44:47], v[156:171]
    ds_read_b128 v[220:223], v2 offset:19456
    ds_read_b128 a[244:247], v81 offset:0
    s_add_u32 m0, s54, 12288
    s_add_u32 s43, s53, 896
    buffer_load_dwordx4 v74, s[12:15], s43 offen offset:0 lds
    s_mov_b32 s84, 15360
    buffer_load_dwordx4 v[92:95], v65, s[8:11], s84 offen sc1
    v_mfma_f32_32x32x16_bf16 v[184:199], v[224:227], a[60:63], v[184:199]
    s_mov_b32 s84, 30720
    buffer_load_dwordx4 v[96:99], v65, s[8:11], s84 offen sc1
    v_mfma_f32_32x32x16_bf16 v[200:215], v[228:231], a[60:63], v[200:215]
    s_add_u32 m0, s85, 0
    s_nop 0
    buffer_load_dwordx4 v2, s[8:11], s41 offen offset:1024 sc1 lds
    s_waitcnt lgkmcnt(5)
    v_mfma_f32_32x32x16_bf16 v[140:155], v[232:235], a[64:67], v[140:155]
    ds_read_b128 v[224:227], v2 offset:20480
    s_add_u32 m0, s54, 12288
    s_nop 0
    buffer_load_dwordx4 v75, s[12:15], s43 offen offset:1024 lds
    s_mov_b32 s84, 46080
    buffer_load_dwordx4 v[100:103], v65, s[8:11], s84 offen sc1
    v_mfma_f32_32x32x16_bf16 v[156:171], v[236:239], a[64:67], v[156:171]
    ds_read_b128 v[228:231], v2 offset:21504
    buffer_load_dwordx2 v[110:111], v71, s[8:11], s68 offen sc1
    v_mfma_f32_32x32x16_bf16 v[184:199], v[232:235], a[80:83], v[184:199]
    s_add_u32 m0, s54, 12288
    s_nop 0
    buffer_load_dwordx4 v76, s[12:15], s43 offen offset:2048 lds
    v_mfma_f32_32x32x16_bf16 v[200:215], v[236:239], a[80:83], v[200:215]
    buffer_load_dwordx2 v[112:113], v71, s[8:11], s69 offen sc1
    buffer_store_dwordx4 a[200:203], v2, s[8:11], s78 offen sc1
    s_add_u32 s78, s78, s82
    s_waitcnt lgkmcnt(3)
    v_mfma_f32_32x32x16_bf16 v[140:155], v[216:219], a[68:71], v[140:155]
    ds_read_b128 v[232:235], v2 offset:22528
    s_mov_b64 exec, 1
    buffer_store_dword v6, v7, s[8:11], s70 offen
    s_mov_b64 exec, -1
    s_mov_b32 s84, 0x2fa0000
    v_mfma_f32_32x32x16_bf16 v[156:171], v[220:223], a[68:71], v[156:171]
    ds_read_b128 v[236:239], v2 offset:23552
    s_add_u32 m0, s54, 12288
    s_nop 0
    buffer_load_dwordx4 v77, s[12:15], s43 offen offset:3072 lds
    v_mfma_f32_32x32x16_bf16 v[184:199], v[216:219], a[84:87], v[184:199]
    s_waitcnt vmcnt(20)
    ds_read_b128 a[0:3], v78 offset:4096
    ds_read_b128 a[4:7], v79 offset:4096
    s_cmp_ge_u32 s40, 1
    s_cselect_b32 s48, s48, s49
    s_cselect_b64 s[88:89], -1, 0
    s_mul_i32 s48, s48, 3584
    v_mfma_f32_32x32x16_bf16 v[200:215], v[220:223], a[84:87], v[200:215]
    ds_read_b128 a[8:11], v80 offset:4096
    ds_read_b128 a[12:15], v81 offset:4096
    s_add_u32 s48, s48, 102400
    v_add_u32 v35, s48, v2
    v_add_u32_e64 v40, s48, v72
    s_waitcnt lgkmcnt(6)
    v_mfma_f32_32x32x16_bf16 v[140:155], v[224:227], a[72:75], v[140:155]
    s_barrier
    ds_read_b128 v[216:219], v2 offset:24576
    s_sub_u32 s48, s40, 2
    s_sub_u32 s49, 1, s40
    v_mfma_f32_32x32x16_bf16 v[156:171], v[228:231], a[72:75], v[156:171]
    ds_read_b128 v[220:223], v2 offset:25600
    s_add_u32 m0, s54, 0
    s_add_u32 s43, s52, 1024
    buffer_load_dwordx4 v74, s[12:15], s43 offen offset:0 lds
    v_mfma_f32_32x32x16_bf16 v[184:199], v[224:227], a[88:91], v[184:199]
    s_add_u32 m0, s85, 8192
    s_add_u32 s41, s83, 40960
    buffer_load_dwordx4 v2, s[8:11], s41 offen offset:0 sc1 lds
    v_mfma_f32_32x32x16_bf16 v[200:215], v[228:231], a[88:91], v[200:215]
    s_add_u32 m0, s54, 0
    s_nop 0
    buffer_load_dwordx4 v75, s[12:15], s43 offen offset:1024 lds
    s_waitcnt lgkmcnt(6)
    v_mfma_f32_32x32x16_bf16 v[140:155], v[232:235], a[76:79], v[140:155]
    ds_read_b128 v[224:227], v2 offset:26624
    buffer_store_dwordx4 a[204:207], v2, s[8:11], s78 offen sc1
    s_add_u32 s78, s78, s82
    v_mfma_f32_32x32x16_bf16 v[156:171], v[236:239], a[76:79], v[156:171]
    ds_read_b128 v[228:231], v2 offset:27648
    s_add_u32 m0, s85, 8192
    s_nop 0
    buffer_load_dwordx4 v2, s[8:11], s41 offen offset:1024 sc1 lds
    v_mfma_f32_32x32x16_bf16 v[184:199], v[232:235], a[92:95], v[184:199]
    s_add_u32 m0, s54, 0
    s_nop 0
    buffer_load_dwordx4 v76, s[12:15], s43 offen offset:2048 lds
    v_mfma_f32_32x32x16_bf16 v[200:215], v[236:239], a[92:95], v[200:215]
    ds_read_b64_tr_b16 a[228:229], v64 offset:20608
    s_add_u32 m0, s54, 0
    s_nop 0
    buffer_load_dwordx4 v77, s[12:15], s43 offen offset:3072 lds
    s_waitcnt lgkmcnt(3)
    v_mfma_f32_32x32x16_bf16 v[140:155], v[216:219], a[96:99], v[140:155]
    ds_read_b128 v[232:235], v2 offset:28672
    s_waitcnt vmcnt(22)
    ds_read_b128 a[16:19], v78 offset:8192
    s_cmp_ge_u32 s40, 2
    s_cselect_b32 s48, s48, s49
    s_cselect_b64 s[90:91], -1, 0
    s_mul_i32 s48, s48, 3584
    v_mfma_f32_32x32x16_bf16 v[156:171], v[220:223], a[96:99], v[156:171]
    ds_read_b128 v[236:239], v2 offset:29696
    ds_read_b128 a[20:23], v79 offset:8192
    s_add_u32 s48, s48, 102400
    v_add_u32 v36, s48, v2
    v_add_u32_e64 v41, s48, v72
    s_sub_u32 s48, s40, 3
    v_mfma_f32_32x32x16_bf16 v[184:199], v[216:219], a[112:115], v[184:199]
    ds_read_b128 a[24:27], v80 offset:8192
    ds_read_b64_tr_b16 a[230:231], v64 offset:23168
    s_sub_u32 s49, 2, s40
    s_cmp_ge_u32 s40, 3
    s_cselect_b32 s48, s48, s49
    s_cselect_b64 s[92:93], -1, 0
    v_mfma_f32_32x32x16_bf16 v[200:215], v[220:223], a[112:115], v[200:215]
    ds_read_b128 a[28:31], v81 offset:8192
    s_add_u32 m0, s54, 4096
    s_add_u32 s43, s53, 1024
    buffer_load_dwordx4 v74, s[12:15], s43 offen offset:0 lds
    s_waitcnt lgkmcnt(8)
    v_mfma_f32_32x32x16_bf16 v[140:155], v[224:227], a[100:103], v[140:155]
    ds_read_b128 v[216:219], v2 offset:30720
    buffer_store_dwordx4 a[208:211], v2, s[8:11], s78 offen sc1
    s_add_u32 s78, s78, s82
    v_mfma_f32_32x32x16_bf16 v[156:171], v[228:231], a[100:103], v[156:171]
    ds_read_b128 v[220:223], v2 offset:31744
    s_add_u32 m0, s54, 4096
    s_nop 0
    buffer_load_dwordx4 v75, s[12:15], s43 offen offset:1024 lds
    v_mfma_f32_32x32x16_bf16 v[184:199], v[224:227], a[116:119], v[184:199]
    s_add_u32 m0, s54, 4096
    s_nop 0
    buffer_load_dwordx4 v76, s[12:15], s43 offen offset:2048 lds
    v_mfma_f32_32x32x16_bf16 v[200:215], v[228:231], a[116:119], v[200:215]
    s_waitcnt vmcnt(21)
    v_add_f32 v88, v88, v92
    v_add_f32 v89, v89, v93
    v_add_f32 v90, v90, v94
    v_add_f32 v91, v91, v95
    s_waitcnt vmcnt(17)
    v_add_f32 v96, v96, v100
    s_waitcnt lgkmcnt(6)
    v_mfma_f32_32x32x16_bf16 v[140:155], v[232:235], a[104:107], v[140:155]
    s_barrier
    ds_read_b128 v[224:227], v2 offset:0
    v_add_f32 v97, v97, v101
    v_add_f32 v98, v98, v102
    v_add_f32 v99, v99, v103
    v_mfma_f32_32x32x16_bf16 v[156:171], v[236:239], a[104:107], v[156:171]
    ds_read_b128 v[228:231], v2 offset:1024
    s_add_u32 m0, s85, 16384
    s_add_u32 s41, s83, 49152
    buffer_load_dwordx4 v2, s[8:11], s41 offen offset:0 sc1 lds
    v_mfma_f32_32x32x16_bf16 v[184:199], v[232:235], a[120:123], v[184:199]
    s_add_u32 m0, s54, 4096
    s_nop 0
    buffer_load_dwordx4 v77, s[12:15], s43 offen offset:3072 lds
    v_mfma_f32_32x32x16_bf16 v[200:215], v[236:239], a[120:123], v[200:215]
    v_add_f32 v88, v88, v96
    v_add_f32 v89, v89, v97
    v_add_f32 v90, v90, v98
    v_add_f32 v91, v91, v99
    v_cvt_pk_bf16_f32 v92, v88, v89
    s_waitcnt lgkmcnt(2)
    v_mfma_f32_32x32x16_bf16 v[140:155], v[216:219], a[108:111], v[140:155]
    ds_read_b128 v[232:235], v2 offset:2048
    s_waitcnt vmcnt(13)
    ds_read_b128 a[32:35], v78 offset:12288
    v_cvt_pk_bf16_f32 v93, v90, v91
    v_lshlrev_b32 v88, 16, v92
    v_and_b32 v89, 0xffff0000, v92
    v_lshlrev_b32 v90, 16, v93
    v_mfma_f32_32x32x16_bf16 v[156:171], v[220:223], a[108:111], v[156:171]
    ds_read_b128 v[236:239], v2 offset:3072
    s_add_u32 m0, s85, 16384
    s_nop 0
    buffer_load_dwordx4 v2, s[8:11], s41 offen offset:1024 sc1 lds
    v_mfma_f32_32x32x16_bf16 v[184:199], v[216:219], a[124:127], v[184:199]
    ds_read_b128 a[36:39], v79 offset:12288
    ds_read_b128 a[40:43], v80 offset:12288
    v_and_b32 v91, 0xffff0000, v93
    v_add_f32 v88, v67, v88
    v_add_f32 v89, v67, v89
    v_add_f32 v90, v67, v90
    v_mfma_f32_32x32x16_bf16 v[200:215], v[220:223], a[124:127], v[200:215]
    buffer_store_dwordx4 a[212:215], v2, s[8:11], s79 offen offset:0 sc1
    ds_read_b128 a[44:47], v81 offset:12288
    s_waitcnt lgkmcnt(6)
    v_mfma_f32_32x32x16_bf16 v[140:155], v[224:227], a[128:131], v[140:155]
    ds_read_b128 v[216:219], v2 offset:4096
    s_add_u32 m0, s54, 8192
    s_add_u32 s43, s52, 1152
    buffer_load_dwordx4 v74, s[12:15], s43 offen offset:0 lds
    v_mfma_f32_32x32x16_bf16 v[156:171], v[228:231], a[128:131], v[156:171]
    ds_read_b128 v[220:223], v2 offset:5120
    s_add_u32 m0, s54, 8192
    s_nop 0
    buffer_load_dwordx4 v75, s[12:15], s43 offen offset:1024 lds
    v_add_f32 v91, v67, v91
    v_cvt_pk_bf16_f32 v92, v88, v89
    v_cvt_pk_bf16_f32 v93, v90, v91
    v_mfma_f32_32x32x16_bf16 v[184:199], v[224:227], a[144:147], v[184:199]
    s_add_u32 m0, s54, 8192
    s_nop 0
    buffer_load_dwordx4 v76, s[12:15], s43 offen offset:2048 lds
    v_lshlrev_b32 v88, 16, v92
    v_and_b32 v89, 0xffff0000, v92
    v_mfma_f32_32x32x16_bf16 v[200:215], v[228:231], a[144:147], v[200:215]
    v_lshlrev_b32_e64 v90, 16, v93
    v_and_b32 v91, 0xffff0000, v93
    s_mul_i32 s48, s48, 3584
    s_add_u32 s48, s48, 102400
    v_add_u32 v37, s48, v2
    s_waitcnt lgkmcnt(5)
    v_mfma_f32_32x32x16_bf16 v[140:155], v[232:235], a[132:135], v[140:155]
    ds_read_b128 v[224:227], v2 offset:6144
    ds_write_b128 v66, v[88:91]
    ds_write_b64 v68, v[92:93]
    v_add_u32 v42, s48, v72
    s_sub_u32 s48, s94, 28672
    v_add_u32 v38, s48, v2
    v_mfma_f32_32x32x16_bf16 v[156:171], v[236:239], a[132:135], v[156:171]
    ds_read_b128 v[228:231], v2 offset:7168
    s_add_u32 m0, s54, 8192
    s_nop 0
    buffer_load_dwordx4 v77, s[12:15], s43 offen offset:3072 lds
    v_mfma_f32_32x32x16_bf16 v[184:199], v[232:235], a[148:151], v[184:199]
    buffer_load_dwordx2 v[120:121], v69, s[8:11], s86 offen offset:0 sc1
    v_add_u32 v43, s48, v72
    v_and_b32 v3, 31, v1
    v_mfma_f32_32x32x16_bf16 v[200:215], v[236:239], a[148:151], v[200:215]
    v_lshrrev_b32 v4, 5, v1
    v_lshlrev_b32 v4, 2, v4
    v_sub_u32 v3, v3, v4
    v_mov_b32 v44, 0xf149f2ca
    v_subrev_u32 v12, 0, v3
    s_waitcnt lgkmcnt(4)
    v_mfma_f32_32x32x16_bf16 v[140:155], v[216:219], a[136:139], v[140:155]
    s_waitcnt vmcnt(15)
    s_waitcnt lgkmcnt(1)
    s_barrier
    ds_read_b128 v[232:235], v2 offset:8192
    s_waitcnt vmcnt(13)
    ds_read_b128 a[48:51], v78 offset:0
    v_subrev_u32 v13, 1, v3
    v_subrev_u32 v14, 2, v3
    v_mfma_f32_32x32x16_bf16 v[156:171], v[220:223], a[136:139], v[156:171]
    ds_read_b128 v[236:239], v2 offset:9216
    ds_read_b128 v[240:243], v70 offset:0
    v_rsq_f32 v172, v111
    v_and_b32 v114, 0xffff0000, v110
    v_sub_f32 v115, v110, v114
    v_mfma_f32_32x32x16_bf16 v[184:199], v[216:219], a[152:155], v[184:199]
    ds_read_b128 a[52:55], v79 offset:0
    ds_read_b128 v[244:247], v70 offset:32
    v_mul_f32_e64 v111, v111, v172
    v_mul_f32 v173, 0x3ea52b5c, v172
    v_and_b32 v116, 0xffff0000, v111
    v_subrev_u32 v15, 3, v3
    v_mfma_f32_32x32x16_bf16 v[200:215], v[220:223], a[152:155], v[200:215]
    s_add_u32 m0, s85, 24576
    s_add_u32 s41, s83, 57344
    buffer_load_dwordx4 v2, s[8:11], s41 offen offset:0 sc1 lds
    s_waitcnt lgkmcnt(6)
    v_mfma_f32_32x32x16_bf16 v[140:155], v[224:227], a[140:143], v[140:155]
    ds_read_b128 v[216:219], v2 offset:10240
    ds_read_b128 a[56:59], v80 offset:0
    ds_read_b128 v[248:251], v70 offset:64
    v_subrev_u32_e64 v16, 8, v3
    v_subrev_u32_e64 v17, 9, v3
    v_sub_f32_e64 v117, v111, v116
    v_mfma_f32_32x32x16_bf16 v[156:171], v[228:231], a[140:143], v[156:171]
    ds_read_b128 v[220:223], v2 offset:11264
    buffer_load_dwordx2 v[122:123], v69, s[8:11], s86 offen offset:2048 sc1
    ds_read_b128 a[60:63], v81 offset:0
    s_add_u32 m0, s54, 12288
    s_add_u32 s43, s53, 1152
    buffer_load_dwordx4 v74, s[12:15], s43 offen offset:0 lds
    ds_read_b128 a[248:251], v70 offset:96
    buffer_store_dwordx4 a[216:219], v2, s[8:11], s79 offen offset:1024 sc1
    v_mfma_f32_32x32x16_bf16 v[184:199], v[224:227], a[156:159], v[184:199]
    ds_read_b128 a[252:255], v70 offset:128
    s_add_u32 m0, s85, 24576
    s_nop 0
    buffer_load_dwordx4 v2, s[8:11], s41 offen offset:1024 sc1 lds
    v_mfma_f32_32x32x16_bf16 v[200:215], v[228:231], a[156:159], v[200:215]
    s_add_u32 s86, s86, 4096
    buffer_load_dwordx2 v[124:125], v69, s[8:11], s86 offen offset:0 sc1
    s_waitcnt lgkmcnt(10)
    v_mfma_f32_32x32x16_bf16 v[140:155], v[232:235], a[160:163], v[140:155]
    ds_read_b128 v[224:227], v2 offset:12288
    s_add_u32 m0, s54, 12288
    s_nop 0
    buffer_load_dwordx4 v75, s[12:15], s43 offen offset:1024 lds
    v_mfma_f32_32x32x16_bf16 v[156:171], v[236:239], a[160:163], v[156:171]
    ds_read_b128 v[228:231], v2 offset:13312
    s_waitcnt vmcnt(18)
    s_mov_b32 exec_hi, 0
    buffer_store_dword v6, v7, s[8:11], s71 offen offset:0 sc1
    s_mov_b64 exec, -1
    v_mfma_f32_32x32x16_bf16 v[184:199], v[232:235], a[176:179], v[184:199]
    buffer_load_dwordx2 v[126:127], v69, s[8:11], s86 offen offset:2048 sc1
    v_subrev_u32 v18, 10, v3
    v_subrev_u32_e64 v19, 11, v3
    s_waitcnt lgkmcnt(11)
    v_mfma_f32_32x32x16_bf16 v[88:103], v[240:243], a[192:195], 0
    s_add_u32 m0, s54, 12288
    s_nop 0
    buffer_load_dwordx4 v76, s[12:15], s43 offen offset:2048 lds
    s_waitcnt lgkmcnt(9)
    v_mfma_f32_32x32x16_bf16 v[88:103], v[244:247], a[196:199], v[88:103]
    s_add_u32 s86, s86, 4096
    buffer_load_dwordx2 v[128:129], v69, s[8:11], s86 offen offset:0 sc1
    v_subrev_u32 v20, 16, v3
    s_waitcnt lgkmcnt(6)
    v_mfma_f32_32x32x16_bf16 v[88:103], v[248:251], a[200:203], v[88:103]
    s_add_u32 m0, s54, 12288
    s_nop 0
    buffer_load_dwordx4 v77, s[12:15], s43 offen offset:3072 lds
    s_waitcnt lgkmcnt(3)
    v_mfma_f32_32x32x16_bf16 v[88:103], a[248:251], a[204:207], v[88:103]
    v_perm_b32 v48, v115, v114, s59
    v_subrev_u32 v21, 17, v3
    v_subrev_u32 v22, 18, v3
    v_subrev_u32 v23, 19, v3
    v_subrev_u32_e64 v24, 24, v3
    v_perm_b32 v49, v116, v114, s59
    s_waitcnt lgkmcnt(2)
    v_mfma_f32_32x32x16_bf16 v[88:103], a[252:255], a[208:211], v[88:103]
    v_subrev_u32 v25, 25, v3
    v_subrev_u32 v26, 26, v3
    v_subrev_u32 v27, 27, v3
    v_perm_b32 v50, v116, v117, s59
    v_ashrrev_i32 v12, 31, v12
    v_and_b32 v12, v44, v12
    v_mfma_f32_32x32x16_bf16 v[200:215], v[236:239], a[176:179], v[200:215]
    v_ashrrev_i32 v13, 31, v13
    v_and_b32 v13, v44, v13
    v_mov_b32 v51, v48
    v_ashrrev_i32 v14, 31, v14
    v_and_b32 v14, v44, v14
    v_mfma_f32_32x32x16_bf16 v[140:155], v[216:219], a[164:167], v[140:155]
    ds_read_b128 v[232:235], v2 offset:14336
    s_waitcnt vmcnt(19)
    ds_read_b128 a[64:67], v78 offset:4096
    v_ashrrev_i32 v15, 31, v15
    v_rsq_f32 v174, v113
    v_and_b32 v15, v44, v15
    v_mfma_f32_32x32x16_bf16 v[156:171], v[220:223], a[164:167], v[156:171]
    ds_read_b128 v[236:239], v2 offset:15360
    ds_read_b128 a[68:71], v79 offset:4096
    v_ashrrev_i32 v16, 31, v16
    v_and_b32 v16, v44, v16
    v_and_b32 v114, 0xffff0000, v112
    v_ashrrev_i32_e64 v17, 31, v17
    v_mfma_f32_32x32x16_bf16 v[184:199], v[216:219], a[180:183], v[184:199]
    ds_read_b128 a[72:75], v80 offset:4096
    buffer_load_dwordx2 v[130:131], v69, s[8:11], s86 offen offset:2048 sc1
    v_and_b32_e64 v17, v44, v17
    v_mfma_f32_32x32x16_bf16 v[200:215], v[220:223], a[180:183], v[200:215]
    ds_read_b128 a[76:79], v81 offset:4096
    buffer_store_dwordx4 a[220:223], v2, s[8:11], s79 offen offset:2048 sc1
    s_waitcnt lgkmcnt(6)
    v_mfma_f32_32x32x16_bf16 v[140:155], v[224:227], a[168:171], v[140:155]
    s_waitcnt vmcnt(20)
    s_barrier
    ds_read_b128 v[216:219], v2 offset:16384
    v_ashrrev_i32 v18, 31, v18
    v_and_b32 v18, v44, v18
    v_sub_f32 v115, v112, v114
    v_mfma_f32_32x32x16_bf16 v[156:171], v[228:231], a[168:171], v[156:171]
    ds_read_b128 v[220:223], v2 offset:17408
    s_add_u32 s86, s86, 4096
    buffer_load_dwordx2 v[132:133], v69, s[8:11], s86 offen offset:0 sc1
    v_mfma_f32_32x32x16_bf16 v[184:199], v[224:227], a[184:187], v[184:199]
    s_add_u32 m0, s85, 0
    s_add_u32 s41, s83, 65536
    buffer_load_dwordx4 v2, s[8:11], s41 offen offset:0 sc1 lds
    v_mfma_f32_32x32x16_bf16 v[200:215], v[228:231], a[184:187], v[200:215]
    buffer_load_dwordx2 v[134:135], v69, s[8:11], s86 offen offset:2048 sc1
    v_ashrrev_i32 v19, 31, v19
    s_waitcnt lgkmcnt(5)
    v_mfma_f32_32x32x16_bf16 v[140:155], v[232:235], a[172:175], v[140:155]
    ds_read_b128 v[224:227], v2 offset:18432
    s_mov_b32 exec_hi, 0
    buffer_store_dwordx2 v[88:89], v69, s[8:11], s58 offen sc1
    s_mov_b32 exec_hi, -1
    v_mfma_f32_32x32x16_bf16 v[156:171], v[236:239], a[172:175], v[156:171]
    ds_read_b128 v[228:231], v2 offset:19456
    s_add_u32 m0, s85, 0
    s_nop 0
    buffer_load_dwordx4 v2, s[8:11], s41 offen offset:1024 sc1 lds
    v_mfma_f32_32x32x16_bf16 v[184:199], v[232:235], a[188:191], v[184:199]
    s_waitcnt vmcnt(20)
    ds_read_b128 a[80:83], v78 offset:8192
    ds_read_b128 a[84:87], v79 offset:8192
    v_and_b32 v19, v44, v19
    v_ashrrev_i32 v20, 31, v20
    v_mul_f32 v113, v113, v174
    v_and_b32 v20, v44, v20
    v_mfma_f32_32x32x16_bf16 v[200:215], v[236:239], a[188:191], v[200:215]
    ds_read_b128 a[88:91], v80 offset:8192
    v_ashrrev_i32 v21, 31, v21
    v_and_b32 v21, v44, v21
    v_ashrrev_i32 v22, 31, v22
    v_mul_f32 v175, 0x3ea52b5c, v174
    s_waitcnt lgkmcnt(5)
    v_mfma_f32_32x32x16_bf16 v[140:155], v[216:219], a[232:235], v[140:155]
    ds_read_b128 v[232:235], v2 offset:20480
    s_add_u32 s86, s86, 4096
    buffer_load_dwordx2 v[136:137], v69, s[8:11], s86 offen offset:0 sc1
    v_mfma_f32_32x32x16_bf16 v[156:171], v[220:223], a[232:235], v[156:171]
    ds_read_b128 v[236:239], v2 offset:21504
    ds_read_b128 a[92:95], v81 offset:8192
    v_and_b32 v22, v44, v22
    v_ashrrev_i32 v23, 31, v23
    v_and_b32 v23, v44, v23
    v_and_b32 v116, 0xffff0000, v113
    v_mfma_f32_32x32x16_bf16 v[184:199], v[216:219], a[0:3], v[184:199]
    buffer_load_dwordx2 v[138:139], v69, s[8:11], s86 offen offset:2048 sc1
    v_ashrrev_i32 v24, 31, v24
    v_and_b32 v24, v44, v24
    v_mfma_f32_32x32x16_bf16 v[200:215], v[220:223], a[0:3], v[200:215]
    buffer_store_dwordx4 a[224:227], v2, s[8:11], s79 offen offset:3072 sc1
    v_ashrrev_i32_e64 v25, 31, v25
    s_waitcnt lgkmcnt(6)
    v_mfma_f32_32x32x16_bf16 v[140:155], v[224:227], a[236:239], v[140:155]
    ds_read_b128 v[216:219], v2 offset:22528
    v_sub_f32 v117, v113, v116
    v_and_b32 v25, v44, v25
    v_ashrrev_i32 v26, 31, v26
    v_and_b32 v26, v44, v26
    v_ashrrev_i32_e64 v27, 31, v27
    v_mfma_f32_32x32x16_bf16 v[156:171], v[228:231], a[236:239], v[156:171]
    ds_read_b128 v[220:223], v2 offset:23552
    v_perm_b32 v54, v115, v114, s59
    v_and_b32_e64 v27, v44, v27
    v_mov_b32 v4, 0xbf80bf80
    v_cndmask_b32 v46, v4, 0, s[56:57]
    v_perm_b32 v55, v116, v114, s59
    v_mfma_f32_32x32x16_bf16 v[184:199], v[224:227], a[4:7], v[184:199]
    v_mov_b32 v4, 0xbf80
    v_cndmask_b32 v47, v4, 0, s[56:57]
    v_perm_b32 v56, v116, v117, s59
    v_mov_b32 v57, v54
    v_mfma_f32_32x32x16_bf16 v[200:215], v[228:231], a[4:7], v[200:215]
    s_waitcnt lgkmcnt(3)
    v_mfma_f32_32x32x16_bf16 v[140:155], v[232:235], a[240:243], v[140:155]
    s_waitcnt vmcnt(17)
    s_barrier
    ds_read_b128 v[224:227], v2 offset:24576
    v_mfma_f32_32x32x16_bf16 v[156:171], v[236:239], a[240:243], v[156:171]
    ds_read_b128 v[228:231], v2 offset:25600
    s_waitcnt vmcnt(10)
    ds_read_b128 a[96:99], v78 offset:12288
    v_mfma_f32_32x32x16_bf16 v[184:199], v[232:235], a[8:11], v[184:199]
    s_add_u32 m0, s85, 8192
    s_add_u32 s41, s83, 73728
    buffer_load_dwordx4 v2, s[8:11], s41 offen offset:0 sc1 lds
    v_mfma_f32_32x32x16_bf16 v[200:215], v[236:239], a[8:11], v[200:215]
    ds_read_b128 a[100:103], v79 offset:12288
    ds_read_b128 a[104:107], v80 offset:12288
    s_waitcnt lgkmcnt(5)
    v_mfma_f32_32x32x16_bf16 v[140:155], v[216:219], a[244:247], v[140:155]
    ds_read_b128 v[232:235], v2 offset:26624
    ds_read_b128 a[108:111], v81 offset:12288
    v_mfma_f32_32x32x16_bf16 v[156:171], v[220:223], a[244:247], v[156:171]
    ds_read_b128 v[236:239], v2 offset:27648
    s_add_u32 m0, s85, 8192
    s_nop 0
    buffer_load_dwordx4 v2, s[8:11], s41 offen offset:1024 sc1 lds
    v_mfma_f32_32x32x16_bf16 v[184:199], v[216:219], a[12:15], v[184:199]
    v_mfma_f32_32x32x16_bf16 v[200:215], v[220:223], a[12:15], v[200:215]
    s_waitcnt lgkmcnt(6)
    v_mfma_f32_32x32x16_bf16 v[140:155], v[224:227], a[16:19], v[140:155]
    ds_read_b128 v[216:219], v2 offset:28672
    buffer_store_dwordx4 a[228:231], v5, s[8:11], s79 offen offset:0 sc1
    v_mfma_f32_32x32x16_bf16 v[156:171], v[228:231], a[16:19], v[156:171]
    ds_read_b128 v[220:223], v2 offset:29696
    v_mfma_f32_32x32x16_bf16 v[184:199], v[224:227], a[32:35], v[184:199]
    v_mfma_f32_32x32x16_bf16 v[200:215], v[228:231], a[32:35], v[200:215]
    s_waitcnt lgkmcnt(2)
    v_mfma_f32_32x32x16_bf16 v[140:155], v[232:235], a[20:23], v[140:155]
    ds_read_b128 v[224:227], v2 offset:30720
    v_mfma_f32_32x32x16_bf16 v[156:171], v[236:239], a[20:23], v[156:171]
    ds_read_b128 v[228:231], v2 offset:31744
    v_mfma_f32_32x32x16_bf16 v[184:199], v[232:235], a[36:39], v[184:199]
    v_mfma_f32_32x32x16_bf16 v[200:215], v[236:239], a[36:39], v[200:215]
    s_waitcnt lgkmcnt(2)
    v_mfma_f32_32x32x16_bf16 v[140:155], v[216:219], a[24:27], v[140:155]
    s_waitcnt vmcnt(6)
    s_barrier
    ds_read_b128 v[232:235], v2 offset:0
    v_mfma_f32_32x32x16_bf16 v[156:171], v[220:223], a[24:27], v[156:171]
    ds_read_b128 v[236:239], v2 offset:1024
    v_mfma_f32_32x32x16_bf16 v[184:199], v[216:219], a[40:43], v[184:199]
    v_add_f32 v120, v120, v130
    v_add_f32 v121, v121, v131
    v_add_f32 v122, v122, v132
    v_add_f32 v123, v123, v133
    v_add_f32 v124, v124, v134
    v_add_f32 v125, v125, v135
    v_mfma_f32_32x32x16_bf16 v[200:215], v[220:223], a[40:43], v[200:215]
    s_waitcnt vmcnt(5)
    v_add_f32 v126, v126, v136
    v_add_f32 v127, v127, v137
    s_waitcnt vmcnt(4)
    v_add_f32 v128, v128, v138
    v_add_f32 v129, v129, v139
    v_add_f32 v120, v120, v124
    s_waitcnt lgkmcnt(2)
    v_mfma_f32_32x32x16_bf16 v[140:155], v[224:227], a[28:31], v[140:155]
    ds_read_b128 v[216:219], v2 offset:2048
    v_add_f32_e64 v121, v121, v125
    v_add_f32_e64 v122, v122, v126
    v_add_f32_e64 v123, v123, v127
    v_add_f32_e64 v120, v120, v122
    v_add_f32_e64 v121, v121, v123
    v_mfma_f32_32x32x16_bf16 v[156:171], v[228:231], a[28:31], v[156:171]
    ds_read_b128 v[220:223], v2 offset:3072
    v_add_f32_e64 v120, v120, v128
    v_add_f32_e64 v121, v121, v129
    v_lshlrev_b32_e64 v118, 3, v0
    v_mfma_f32_32x32x16_bf16 v[184:199], v[224:227], a[44:47], v[184:199]
    ds_write_b64 v118, v[120:121] offset:32768
    v_mfma_f32_32x32x16_bf16 v[200:215], v[228:231], a[44:47], v[200:215]
    s_waitcnt lgkmcnt(3)
    v_mfma_f32_32x32x16_bf16 v[140:155], v[232:235], a[48:51], v[140:155]
    ds_read_b128 v[224:227], v2 offset:4096
    v_mfma_f32_32x32x16_bf16 v[156:171], v[236:239], a[48:51], v[156:171]
    ds_read_b128 v[228:231], v2 offset:5120
    v_mfma_f32_32x32x16_bf16 v[184:199], v[232:235], a[64:67], v[184:199]
    v_mfma_f32_32x32x16_bf16 v[200:215], v[236:239], a[64:67], v[200:215]
    s_waitcnt lgkmcnt(3)
    v_mfma_f32_32x32x16_bf16 v[140:155], v[216:219], a[52:55], v[140:155]
    ds_read_b128 v[232:235], v2 offset:6144
    v_mfma_f32_32x32x16_bf16 v[156:171], v[220:223], a[52:55], v[156:171]
    ds_read_b128 v[236:239], v2 offset:7168
    v_mfma_f32_32x32x16_bf16 v[184:199], v[216:219], a[68:71], v[184:199]
    v_mfma_f32_32x32x16_bf16 v[200:215], v[220:223], a[68:71], v[200:215]
    s_waitcnt lgkmcnt(2)
    v_mfma_f32_32x32x16_bf16 v[140:155], v[224:227], a[56:59], v[140:155]
    s_waitcnt vmcnt(0)
    s_barrier
    ds_read_b128 v[216:219], v2 offset:8192
    v_mfma_f32_32x32x16_bf16 v[156:171], v[228:231], a[56:59], v[156:171]
    ds_read_b128 v[220:223], v2 offset:9216
    ds_read_b64 v[120:121], v69 offset:32768
    v_mfma_f32_32x32x16_bf16 v[184:199], v[224:227], a[72:75], v[184:199]
    ds_write_b64 v45, v[60:61] offset:0
    s_lshl_b32 s47, s2, 4
    s_add_u32 s47, s47, 0x2fa0000
    s_cmp_eq_u32 s40, 0
    s_cselect_b32 s47, s47, 0x10000000
    s_mov_b64 exec, 0xf
    buffer_store_dword v6, v7, s[8:11], s47 offen sc1
    s_mov_b64 exec, -1
    ds_read_b64 v[122:123], v69 offset:33280
    v_mfma_f32_32x32x16_bf16 v[200:215], v[228:231], a[72:75], v[200:215]
    ds_read_b64 v[124:125], v69 offset:33792
    ds_write_b64 v45, v[60:61] offset:3584
    s_waitcnt lgkmcnt(7)
    v_mfma_f32_32x32x16_bf16 v[140:155], v[232:235], a[60:63], v[140:155]
    ds_read_b128 v[224:227], v2 offset:10240
    ds_read_b64 v[126:127], v69 offset:34304
    v_mfma_f32_32x32x16_bf16 v[156:171], v[236:239], a[60:63], v[156:171]
    ds_read_b128 v[228:231], v2 offset:11264
    ds_write_b64 v45, v[60:61] offset:7168
    v_mfma_f32_32x32x16_bf16 v[184:199], v[232:235], a[76:79], v[184:199]
    ds_write_b64 v45, v[60:61] offset:10752
    v_mfma_f32_32x32x16_bf16 v[200:215], v[236:239], a[76:79], v[200:215]
    s_waitcnt lgkmcnt(10)
    v_mfma_f32_32x32x16_bf16 v[140:155], v[216:219], a[80:83], v[140:155]
    ds_read_b128 v[232:235], v2 offset:12288
    s_waitcnt lgkmcnt(7)
    v_add_f32 v120, v120, v124
    v_add_f32 v121, v121, v125
    s_waitcnt lgkmcnt(4)
    v_add_f32 v122, v122, v126
    v_add_f32 v123, v123, v127
    v_add_f32 v120, v120, v122
    v_mfma_f32_32x32x16_bf16 v[156:171], v[220:223], a[80:83], v[156:171]
    ds_read_b128 v[236:239], v2 offset:13312
    v_add_f32 v121, v121, v123
    v_and_b32 v114, 0xffff0000, v120
    v_sub_f32 v115, v120, v114
    v_and_b32 v116, 0xffff0000, v121
    v_sub_f32_e64 v117, v121, v116
    v_mfma_f32_32x32x16_bf16 v[184:199], v[216:219], a[96:99], v[184:199]
    v_perm_b32 v124, v114, v114, s59
    v_perm_b32 v125, v116, v115, s59
    v_perm_b32 v126, v117, v116, s59
    v_and_b32 v128, 0xffff0000, v115
    v_sub_f32_e64 v128, v115, v128
    v_perm_b32 v127, v115, v128, s59
    v_mfma_f32_32x32x16_bf16 v[200:215], v[220:223], a[96:99], v[200:215]
    v_cndmask_b32 v96, v124, 0, s[56:57]
    v_cndmask_b32 v100, 0, v124, s[56:57]
    v_cndmask_b32 v97, v125, 0, s[56:57]
    v_cndmask_b32 v101, 0, v125, s[56:57]
    v_cndmask_b32 v98, v126, 0, s[56:57]
    s_waitcnt lgkmcnt(4)
    v_mfma_f32_32x32x16_bf16 v[140:155], v[224:227], a[84:87], v[140:155]
    ds_read_b128 v[216:219], v2 offset:14336
    v_cndmask_b32 v102, 0, v126, s[56:57]
    v_cndmask_b32 v99, v127, 0, s[56:57]
    v_cndmask_b32 v103, 0, v127, s[56:57]
    v_mfma_f32_32x32x16_bf16 v[156:171], v[228:231], a[84:87], v[156:171]
    ds_read_b128 v[220:223], v2 offset:15360
    v_mfma_f32_32x32x16_bf16 v[184:199], v[224:227], a[100:103], v[184:199]
    s_mov_b32 exec_hi, 0x1f
    buffer_load_dword v8, v73, s[8:11], s72 offen offset:0 sc1
    s_mov_b64 exec, -1
    v_mfma_f32_32x32x16_bf16 v[200:215], v[228:231], a[100:103], v[200:215]
    s_waitcnt lgkmcnt(2)
    v_mfma_f32_32x32x16_bf16 v[140:155], v[232:235], a[88:91], v[140:155]
    v_mfma_f32_32x32x16_bf16 v[156:171], v[236:239], a[88:91], v[156:171]
    v_mfma_f32_32x32x16_bf16 v[184:199], v[232:235], a[104:107], v[184:199]
    v_mfma_f32_32x32x16_bf16 v[200:215], v[236:239], a[104:107], v[200:215]
    s_waitcnt lgkmcnt(0)
    v_mfma_f32_32x32x16_bf16 v[140:155], v[216:219], a[92:95], v[140:155]
    v_mfma_f32_32x32x16_bf16 v[156:171], v[220:223], a[92:95], v[156:171]
    v_mfma_f32_32x32x16_bf16 v[184:199], v[216:219], a[108:111], v[184:199]
    v_mfma_f32_32x32x16_bf16 v[200:215], v[220:223], a[108:111], v[200:215]
    v_mfma_f32_32x32x16_bf16 v[156:171], v[100:103], v[48:51], v[156:171]
    v_mfma_f32_32x32x16_bf16 v[140:155], v[96:99], v[48:51], v[140:155]
    v_mfma_f32_32x32x16_bf16 v[200:215], v[100:103], v[54:57], v[200:215]
    v_mfma_f32_32x32x16_bf16 v[184:199], v[96:99], v[54:57], v[184:199]
    s_nop 9
    v_pk_mul_f32 v[152:153], v[152:153], v[172:173] op_sel_hi:[1,0]
    v_pk_mul_f32 v[154:155], v[154:155], v[172:173] op_sel_hi:[1,0]
    v_pk_mul_f32 v[156:157], v[156:157], v[172:173] op_sel_hi:[1,0]
    v_pk_mul_f32 v[158:159], v[158:159], v[172:173] op_sel_hi:[1,0]
    v_cvt_pk_bf16_f32 v74, v152, v153
    v_cvt_pk_bf16_f32 v75, v154, v155
    v_cvt_pk_bf16_f32 v76, v156, v157
    v_cvt_pk_bf16_f32 v77, v158, v159
    buffer_store_dwordx4 v[74:77], v2, s[8:11], s0 offen offset:0 sc1
    v_pk_mul_f32 v[164:165], v[164:165], v[172:173] op_sel_hi:[1,0]
    v_pk_mul_f32 v[166:167], v[166:167], v[172:173] op_sel_hi:[1,0]
    v_pk_mul_f32 v[168:169], v[168:169], v[172:173] op_sel_hi:[1,0]
    v_pk_mul_f32 v[170:171], v[170:171], v[172:173] op_sel_hi:[1,0]
    v_cvt_pk_bf16_f32 v78, v164, v165
    v_cvt_pk_bf16_f32 v79, v166, v167
    v_cvt_pk_bf16_f32 v80, v168, v169
    v_cvt_pk_bf16_f32 v81, v170, v171
    buffer_store_dwordx4 v[78:81], v2, s[8:11], s0 offen offset:1024 sc1
    v_pk_mul_f32 v[196:197], v[196:197], v[174:175] op_sel_hi:[1,0]
    v_pk_mul_f32 v[198:199], v[198:199], v[174:175] op_sel_hi:[1,0]
    v_pk_mul_f32 v[200:201], v[200:201], v[174:175] op_sel_hi:[1,0]
    v_pk_mul_f32 v[202:203], v[202:203], v[174:175] op_sel_hi:[1,0]
    v_cvt_pk_bf16_f32 v82, v196, v197
    v_cvt_pk_bf16_f32 v83, v198, v199
    v_cvt_pk_bf16_f32 v84, v200, v201
    v_cvt_pk_bf16_f32 v85, v202, v203
    buffer_store_dwordx4 v[82:85], v2, s[8:11], s0 offen offset:2048 sc1
    v_pk_mul_f32 v[208:209], v[208:209], v[174:175] op_sel_hi:[1,0]
    v_pk_mul_f32 v[210:211], v[210:211], v[174:175] op_sel_hi:[1,0]
    v_pk_mul_f32 v[212:213], v[212:213], v[174:175] op_sel_hi:[1,0]
    v_pk_mul_f32 v[214:215], v[214:215], v[174:175] op_sel_hi:[1,0]
    v_cvt_pk_bf16_f32 v86, v208, v209
    v_cvt_pk_bf16_f32 v87, v210, v211
    v_cvt_pk_bf16_f32 v88, v212, v213
    v_cvt_pk_bf16_f32 v89, v214, v215
    buffer_store_dwordx4 v[86:89], v2, s[8:11], s0 offen offset:3072 sc1
    v_pk_mul_f32 v[148:149], v[148:149], v[172:173] op_sel_hi:[1,0]
    v_pk_mul_f32 v[150:151], v[150:151], v[172:173] op_sel_hi:[1,0]
    v_pk_mul_f32 v[160:161], v[160:161], v[172:173] op_sel_hi:[1,0]
    v_pk_mul_f32 v[162:163], v[162:163], v[172:173] op_sel_hi:[1,0]
    v_pk_mul_f32 v[192:193], v[192:193], v[174:175] op_sel_hi:[1,0]
    v_pk_mul_f32 v[194:195], v[194:195], v[174:175] op_sel_hi:[1,0]
    v_pk_mul_f32 v[204:205], v[204:205], v[174:175] op_sel_hi:[1,0]
    v_pk_mul_f32 v[206:207], v[206:207], v[174:175] op_sel_hi:[1,0]
    v_cvt_pk_bf16_f32 v90, v160, v161
    v_cvt_pk_bf16_f32 v60, v204, v205
    v_cvt_pk_bf16_f32 v62, v148, v149
    v_cvt_pk_bf16_f32 v92, v192, v193
    v_cvt_pk_bf16_f32 v91, v162, v163
    v_cvt_pk_bf16_f32 v61, v206, v207
    v_cvt_pk_bf16_f32 v63, v150, v151
    v_cvt_pk_bf16_f32 v93, v194, v195
    ds_write_b128 v11, v[74:77] offset:28672
    ds_write_b128 v29, v[78:81] offset:28672
    v_permlane32_swap_b32 v90, v60
    v_permlane32_swap_b32 v62, v92
    v_permlane32_swap_b32 v91, v61
    v_permlane32_swap_b32 v63, v93
    buffer_store_dwordx4 v[90:93], v5, s[8:11], s0 offen sc1
    ds_write_b128 v28, v[82:85] offset:28672
    ds_write_b128 v30, v[86:89] offset:28672
    ds_write_b64 v31, v[90:91] offset:29696
    ds_write_b64 v32, v[92:93] offset:28704
    v_mov_b32 v4, 0x3f80
    v_pk_mul_f32 v[140:141], v[140:141], v[172:173] op_sel:[0,1] op_sel_hi:[1,1]
    v_pk_mul_f32 v[142:143], v[142:143], v[172:173] op_sel:[0,1] op_sel_hi:[1,1]
    v_pk_mul_f32 v[144:145], v[144:145], v[172:173] op_sel:[0,1] op_sel_hi:[1,1]
    v_pk_mul_f32 v[146:147], v[146:147], v[172:173] op_sel:[0,1] op_sel_hi:[1,1]
    v_mul_f32 v148, 0x3ea52b5c, v148
    v_mul_f32 v149, 0x3ea52b5c, v149
    v_mul_f32 v150, 0x3ea52b5c, v150
    v_mul_f32 v151, 0x3ea52b5c, v151
    v_cvt_pk_bf16_f32 v48, v140, v141
    v_cvt_pk_bf16_f32 v49, v142, v143
    v_cvt_pk_bf16_f32 v50, v144, v145
    v_cvt_pk_bf16_f32 v51, v146, v147
    v_cvt_pk_bf16_f32 v52, v148, v149
    v_cvt_pk_bf16_f32 v53, v150, v151
    v_cndmask_b32 v52, v52, v4, s[56:57]
    v_cndmask_b32 v53, v53, 0, s[56:57]
    s_waitcnt lgkmcnt(0)
    s_barrier
    ds_read_b128 a[100:103], v11 offset:28672
    ds_read_b64 a[104:105], v11 offset:29696
    ds_read_b128 a[106:109], v35 offset:28672
    ds_read_b64 a[110:111], v35 offset:29696
    ds_read_b128 a[112:115], v36 offset:28672
    ds_read_b64 a[116:117], v36 offset:29696
    v_pk_mul_f32 v[184:185], v[184:185], v[174:175] op_sel:[0,1] op_sel_hi:[1,1]
    v_pk_mul_f32 v[186:187], v[186:187], v[174:175] op_sel:[0,1] op_sel_hi:[1,1]
    v_pk_mul_f32 v[188:189], v[188:189], v[174:175] op_sel:[0,1] op_sel_hi:[1,1]
    v_pk_mul_f32 v[190:191], v[190:191], v[174:175] op_sel:[0,1] op_sel_hi:[1,1]
    v_mul_f32 v192, 0x3ea52b5c, v192
    v_mul_f32 v193, 0x3ea52b5c, v193
    v_mul_f32 v194, 0x3ea52b5c, v194
    v_mul_f32 v195, 0x3ea52b5c, v195
    v_cvt_pk_bf16_f32 v54, v184, v185
    v_cvt_pk_bf16_f32 v55, v186, v187
    v_cvt_pk_bf16_f32 v56, v188, v189
    v_cvt_pk_bf16_f32 v57, v190, v191
    v_cvt_pk_bf16_f32 v58, v192, v193
    v_cvt_pk_bf16_f32 v59, v194, v195
    v_cndmask_b32 v58, v58, v4, s[56:57]
    v_cndmask_b32 v59, v59, 0, s[56:57]
    s_waitcnt vmcnt(5)
    v_cmp_ne_u32_e64 vcc, s45, v8
    s_nop 0
    s_and_b32 vcc_hi, vcc_hi, 0x1f
    s_or_b32 vcc_lo, vcc_lo, vcc_hi
    s_cbranch_scc1 Ls_S1
Lr_S1:
    s_waitcnt lgkmcnt(4)
    v_mfma_f32_32x32x16_bf16 v[94:109], a[100:103], v[48:51], v[12:27]
    ds_read_b128 a[118:121], v37 offset:28672
    v_cndmask_b32 v158, v54, v48, s[88:89]
    v_cndmask_b32 v159, v55, v49, s[88:89]
    v_cndmask_b32 v160, v56, v50, s[88:89]
    v_cndmask_b32 v161, v57, v51, s[88:89]
    v_cndmask_b32 v162, v58, v52, s[88:89]
    v_mfma_f32_32x32x8bf16_1k v[94:109], a[104:105], v[52:53], v[94:109]
    ds_read_b64 a[122:123], v37 offset:29696
    s_add_u32 m0, s24, 0
    s_add_u32 s42, s22, 0
    buffer_load_dwordx4 v2, s[8:11], s42 offen offset:0 sc1 lds
    v_cndmask_b32 v163, v59, v53, s[88:89]
    v_mov_b32 v60, 0
    v_mov_b32 v61, 0
    v_mov_b32 v62, 0
    v_mov_b32_e64 v63, 0
    s_waitcnt lgkmcnt(4)
    v_mfma_f32_32x32x16_bf16 v[110:125], a[106:109], v[158:161], 0
    ds_read_b128 a[100:103], v38 offset:43008
    v_cndmask_b32 v164, v54, v48, s[90:91]
    v_cndmask_b32 v165, v55, v49, s[90:91]
    v_cndmask_b32 v166, v56, v50, s[90:91]
    v_cndmask_b32 v167, v57, v51, s[90:91]
    v_cndmask_b32 v168, v58, v52, s[90:91]
    v_mfma_f32_32x32x8bf16_1k v[110:125], a[110:111], v[162:163], v[110:125]
    ds_read_b64 a[104:105], v38 offset:44032
    buffer_load_dwordx4 v2, s[8:11], s42 offen offset:1024 sc1 lds
    v_cndmask_b32 v169, v59, v53, s[90:91]
    v_mov_b32 v64, 0
    v_mov_b32 v65, 0
    v_mov_b32_e64 v66, 0
    v_mov_b32 v67, 0
    s_waitcnt lgkmcnt(4)
    v_mfma_f32_32x32x16_bf16 v[126:141], a[112:115], v[164:167], 0
    ds_read_b128 a[106:109], v38 offset:46592
    v_cndmask_b32 v174, v54, v48, s[92:93]
    v_cndmask_b32 v175, v55, v49, s[92:93]
    v_cndmask_b32 v176, v56, v50, s[92:93]
    v_cndmask_b32 v177, v57, v51, s[92:93]
    v_cndmask_b32 v178, v58, v52, s[92:93]
    v_cndmask_b32 v179, v59, v53, s[92:93]
    v_max3_f32 v249, v94, v95, v44
    v_mfma_f32_32x32x8bf16_1k v[126:141], a[116:117], v[168:169], v[126:141]
    ds_read_b64 a[110:111], v38 offset:47616
    buffer_load_dwordx4 v2, s[8:11], s42 offen offset:2048 sc1 lds
    v_max3_f32 v249, v96, v97, v249
    v_max3_f32 v249, v98, v99, v249
    v_max3_f32 v249, v100, v101, v249
    v_max3_f32 v249, v102, v103, v249
    v_max3_f32 v249, v104, v105, v249
    v_max3_f32 v249, v106, v107, v249
    v_max3_f32 v249, v108, v109, v249
    s_waitcnt lgkmcnt(4)
    v_mfma_f32_32x32x16_bf16 v[142:157], a[118:121], v[174:177], 0
    ds_read_b128 a[112:115], v38 offset:50176
    v_mov_b32 v68, 0
    v_mov_b32_e64 v69, 0
    v_mov_b32_e64 v70, 0
    v_max3_f32 v250, v110, v111, v44
    v_max3_f32 v250, v112, v113, v250
    v_mfma_f32_32x32x8bf16_1k v[142:157], a[122:123], v[178:179], v[142:157]
    ds_read_b64 a[116:117], v38 offset:51200
    buffer_load_dwordx4 v2, s[8:11], s42 offen offset:3072 sc1 lds
    v_max3_f32 v250, v114, v115, v250
    v_max3_f32 v250, v116, v117, v250
    v_max3_f32 v250, v118, v119, v250
    v_max3_f32 v250, v120, v121, v250
    v_max3_f32 v250, v122, v123, v250
    v_max3_f32 v250, v124, v125, v250
    s_waitcnt lgkmcnt(4)
    v_mfma_f32_32x32x16_bf16 v[158:173], a[100:103], v[54:57], 0
    ds_read_b128 a[118:121], v38 offset:53760
    v_mov_b32 v71, 0
    v_mov_b32_e64 v72, 0
    v_max3_f32 v251, v126, v127, v44
    v_max3_f32 v251, v128, v129, v251
    v_max3_f32 v251, v130, v131, v251
    v_mfma_f32_32x32x8bf16_1k v[158:173], a[104:105], v[58:59], v[158:173]
    ds_read_b64 a[122:123], v38 offset:54784
    s_add_u32 m0, s24, 4096
    s_add_u32 s42, s22, 4096
    buffer_load_dwordx4 v2, s[8:11], s42 offen offset:0 sc1 lds
    v_max3_f32 v251, v132, v133, v251
    v_max3_f32 v251, v134, v135, v251
    v_max3_f32 v251, v136, v137, v251
    v_max3_f32 v251, v138, v139, v251
    v_max3_f32 v251, v140, v141, v251
    s_waitcnt lgkmcnt(4)
    v_mfma_f32_32x32x16_bf16 v[174:189], a[106:109], v[54:57], 0
    ds_read_b128 a[100:103], v38 offset:57344
    v_max3_f32 v252, v142, v143, v44
    v_max3_f32 v252, v144, v145, v252
    v_max3_f32 v252, v146, v147, v252
    v_max3_f32 v252, v148, v149, v252
    v_mfma_f32_32x32x8bf16_1k v[174:189], a[110:111], v[58:59], v[174:189]
    ds_read_b64 a[104:105], v38 offset:58368
    s_add_u32 m0, s24, 5120
    s_add_u32 s42, s22, 5120
    buffer_load_dwordx4 v2, s[8:11], s42 offen offset:0 sc1 lds
    v_max3_f32 v252, v150, v151, v252
    v_max3_f32 v252, v152, v153, v252
    v_max3_f32 v252, v154, v155, v252
    v_max3_f32 v252, v156, v157, v252
    s_waitcnt lgkmcnt(4)
    v_mfma_f32_32x32x16_bf16 v[190:205], a[112:115], v[54:57], 0
    v_max3_f32 v253, v158, v159, v44
    v_max3_f32 v253, v160, v161, v253
    v_max3_f32 v253, v162, v163, v253
    v_max3_f32 v253, v164, v165, v253
    v_mfma_f32_32x32x8bf16_1k v[190:205], a[116:117], v[58:59], v[190:205]
    buffer_load_dwordx4 v2, s[8:11], s42 offen offset:1024 sc1 lds
    v_max3_f32 v253, v166, v167, v253
    v_max3_f32 v253, v168, v169, v253
    v_max3_f32 v253, v170, v171, v253
    v_max3_f32 v253, v172, v173, v253
    s_waitcnt lgkmcnt(2)
    v_mfma_f32_32x32x16_bf16 v[206:221], a[118:121], v[54:57], 0
    v_max3_f32 v253, v174, v175, v253
    v_max3_f32 v253, v176, v177, v253
    v_max3_f32 v253, v178, v179, v253
    v_max3_f32 v253, v180, v181, v253
    v_mfma_f32_32x32x8bf16_1k v[206:221], a[122:123], v[58:59], v[206:221]
    buffer_load_dwordx4 v2, s[8:11], s42 offen offset:2048 sc1 lds
    v_max3_f32 v253, v182, v183, v253
    v_max3_f32 v253, v184, v185, v253
    v_max3_f32 v253, v186, v187, v253
    v_max3_f32 v253, v188, v189, v253
    s_waitcnt lgkmcnt(0)
    v_mfma_f32_32x32x16_bf16 v[74:89], a[100:103], v[54:57], v[12:27]
    v_max3_f32 v253, v190, v191, v253
    v_max3_f32 v253, v192, v193, v253
    v_max3_f32 v253, v194, v195, v253
    v_max3_f32 v253, v196, v197, v253
    v_mfma_f32_32x32x8bf16_1k v[74:89], a[104:105], v[58:59], v[74:89]
    v_max3_f32 v253, v198, v199, v253
    v_max3_f32 v253, v200, v201, v253
    v_max3_f32 v253, v202, v203, v253
    v_max3_f32 v253, v204, v205, v253
    v_max3_f32 v253, v206, v207, v253
    v_max3_f32 v253, v208, v209, v253
    v_max3_f32 v253, v210, v211, v253
    v_max3_f32 v253, v212, v213, v253
    v_max3_f32 v253, v214, v215, v253
    v_max3_f32 v253, v216, v217, v253
    v_max3_f32 v253, v218, v219, v253
    v_max3_f32 v253, v220, v221, v253
    ds_read_b64_tr_b16 a[100:101], v39 offset:28672
    ds_read_b64_tr_b16 a[102:103], v39 offset:29056
    ds_read_b64_tr_b16 a[104:105], v39 offset:29440
    ds_read_b64_tr_b16 a[106:107], v39 offset:29824
    ds_read_b64_tr_b16 a[108:109], v40 offset:28672
    ds_read_b64_tr_b16 a[110:111], v40 offset:29056
    ds_read_b64_tr_b16 a[112:113], v40 offset:29440
    ds_read_b64_tr_b16 a[114:115], v40 offset:29824
    v_cndmask_b32 v3, v44, v250, s[88:89]
    v_cndmask_b32 v250, v250, v44, s[88:89]
    v_max_f32 v249, v249, v3
    v_cndmask_b32 v3, v44, v251, s[90:91]
    v_cndmask_b32 v251, v251, v44, s[90:91]
    v_max_f32 v249, v249, v3
    v_cndmask_b32 v3, v44, v252, s[92:93]
    v_cndmask_b32 v252, v252, v44, s[92:93]
    v_max_f32 v249, v249, v3
    v_max3_f32 v250, v250, v251, v252
    v_mov_b32 v251, v249
    s_nop 1
    v_permlane32_swap_b32 v249, v251
    v_max_f32 v249, v249, v251
    v_and_b32 v3, 0xffff0000, v249
    v_sub_f32 v251, v249, v3
    v_and_b32 v4, 0xffff0000, v251
    v_sub_f32 v251, v251, v4
    v_lshrrev_b32 v3, 16, v3
    v_or_b32 v238, v3, v4
    v_lshrrev_b32_e64 v239, 16, v251
    s_nop 1
    v_mfma_f32_32x32x8bf16_1k v[94:109], v[46:47], v[238:239], v[94:109]
    v_max3_f32 v253, v74, v75, v253
    v_max3_f32 v253, v76, v77, v253
    v_max3_f32 v253, v78, v79, v253
    v_max3_f32 v253, v80, v81, v253
    v_max3_f32 v253, v82, v83, v253
    v_max3_f32 v253, v84, v85, v253
    v_max3_f32 v253, v86, v87, v253
    v_max3_f32 v253, v88, v89, v253
    v_max_f32 v253, v253, v250
    v_mov_b32 v251, v253
    s_nop 1
    v_permlane32_swap_b32 v253, v251
    v_max_f32 v253, v253, v251
    v_and_b32 v3, 0xffff0000, v253
    v_sub_f32 v251, v253, v3
    v_and_b32 v4, 0xffff0000, v251
    v_sub_f32 v251, v251, v4
    v_lshrrev_b32 v3, 16, v3
    v_or_b32 v246, v3, v4
    v_lshrrev_b32 v247, 16, v251
    v_cndmask_b32 v240, v246, v238, s[88:89]
    v_cndmask_b32 v241, v247, v239, s[88:89]
    v_cndmask_b32 v242, v246, v238, s[90:91]
    v_cndmask_b32 v243, v247, v239, s[90:91]
    v_cndmask_b32 v244, v246, v238, s[92:93]
    v_cndmask_b32 v245, v247, v239, s[92:93]
    v_mfma_f32_32x32x8bf16_1k v[110:125], v[46:47], v[240:241], v[110:125]
    v_mov_b32 v45, v249
    v_mov_b32 v248, v253
    s_waitcnt vmcnt(8)
    s_mov_b32 exec_hi, 0
    buffer_store_dword v6, v7, s[8:11], s1 offen offset:0 sc1
    s_mov_b64 exec, -1
    s_sub_u32 s0, s0, 655360
    s_sub_u32 s48, s1, 16384
    s_cmp_eq_u32 s50, 0
    s_cselect_b32 s0, 0x10000000, s0
    s_cselect_b32 s1, s1, s48
    v_exp_f32 v94, v94
    v_exp_f32 v95, v95
    buffer_load_dwordx4 v2, s[8:11], s42 offen offset:3072 sc1 lds
    v_exp_f32 v96, v96
    v_exp_f32 v97, v97
    v_exp_f32 v98, v98
    v_exp_f32 v99, v99
    v_exp_f32 v100, v100
    s_add_u32 m0, s24, 9216
    s_add_u32 s42, s22, 9216
    buffer_load_dwordx4 v2, s[8:11], s42 offen offset:0 sc1 lds
    v_exp_f32 v101, v101
    v_exp_f32 v102, v102
    v_exp_f32 v103, v103
    v_exp_f32 v104, v104
    v_exp_f32_e64 v105, v105
    v_mfma_f32_32x32x8bf16_1k v[126:141], v[46:47], v[242:243], v[126:141]
    s_add_u32 m0, s24, 10240
    s_add_u32 s42, s22, 10240
    buffer_load_dwordx4 v2, s[8:11], s42 offen offset:0 sc1 lds
    buffer_load_dwordx4 v2, s[8:11], s42 offen offset:1024 sc1 lds
    v_exp_f32 v106, v106
    v_exp_f32 v107, v107
    v_exp_f32 v108, v108
    v_exp_f32 v109, v109
    v_cvt_pk_bf16_f32 v94, v94, v95
    v_cvt_pk_bf16_f32 v95, v96, v97
    v_cvt_pk_bf16_f32 v96, v98, v99
    v_cvt_pk_bf16_f32 v97, v100, v101
    v_cvt_pk_bf16_f32 v98, v102, v103
    v_cvt_pk_bf16_f32 v99, v104, v105
    v_cvt_pk_bf16_f32 v100, v106, v107
    v_cvt_pk_bf16_f32 v101, v108, v109
    v_sub_f32 v12, v44, v12
    v_sub_f32 v13, v44, v13
    v_sub_f32 v14, v44, v14
    v_sub_f32 v15, v44, v15
    v_sub_f32 v16, v44, v16
    v_sub_f32 v17, v44, v17
    v_sub_f32 v18, v44, v18
    v_sub_f32 v19, v44, v19
    v_sub_f32 v20, v44, v20
    v_sub_f32 v21, v44, v21
    v_sub_f32 v22, v44, v22
    v_sub_f32 v23, v44, v23
    v_sub_f32 v24, v44, v24
    v_sub_f32 v25, v44, v25
    v_sub_f32 v26, v44, v26
    v_sub_f32 v27, v44, v27
    v_exp_f32 v110, v110
    v_exp_f32_e64 v111, v111
    s_waitcnt lgkmcnt(4)
    v_mfma_f32_32x32x16_bf16 v[222:237], a[100:103], v[94:97], 0
    ds_read_b64_tr_b16 a[116:117], v41 offset:28672
    buffer_load_dwordx4 v2, s[8:11], s42 offen offset:2048 sc1 lds
    v_exp_f32 v112, v112
    v_exp_f32 v113, v113
    v_exp_f32 v114, v114
    v_exp_f32 v115, v115
    v_exp_f32_e64 v116, v116
    v_mfma_f32_32x32x16_bf16 v[222:237], a[104:107], v[98:101], v[222:237]
    ds_read_b64_tr_b16 a[118:119], v41 offset:29056
    ds_read_b64_tr_b16 a[120:121], v41 offset:29440
    buffer_load_dwordx4 v2, s[8:11], s42 offen offset:3072 sc1 lds
    v_exp_f32 v117, v117
    v_exp_f32 v118, v118
    v_exp_f32 v119, v119
    v_exp_f32 v120, v120
    v_exp_f32_e64 v121, v121
    v_mfma_f32_32x32x8bf16_1k v[142:157], v[46:47], v[244:245], v[142:157]
    ds_read_b64_tr_b16 a[122:123], v41 offset:29824
    s_add_u32 m0, s24, 14336
    s_add_u32 s42, s22, 14336
    buffer_load_dwordx4 v2, s[8:11], s42 offen offset:0 sc1 lds
    s_add_u32 m0, s24, 15360
    s_add_u32 s42, s22, 15360
    buffer_load_dwordx4 v2, s[8:11], s42 offen offset:0 sc1 lds
    v_exp_f32 v122, v122
    v_exp_f32 v123, v123
    v_exp_f32 v124, v124
    v_exp_f32 v125, v125
    v_cvt_pk_bf16_f32 v110, v110, v111
    v_cvt_pk_bf16_f32 v111, v112, v113
    v_cvt_pk_bf16_f32 v112, v114, v115
    v_cvt_pk_bf16_f32 v113, v116, v117
    v_cvt_pk_bf16_f32 v114, v118, v119
    v_cvt_pk_bf16_f32 v115, v120, v121
    v_cvt_pk_bf16_f32 v116, v122, v123
    v_cvt_pk_bf16_f32 v117, v124, v125
    s_cmp_eq_u32 s40, 0
    s_cbranch_scc1 Lsw01
Lsr01:
    v_exp_f32 v126, v126
    v_exp_f32_e64 v127, v127
    s_waitcnt lgkmcnt(4)
    v_mfma_f32_32x32x16_bf16 v[222:237], a[108:111], v[110:113], v[222:237]
    ds_read_b64_tr_b16 a[100:101], v42 offset:28672
    buffer_load_dwordx4 v2, s[8:11], s42 offen offset:1024 sc1 lds
    v_exp_f32 v128, v128
    v_exp_f32 v129, v129
    v_exp_f32 v130, v130
    v_exp_f32 v131, v131
    v_exp_f32_e64 v132, v132
    v_mfma_f32_32x32x16_bf16 v[222:237], a[112:115], v[114:117], v[222:237]
    ds_read_b64_tr_b16 a[102:103], v42 offset:29056
    ds_read_b64_tr_b16 a[104:105], v42 offset:29440
    buffer_load_dwordx4 v2, s[8:11], s42 offen offset:2048 sc1 lds
    v_exp_f32 v133, v133
    v_exp_f32 v134, v134
    v_exp_f32 v135, v135
    v_exp_f32 v136, v136
    v_exp_f32_e64 v137, v137
    v_mfma_f32_32x32x8bf16_1k v[158:173], v[46:47], v[246:247], v[158:173]
    ds_read_b64_tr_b16 a[106:107], v42 offset:29824
    buffer_load_dwordx4 v2, s[8:11], s42 offen offset:3072 sc1 lds
    s_add_u32 m0, s24, 19456
    s_add_u32 s42, s22, 19456
    buffer_load_dwordx4 v2, s[8:11], s42 offen offset:0 sc1 lds
    v_exp_f32 v138, v138
    v_exp_f32 v139, v139
    v_exp_f32 v140, v140
    v_exp_f32 v141, v141
    v_cvt_pk_bf16_f32 v126, v126, v127
    v_cvt_pk_bf16_f32 v127, v128, v129
    v_cvt_pk_bf16_f32 v128, v130, v131
    v_cvt_pk_bf16_f32 v129, v132, v133
    v_cvt_pk_bf16_f32 v130, v134, v135
    v_cvt_pk_bf16_f32 v131, v136, v137
    v_cvt_pk_bf16_f32 v132, v138, v139
    v_cvt_pk_bf16_f32 v133, v140, v141
    s_cmp_eq_u32 s40, 1
    s_cbranch_scc1 Lsw02
Lsr02:
    v_exp_f32 v142, v142
    v_exp_f32_e64 v143, v143
    s_waitcnt lgkmcnt(4)
    v_mfma_f32_32x32x16_bf16 v[222:237], a[116:119], v[126:129], v[222:237]
    ds_read_b64_tr_b16 a[108:109], v43 offset:43008
    s_add_u32 m0, s24, 20480
    s_add_u32 s42, s22, 20480
    buffer_load_dwordx4 v2, s[8:11], s42 offen offset:0 sc1 lds
    v_exp_f32 v144, v144
    v_exp_f32 v145, v145
    v_exp_f32 v146, v146
    v_exp_f32 v147, v147
    v_exp_f32_e64 v148, v148
    v_mfma_f32_32x32x16_bf16 v[222:237], a[120:123], v[130:133], v[222:237]
    ds_read_b64_tr_b16 a[110:111], v43 offset:43392
    ds_read_b64_tr_b16 a[112:113], v43 offset:43776
    buffer_load_dwordx4 v2, s[8:11], s42 offen offset:1024 sc1 lds
    v_exp_f32 v149, v149
    v_exp_f32 v150, v150
    v_exp_f32 v151, v151
    v_exp_f32 v152, v152
    v_exp_f32_e64 v153, v153
    v_mfma_f32_32x32x8bf16_1k v[174:189], v[46:47], v[246:247], v[174:189]
    ds_read_b64_tr_b16 a[114:115], v43 offset:44160
    buffer_load_dwordx4 v2, s[8:11], s42 offen offset:2048 sc1 lds
    buffer_load_dwordx4 v2, s[8:11], s42 offen offset:3072 sc1 lds
    v_exp_f32 v154, v154
    v_exp_f32 v155, v155
    v_exp_f32 v156, v156
    v_exp_f32 v157, v157
    v_cvt_pk_bf16_f32 v142, v142, v143
    v_cvt_pk_bf16_f32 v143, v144, v145
    v_cvt_pk_bf16_f32 v144, v146, v147
    v_cvt_pk_bf16_f32 v145, v148, v149
    v_cvt_pk_bf16_f32 v146, v150, v151
    v_cvt_pk_bf16_f32 v147, v152, v153
    v_cvt_pk_bf16_f32 v148, v154, v155
    v_cvt_pk_bf16_f32 v149, v156, v157
    s_cmp_eq_u32 s40, 2
    s_cbranch_scc1 Lsw03
Lsr03:
    v_exp_f32 v158, v158
    v_exp_f32_e64 v159, v159
    s_waitcnt lgkmcnt(4)
    v_mfma_f32_32x32x16_bf16 v[222:237], a[100:103], v[142:145], v[222:237]
    ds_read_b64_tr_b16 a[116:117], v43 offset:46592
    s_add_u32 m0, s24, 24576
    s_add_u32 s42, s22, 24576
    buffer_load_dwordx4 v2, s[8:11], s42 offen offset:0 sc1 lds
    v_exp_f32 v160, v160
    v_exp_f32 v161, v161
    v_exp_f32 v162, v162
    v_exp_f32 v163, v163
    v_exp_f32_e64 v164, v164
    v_mfma_f32_32x32x16_bf16 v[222:237], a[104:107], v[146:149], v[222:237]
    ds_read_b64_tr_b16 a[118:119], v43 offset:46976
    ds_read_b64_tr_b16 a[120:121], v43 offset:47360
    s_add_u32 s42, s21, 0
    buffer_load_dwordx4 a[0:3], v2, s[8:11], s42 offen offset:0 sc1
    v_exp_f32 v165, v165
    v_exp_f32 v166, v166
    v_exp_f32 v167, v167
    v_exp_f32 v168, v168
    v_exp_f32_e64 v169, v169
    v_mfma_f32_32x32x8bf16_1k v[190:205], v[46:47], v[246:247], v[190:205]
    ds_read_b64_tr_b16 a[122:123], v43 offset:47744
    s_mov_b64 exec, 0x1
    buffer_load_dword v8, v7, s[8:11], s1 offen offset:0 sc1
    s_mov_b64 exec, -1
    v_exp_f32 v170, v170
    v_exp_f32 v171, v171
    v_exp_f32 v172, v172
    v_exp_f32_e64 v173, v173
    v_cvt_pk_bf16_f32 v158, v158, v159
    v_cvt_pk_bf16_f32 v159, v160, v161
    v_cvt_pk_bf16_f32 v160, v162, v163
    v_cvt_pk_bf16_f32 v161, v164, v165
    v_cvt_pk_bf16_f32 v162, v166, v167
    v_cvt_pk_bf16_f32 v163, v168, v169
    v_cvt_pk_bf16_f32 v164, v170, v171
    v_cvt_pk_bf16_f32 v165, v172, v173
    s_cmp_eq_u32 s40, 3
    s_cbranch_scc1 Lsw04
Lsr04:
    v_exp_f32 v174, v174
    v_exp_f32_e64 v175, v175
    s_waitcnt lgkmcnt(4)
    v_mfma_f32_32x32x16_bf16 v[222:237], a[108:111], v[158:161], v[222:237]
    ds_read_b64_tr_b16 a[100:101], v43 offset:50176
    v_exp_f32 v176, v176
    v_exp_f32 v177, v177
    v_exp_f32 v178, v178
    v_exp_f32 v179, v179
    v_exp_f32_e64 v180, v180
    v_mfma_f32_32x32x16_bf16 v[222:237], a[112:115], v[162:165], v[222:237]
    ds_read_b64_tr_b16 a[102:103], v43 offset:50560
    ds_read_b64_tr_b16 a[104:105], v43 offset:50944
    v_exp_f32 v181, v181
    v_exp_f32 v182, v182
    v_exp_f32 v183, v183
    v_exp_f32 v184, v184
    v_exp_f32 v185, v185
    v_mfma_f32_32x32x8bf16_1k v[206:221], v[46:47], v[246:247], v[206:221]
    ds_read_b64_tr_b16 a[106:107], v43 offset:51328
    v_exp_f32 v186, v186
    v_exp_f32 v187, v187
    v_exp_f32 v188, v188
    v_exp_f32_e64 v189, v189
    v_cvt_pk_bf16_f32 v174, v174, v175
    v_cvt_pk_bf16_f32 v175, v176, v177
    v_cvt_pk_bf16_f32 v176, v178, v179
    v_cvt_pk_bf16_f32 v177, v180, v181
    v_cvt_pk_bf16_f32 v178, v182, v183
    v_cvt_pk_bf16_f32 v179, v184, v185
    v_cvt_pk_bf16_f32 v180, v186, v187
    v_cvt_pk_bf16_f32 v181, v188, v189
    v_exp_f32 v190, v190
    v_exp_f32_e64 v191, v191
    s_waitcnt lgkmcnt(4)
    v_mfma_f32_32x32x16_bf16 v[222:237], a[116:119], v[174:177], v[222:237]
    ds_read_b64_tr_b16 a[108:109], v43 offset:53760
    s_waitcnt vmcnt(0)
    v_cmp_ne_u32_e64 vcc, s45, v8
    s_nop 0
    s_and_b32 vcc_lo, vcc_lo, 0x1
    s_cbranch_scc1 Ls_kv
Lr_kv:
    buffer_load_dwordx4 a[132:135], v2, s[8:11], s0 offen offset:0 sc1
    buffer_load_dwordx4 a[136:139], v2, s[8:11], s0 offen offset:1024 sc1
    buffer_load_dwordx4 a[140:143], v2, s[8:11], s0 offen offset:2048 sc1
    buffer_load_dwordx4 a[144:147], v2, s[8:11], s0 offen offset:3072 sc1
    buffer_load_dwordx4 a[148:151], v5, s[8:11], s0 offen offset:0 sc1
    v_exp_f32 v192, v192
    v_exp_f32 v193, v193
    v_exp_f32 v194, v194
    v_exp_f32 v195, v195
    v_exp_f32 v196, v196
    v_mfma_f32_32x32x16_bf16 v[222:237], a[120:123], v[178:181], v[222:237]
    ds_read_b64_tr_b16 a[110:111], v43 offset:54144
    ds_read_b64_tr_b16 a[112:113], v43 offset:54528
    v_exp_f32 v197, v197
    v_exp_f32 v198, v198
    v_exp_f32 v199, v199
    v_exp_f32 v200, v200
    v_exp_f32 v201, v201
    v_mfma_f32_32x32x8bf16_1k v[74:89], v[46:47], v[246:247], v[74:89]
    ds_read_b64_tr_b16 a[114:115], v43 offset:54912
    v_exp_f32 v202, v202
    v_exp_f32 v203, v203
    v_exp_f32 v204, v204
    v_exp_f32 v205, v205
    v_cvt_pk_bf16_f32 v190, v190, v191
    v_cvt_pk_bf16_f32 v191, v192, v193
    v_cvt_pk_bf16_f32 v192, v194, v195
    v_cvt_pk_bf16_f32 v193, v196, v197
    v_cvt_pk_bf16_f32 v194, v198, v199
    v_cvt_pk_bf16_f32 v195, v200, v201
    v_cvt_pk_bf16_f32 v196, v202, v203
    v_cvt_pk_bf16_f32 v197, v204, v205
    v_exp_f32 v206, v206
    v_exp_f32_e64 v207, v207
    s_waitcnt lgkmcnt(4)
    v_mfma_f32_32x32x16_bf16 v[222:237], a[100:103], v[190:193], v[222:237]
    ds_read_b64_tr_b16 a[116:117], v43 offset:57344
    s_mov_b32 exec_hi, 0xffffffff
    buffer_load_dword v8, v10, s[8:11], s84 offen offset:0 sc1
    s_mov_b64 exec, -1
    v_exp_f32 v208, v208
    v_exp_f32 v209, v209
    v_exp_f32 v210, v210
    v_exp_f32 v211, v211
    v_exp_f32_e64 v212, v212
    v_mfma_f32_32x32x16_bf16 v[222:237], a[104:107], v[194:197], v[222:237]
    ds_read_b64_tr_b16 a[118:119], v43 offset:57728
    ds_read_b64_tr_b16 a[120:121], v43 offset:58112
    v_exp_f32 v213, v213
    v_exp_f32 v214, v214
    v_exp_f32 v215, v215
    v_exp_f32 v216, v216
    v_exp_f32 v217, v217
    ds_read_b64_tr_b16 a[122:123], v43 offset:58496
    v_exp_f32 v218, v218
    v_exp_f32 v219, v219
    v_exp_f32 v220, v220
    v_exp_f32_e64 v221, v221
    v_cvt_pk_bf16_f32 v206, v206, v207
    v_cvt_pk_bf16_f32 v207, v208, v209
    v_cvt_pk_bf16_f32 v208, v210, v211
    v_cvt_pk_bf16_f32 v209, v212, v213
    v_cvt_pk_bf16_f32 v210, v214, v215
    v_cvt_pk_bf16_f32 v211, v216, v217
    v_cvt_pk_bf16_f32 v212, v218, v219
    v_cvt_pk_bf16_f32 v213, v220, v221
    v_exp_f32 v74, v74
    v_exp_f32 v75, v75
    s_waitcnt lgkmcnt(4)
    v_mfma_f32_32x32x16_bf16 v[222:237], a[108:111], v[206:209], v[222:237]
    v_exp_f32 v76, v76
    v_exp_f32 v77, v77
    v_exp_f32 v78, v78
    v_exp_f32 v79, v79
    v_exp_f32 v80, v80
    v_mfma_f32_32x32x16_bf16 v[222:237], a[112:115], v[210:213], v[222:237]
    v_exp_f32 v81, v81
    v_exp_f32 v82, v82
    v_exp_f32_e64 v83, v83
    v_exp_f32_e64 v84, v84
    v_exp_f32_e64 v85, v85
    v_exp_f32_e64 v86, v86
    v_exp_f32_e64 v87, v87
    v_exp_f32_e64 v88, v88
    v_exp_f32_e64 v89, v89
    v_cvt_pk_bf16_f32 v74, v74, v75
    v_cvt_pk_bf16_f32 v75, v76, v77
    v_cvt_pk_bf16_f32 v76, v78, v79
    v_cvt_pk_bf16_f32 v77, v80, v81
    v_cvt_pk_bf16_f32 v78, v82, v83
    v_cvt_pk_bf16_f32 v79, v84, v85
    v_cvt_pk_bf16_f32 v80, v86, v87
    v_cvt_pk_bf16_f32 v81, v88, v89
    s_waitcnt lgkmcnt(2)
    v_mfma_f32_32x32x16_bf16 v[222:237], a[116:119], v[74:77], v[222:237]
    s_waitcnt lgkmcnt(0)
    v_mfma_f32_32x32x16_bf16 v[222:237], a[120:123], v[78:81], v[222:237]
    s_waitcnt vmcnt(5)
    ds_write_b128 v28, a[132:135] offset:0
    s_waitcnt vmcnt(4)
    ds_write_b128 v30, a[136:139] offset:0
    s_waitcnt vmcnt(3)
    ds_write_b128 v11, a[140:143] offset:0
    s_waitcnt vmcnt(2)
    ds_write_b128 v29, a[144:147] offset:0
    s_waitcnt vmcnt(1)
    ds_write_b64 v33, a[148:149] offset:1024
    ds_write_b64 v34, a[150:151] offset:32
    s_waitcnt vmcnt(0)
    v_cmp_ne_u32 vcc, s45, v8
    s_nop 0
    s_and_b32 vcc_hi, vcc_hi, 0xffffffff
    s_or_b32 vcc_lo, vcc_lo, vcc_hi
    s_cbranch_scc1 Ls_S2
Lr_S2:
    s_waitcnt lgkmcnt(0)
    s_barrier
    ds_read_b128 a[132:135], v11 offset:0
    ds_read_b64 a[136:137], v11 offset:1024
    ds_read_b128 a[138:141], v35 offset:0
    ds_read_b64 a[142:143], v35 offset:1024
    ds_read_b128 a[144:147], v36 offset:0
    ds_read_b64 a[148:149], v36 offset:1024
    s_waitcnt lgkmcnt(4)
    v_mfma_f32_32x32x16_bf16 v[94:109], a[132:135], v[54:57], v[12:27]
    ds_read_b128 a[150:153], v37 offset:0
    v_cndmask_b32 v158, v48, v54, s[88:89]
    v_cndmask_b32 v159, v49, v55, s[88:89]
    v_cndmask_b32 v160, v50, v56, s[88:89]
    v_mfma_f32_32x32x8bf16_1k v[94:109], a[136:137], v[58:59], v[94:109]
    ds_read_b64 a[154:155], v37 offset:1024
    buffer_load_dwordx4 a[4:7], v2, s[8:11], s42 offen offset:1024 sc1
    v_cndmask_b32 v161, v51, v57, s[88:89]
    v_cndmask_b32 v162, v52, v58, s[88:89]
    v_cndmask_b32 v163, v53, v59, s[88:89]
    s_waitcnt lgkmcnt(4)
    v_mfma_f32_32x32x16_bf16 v[110:125], a[138:141], v[158:161], 0
    ds_read_b128 a[132:135], v38 offset:14336
    v_cndmask_b32 v164, v48, v54, s[90:91]
    v_cndmask_b32 v165, v49, v55, s[90:91]
    v_cndmask_b32 v166, v50, v56, s[90:91]
    v_mfma_f32_32x32x8bf16_1k v[110:125], a[142:143], v[162:163], v[110:125]
    ds_read_b64 a[136:137], v38 offset:15360
    buffer_load_dwordx4 a[8:11], v2, s[8:11], s42 offen offset:2048 sc1
    v_cndmask_b32 v167, v51, v57, s[90:91]
    v_cndmask_b32 v168, v52, v58, s[90:91]
    v_cndmask_b32 v169, v53, v59, s[90:91]
    s_waitcnt lgkmcnt(4)
    v_mfma_f32_32x32x16_bf16 v[126:141], a[144:147], v[164:167], 0
    ds_read_b128 a[138:141], v38 offset:17920
    v_cndmask_b32 v174, v48, v54, s[92:93]
    v_cndmask_b32 v175, v49, v55, s[92:93]
    v_cndmask_b32 v176, v50, v56, s[92:93]
    v_cndmask_b32 v177, v51, v57, s[92:93]
    v_cndmask_b32 v178, v52, v58, s[92:93]
    v_cndmask_b32 v179, v53, v59, s[92:93]
    v_max3_f32 v249, v94, v95, v248
    v_mfma_f32_32x32x8bf16_1k v[126:141], a[148:149], v[168:169], v[126:141]
    ds_read_b64 a[142:143], v38 offset:18944
    buffer_load_dwordx4 a[12:15], v2, s[8:11], s42 offen offset:3072 sc1
    v_max3_f32 v249, v96, v97, v249
    v_max3_f32 v249, v98, v99, v249
    v_max3_f32 v249, v100, v101, v249
    v_max3_f32 v249, v102, v103, v249
    v_max3_f32 v249, v104, v105, v249
    v_max3_f32 v249, v106, v107, v249
    v_max3_f32 v249, v108, v109, v249
    s_waitcnt lgkmcnt(4)
    v_mfma_f32_32x32x16_bf16 v[142:157], a[150:153], v[174:177], 0
    ds_read_b128 a[144:147], v38 offset:21504
    v_bfe_u32 v3, v1, 4, 1
    v_mul_u32_u24 v91, 20480, v3
    v_and_b32 v4, 15, v1
    v_max3_f32 v250, v110, v111, v44
    v_max3_f32 v250, v112, v113, v250
    v_mfma_f32_32x32x8bf16_1k v[142:157], a[154:155], v[178:179], v[142:157]
    ds_read_b64 a[148:149], v38 offset:22528
    buffer_load_dwordx4 a[16:19], v5, s[8:11], s42 offen offset:0 sc1
    v_max3_f32 v250, v114, v115, v250
    v_max3_f32 v250, v116, v117, v250
    v_max3_f32 v250, v118, v119, v250
    v_max3_f32 v250, v120, v121, v250
    v_max3_f32 v250, v122, v123, v250
    v_max3_f32 v250, v124, v125, v250
    s_waitcnt lgkmcnt(4)
    v_mfma_f32_32x32x16_bf16 v[158:173], a[132:135], v[48:51], 0
    ds_read_b128 a[150:153], v38 offset:25088
    v_lshl_add_u32 v90, v4, 4, v91
    v_lshl_add_u32 v91, v4, 3, v91
    v_lshrrev_b32 v4, 5, v1
    v_lshl_add_u32 v90, v4, 8, v90
    v_max3_f32 v251, v126, v127, v44
    v_max3_f32 v251, v128, v129, v251
    v_mfma_f32_32x32x8bf16_1k v[158:173], a[136:137], v[52:53], v[158:173]
    ds_read_b64 a[154:155], v38 offset:26112
    s_add_u32 s42, s21, 20480
    buffer_load_dwordx4 a[20:23], v2, s[8:11], s42 offen offset:0 sc1
    v_max3_f32 v251, v130, v131, v251
    v_max3_f32 v251, v132, v133, v251
    v_max3_f32 v251, v134, v135, v251
    v_max3_f32 v251, v136, v137, v251
    v_max3_f32 v251, v138, v139, v251
    v_max3_f32 v251, v140, v141, v251
    s_waitcnt lgkmcnt(4)
    v_mfma_f32_32x32x16_bf16 v[174:189], a[138:141], v[48:51], 0
    ds_read_b128 a[132:135], v38 offset:28672
    s_lshl_b32 s48, s51, 9
    v_add_u32 v90, s48, v90
    s_lshl_b32 s48, s51, 7
    s_add_u32 s48, s48, 16384
    v_max3_f32 v252, v142, v143, v44
    v_max3_f32 v252, v144, v145, v252
    v_mfma_f32_32x32x8bf16_1k v[174:189], a[142:143], v[52:53], v[174:189]
    ds_read_b64 a[136:137], v38 offset:29696
    buffer_load_dwordx4 a[24:27], v2, s[8:11], s42 offen offset:1024 sc1
    v_max3_f32 v252, v146, v147, v252
    v_max3_f32 v252, v148, v149, v252
    v_max3_f32 v252, v150, v151, v252
    v_max3_f32 v252, v152, v153, v252
    v_max3_f32 v252, v154, v155, v252
    v_max3_f32 v252, v156, v157, v252
    s_waitcnt lgkmcnt(4)
    v_mfma_f32_32x32x16_bf16 v[190:205], a[144:147], v[48:51], 0
    v_add_u32 v91, s48, v91
    s_add_u32 s23, s52, 0xd00000
    s_add_u32 s54, s53, 0xd00000
    v_max3_f32 v253, v158, v159, v45
    v_max3_f32 v253, v160, v161, v253
    v_mfma_f32_32x32x8bf16_1k v[190:205], a[148:149], v[52:53], v[190:205]
    buffer_load_dwordx4 a[28:31], v2, s[8:11], s42 offen offset:2048 sc1
    v_max3_f32 v253, v162, v163, v253
    v_max3_f32 v253, v164, v165, v253
    v_max3_f32 v253, v166, v167, v253
    v_max3_f32 v253, v168, v169, v253
    v_max3_f32 v253, v170, v171, v253
    v_max3_f32 v253, v172, v173, v253
    s_waitcnt lgkmcnt(2)
    v_mfma_f32_32x32x16_bf16 v[206:221], a[150:153], v[48:51], 0
    s_lshl_b32 s48, s50, 12
    s_lshl_b32 s49, s51, 4
    s_add_u32 s48, s48, s49
    s_lshl_b32 s49, s40, 9
    v_max3_f32 v253, v174, v175, v253
    v_max3_f32 v253, v176, v177, v253
    v_mfma_f32_32x32x8bf16_1k v[206:221], a[154:155], v[52:53], v[206:221]
    buffer_load_dwordx4 a[32:35], v2, s[8:11], s42 offen offset:3072 sc1
    v_max3_f32 v253, v178, v179, v253
    v_max3_f32 v253, v180, v181, v253
    v_max3_f32 v253, v182, v183, v253
    v_max3_f32 v253, v184, v185, v253
    v_max3_f32 v253, v186, v187, v253
    v_max3_f32 v253, v188, v189, v253
    s_waitcnt lgkmcnt(0)
    v_mfma_f32_32x32x16_bf16 v[74:89], a[132:135], v[48:51], v[12:27]
    s_add_u32 s48, s48, 0x2f40000
    s_add_u32 s58, s48, s49
    s_sub_u32 s60, s48, s49
    s_add_u32 s60, s60, 3584
    v_max3_f32 v253, v190, v191, v253
    v_max3_f32 v253, v192, v193, v253
    v_mfma_f32_32x32x8bf16_1k v[74:89], a[136:137], v[52:53], v[74:89]
    v_max3_f32 v253, v194, v195, v253
    v_max3_f32 v253, v196, v197, v253
    v_max3_f32 v253, v198, v199, v253
    v_max3_f32 v253, v200, v201, v253
    v_max3_f32 v253, v202, v203, v253
    v_max3_f32 v253, v204, v205, v253
    v_max3_f32 v253, v206, v207, v253
    v_max3_f32 v253, v208, v209, v253
    v_max3_f32 v253, v210, v211, v253
    v_max3_f32 v253, v212, v213, v253
    v_max3_f32 v253, v214, v215, v253
    v_max3_f32 v253, v216, v217, v253
    v_max3_f32 v253, v218, v219, v253
    v_max3_f32 v253, v220, v221, v253
    ds_read_b64_tr_b16 a[100:101], v39 offset:0
    ds_read_b64_tr_b16 a[102:103], v39 offset:384
    ds_read_b64_tr_b16 a[104:105], v39 offset:768
    ds_read_b64_tr_b16 a[106:107], v39 offset:1152
    ds_read_b64_tr_b16 a[108:109], v40 offset:0
    ds_read_b64_tr_b16 a[110:111], v40 offset:384
    ds_read_b64_tr_b16 a[112:113], v40 offset:768
    ds_read_b64_tr_b16 a[114:115], v40 offset:1152
    v_cndmask_b32 v3, v44, v250, s[88:89]
    v_cndmask_b32 v250, v250, v44, s[88:89]
    v_max_f32_e64 v249, v249, v3
    v_cndmask_b32 v3, v44, v251, s[90:91]
    v_cndmask_b32 v251, v251, v44, s[90:91]
    v_max_f32_e64 v249, v249, v3
    v_cndmask_b32 v3, v44, v252, s[92:93]
    v_cndmask_b32 v252, v252, v44, s[92:93]
    v_max_f32 v249, v249, v3
    v_max3_f32 v250, v250, v251, v252
    v_mov_b32 v251, v249
    s_nop 1
    v_permlane32_swap_b32 v249, v251
    v_max_f32 v249, v249, v251
    v_and_b32 v3, 0xffff0000, v249
    v_sub_f32 v251, v249, v3
    v_and_b32 v4, 0xffff0000, v251
    v_sub_f32 v251, v251, v4
    v_lshrrev_b32 v3, 16, v3
    v_or_b32 v238, v3, v4
    v_lshrrev_b32_e64 v239, 16, v251
    s_nop 1
    v_mfma_f32_32x32x8bf16_1k v[94:109], v[46:47], v[238:239], v[94:109]
    v_max3_f32 v253, v74, v75, v253
    v_max3_f32 v253, v76, v77, v253
    v_max3_f32 v253, v78, v79, v253
    v_max3_f32 v253, v80, v81, v253
    v_max3_f32 v253, v82, v83, v253
    v_max3_f32 v253, v84, v85, v253
    v_max3_f32 v253, v86, v87, v253
    v_max3_f32 v253, v88, v89, v253
    v_max_f32 v253, v253, v250
    v_mov_b32 v251, v253
    s_nop 1
    v_permlane32_swap_b32 v253, v251
    v_max_f32 v253, v253, v251
    v_and_b32 v3, 0xffff0000, v253
    v_sub_f32 v251, v253, v3
    v_and_b32 v4, 0xffff0000, v251
    v_sub_f32 v251, v251, v4
    v_lshrrev_b32 v3, 16, v3
    v_or_b32 v246, v3, v4
    v_lshrrev_b32 v247, 16, v251
    v_cndmask_b32 v240, v246, v238, s[88:89]
    v_cndmask_b32 v241, v247, v239, s[88:89]
    v_cndmask_b32 v242, v246, v238, s[90:91]
    v_cndmask_b32 v243, v247, v239, s[90:91]
    v_cndmask_b32 v244, v246, v238, s[92:93]
    v_cndmask_b32 v245, v247, v239, s[92:93]
    v_mfma_f32_32x32x8bf16_1k v[110:125], v[46:47], v[240:241], v[110:125]
    v_sub_f32 v248, v248, v249
    v_sub_f32 v45, v45, v253
    v_exp_f32 v248, v248
    v_exp_f32 v45, v45
    v_mul_f32 v222, v222, v248
    v_mul_f32 v223, v223, v248
    v_mul_f32 v224, v224, v248
    v_mul_f32 v225, v225, v248
    v_mul_f32 v226, v226, v248
    v_mul_f32 v227, v227, v248
    v_mul_f32 v228, v228, v248
    v_mul_f32 v229, v229, v248
    v_mul_f32 v230, v230, v248
    v_mul_f32 v231, v231, v248
    v_mul_f32 v232, v232, v248
    v_mul_f32 v233, v233, v248
    v_mul_f32 v234, v234, v248
    v_exp_f32 v94, v94
    v_exp_f32 v95, v95
    buffer_load_dwordx4 a[36:39], v5, s[8:11], s42 offen offset:0 sc1
    v_exp_f32 v96, v96
    v_exp_f32 v97, v97
    v_exp_f32 v98, v98
    v_exp_f32 v99, v99
    v_exp_f32 v100, v100
    s_add_u32 s42, s21, 40960
    buffer_load_dwordx4 a[40:43], v2, s[8:11], s42 offen offset:0 sc1
    v_exp_f32 v101, v101
    v_exp_f32 v102, v102
    v_exp_f32 v103, v103
    v_exp_f32 v104, v104
    v_exp_f32_e64 v105, v105
    v_mfma_f32_32x32x8bf16_1k v[126:141], v[46:47], v[242:243], v[126:141]
    buffer_load_dwordx4 a[44:47], v2, s[8:11], s42 offen offset:1024 sc1
    buffer_load_dwordx4 a[48:51], v2, s[8:11], s42 offen offset:2048 sc1
    v_exp_f32 v106, v106
    v_exp_f32 v107, v107
    v_exp_f32 v108, v108
    v_exp_f32 v109, v109
    v_cvt_pk_bf16_f32 v94, v94, v95
    v_cvt_pk_bf16_f32 v95, v96, v97
    v_cvt_pk_bf16_f32 v96, v98, v99
    v_cvt_pk_bf16_f32 v97, v100, v101
    v_cvt_pk_bf16_f32 v98, v102, v103
    v_cvt_pk_bf16_f32 v99, v104, v105
    v_cvt_pk_bf16_f32 v100, v106, v107
    v_cvt_pk_bf16_f32 v101, v108, v109
    v_mul_f32 v60, v60, v45
    v_mul_f32 v61, v61, v45
    v_mul_f32 v62, v62, v45
    v_mul_f32 v63, v63, v45
    v_mul_f32 v64, v64, v45
    v_mul_f32 v65, v65, v45
    v_mul_f32 v66, v66, v45
    v_mul_f32 v67, v67, v45
    v_mul_f32 v68, v68, v45
    v_mul_f32 v69, v69, v45
    v_mul_f32 v70, v70, v45
    v_mul_f32 v71, v71, v45
    v_mul_f32 v72, v72, v45
    v_exp_f32 v110, v110
    v_exp_f32 v111, v111
    s_waitcnt lgkmcnt(4)
    v_mfma_f32_32x32x16_bf16 v[222:237], a[100:103], v[94:97], v[222:237]
    ds_read_b64_tr_b16 a[116:117], v41 offset:0
    buffer_load_dwordx4 a[52:55], v2, s[8:11], s42 offen offset:3072 sc1
    v_exp_f32 v112, v112
    v_exp_f32 v113, v113
    v_exp_f32 v114, v114
    v_exp_f32 v115, v115
    v_exp_f32_e64 v116, v116
    v_mfma_f32_32x32x16_bf16 v[222:237], a[104:107], v[98:101], v[222:237]
    ds_read_b64_tr_b16 a[118:119], v41 offset:384
    ds_read_b64_tr_b16 a[120:121], v41 offset:768
    buffer_load_dwordx4 a[56:59], v5, s[8:11], s42 offen offset:0 sc1
    v_exp_f32 v117, v117
    v_exp_f32 v118, v118
    v_exp_f32 v119, v119
    v_exp_f32 v120, v120
    v_exp_f32_e64 v121, v121
    v_mfma_f32_32x32x8bf16_1k v[142:157], v[46:47], v[244:245], v[142:157]
    ds_read_b64_tr_b16 a[122:123], v41 offset:1152
    s_add_u32 s42, s21, 61440
    buffer_load_dwordx4 a[60:63], v2, s[8:11], s42 offen offset:0 sc1
    buffer_load_dwordx4 a[64:67], v2, s[8:11], s42 offen offset:1024 sc1
    v_exp_f32 v122, v122
    v_exp_f32 v123, v123
    v_exp_f32 v124, v124
    v_exp_f32 v125, v125
    v_cvt_pk_bf16_f32 v110, v110, v111
    v_cvt_pk_bf16_f32 v111, v112, v113
    v_cvt_pk_bf16_f32 v112, v114, v115
    v_cvt_pk_bf16_f32 v113, v116, v117
    v_cvt_pk_bf16_f32 v114, v118, v119
    v_cvt_pk_bf16_f32 v115, v120, v121
    v_cvt_pk_bf16_f32 v116, v122, v123
    v_cvt_pk_bf16_f32 v117, v124, v125
    s_cmp_eq_u32 s40, 0
    s_cbranch_scc1 Lsw11
Lsr11:
    v_exp_f32 v126, v126
    v_exp_f32_e64 v127, v127
    s_waitcnt lgkmcnt(4)
    v_mfma_f32_32x32x16_bf16 v[222:237], a[108:111], v[110:113], v[222:237]
    ds_read_b64_tr_b16 a[100:101], v42 offset:0
    buffer_load_dwordx4 a[68:71], v2, s[8:11], s42 offen offset:2048 sc1
    v_exp_f32 v128, v128
    v_exp_f32 v129, v129
    v_exp_f32 v130, v130
    v_exp_f32 v131, v131
    v_exp_f32_e64 v132, v132
    v_mfma_f32_32x32x16_bf16 v[222:237], a[112:115], v[114:117], v[222:237]
    ds_read_b64_tr_b16 a[102:103], v42 offset:384
    ds_read_b64_tr_b16 a[104:105], v42 offset:768
    buffer_load_dwordx4 a[72:75], v2, s[8:11], s42 offen offset:3072 sc1
    v_exp_f32 v133, v133
    v_exp_f32 v134, v134
    v_exp_f32 v135, v135
    v_exp_f32 v136, v136
    v_exp_f32_e64 v137, v137
    v_mfma_f32_32x32x8bf16_1k v[158:173], v[46:47], v[246:247], v[158:173]
    ds_read_b64_tr_b16 a[106:107], v42 offset:1152
    buffer_load_dwordx4 a[76:79], v5, s[8:11], s42 offen offset:0 sc1
    s_add_u32 s42, s21, 81920
    buffer_load_dwordx4 a[80:83], v2, s[8:11], s42 offen offset:0 sc1
    v_exp_f32 v138, v138
    v_exp_f32 v139, v139
    v_exp_f32 v140, v140
    v_exp_f32 v141, v141
    v_cvt_pk_bf16_f32 v126, v126, v127
    v_cvt_pk_bf16_f32 v127, v128, v129
    v_cvt_pk_bf16_f32 v128, v130, v131
    v_cvt_pk_bf16_f32 v129, v132, v133
    v_cvt_pk_bf16_f32 v130, v134, v135
    v_cvt_pk_bf16_f32 v131, v136, v137
    v_cvt_pk_bf16_f32 v132, v138, v139
    v_cvt_pk_bf16_f32 v133, v140, v141
    s_cmp_eq_u32 s40, 1
    s_cbranch_scc1 Lsw12
Lsr12:
    v_exp_f32 v142, v142
    v_exp_f32_e64 v143, v143
    s_waitcnt lgkmcnt(4)
    v_mfma_f32_32x32x16_bf16 v[222:237], a[116:119], v[126:129], v[222:237]
    ds_read_b64_tr_b16 a[108:109], v43 offset:14336
    buffer_load_dwordx4 a[84:87], v2, s[8:11], s42 offen offset:1024 sc1
    v_exp_f32 v144, v144
    v_exp_f32 v145, v145
    v_exp_f32 v146, v146
    v_exp_f32 v147, v147
    v_exp_f32_e64 v148, v148
    v_mfma_f32_32x32x16_bf16 v[222:237], a[120:123], v[130:133], v[222:237]
    ds_read_b64_tr_b16 a[110:111], v43 offset:14720
    ds_read_b64_tr_b16 a[112:113], v43 offset:15104
    buffer_load_dwordx4 a[88:91], v2, s[8:11], s42 offen offset:2048 sc1
    v_exp_f32 v149, v149
    v_exp_f32 v150, v150
    v_exp_f32 v151, v151
    v_exp_f32 v152, v152
    v_exp_f32_e64 v153, v153
    v_mfma_f32_32x32x8bf16_1k v[174:189], v[46:47], v[246:247], v[174:189]
    ds_read_b64_tr_b16 a[114:115], v43 offset:15488
    buffer_load_dwordx4 a[92:95], v2, s[8:11], s42 offen offset:3072 sc1
    buffer_load_dwordx4 a[96:99], v5, s[8:11], s42 offen offset:0 sc1
    v_exp_f32 v154, v154
    v_exp_f32 v155, v155
    v_exp_f32 v156, v156
    v_exp_f32 v157, v157
    v_cvt_pk_bf16_f32 v142, v142, v143
    v_cvt_pk_bf16_f32 v143, v144, v145
    v_cvt_pk_bf16_f32 v144, v146, v147
    v_cvt_pk_bf16_f32 v145, v148, v149
    v_cvt_pk_bf16_f32 v146, v150, v151
    v_cvt_pk_bf16_f32 v147, v152, v153
    v_cvt_pk_bf16_f32 v148, v154, v155
    v_cvt_pk_bf16_f32 v149, v156, v157
    s_cmp_eq_u32 s40, 2
    s_cbranch_scc1 Lsw13
Lsr13:
    v_exp_f32 v158, v158
    v_exp_f32_e64 v159, v159
    s_waitcnt lgkmcnt(4)
    v_mfma_f32_32x32x16_bf16 v[222:237], a[100:103], v[142:145], v[222:237]
    ds_read_b64_tr_b16 a[116:117], v43 offset:17920
    buffer_load_dwordx4 a[160:163], v2, s[8:11], s25 offen offset:0 sc1
    v_exp_f32 v160, v160
    v_exp_f32 v161, v161
    v_exp_f32 v162, v162
    v_exp_f32 v163, v163
    v_exp_f32_e64 v164, v164
    v_mfma_f32_32x32x16_bf16 v[222:237], a[104:107], v[146:149], v[222:237]
    ds_read_b64_tr_b16 a[118:119], v43 offset:18304
    ds_read_b64_tr_b16 a[120:121], v43 offset:18688
    buffer_load_dwordx4 a[164:167], v2, s[8:11], s25 offen offset:1024 sc1
    v_exp_f32 v165, v165
    v_exp_f32 v166, v166
    v_exp_f32 v167, v167
    v_exp_f32 v168, v168
    v_exp_f32_e64 v169, v169
    v_mfma_f32_32x32x8bf16_1k v[190:205], v[46:47], v[246:247], v[190:205]
    ds_read_b64_tr_b16 a[122:123], v43 offset:19072
    buffer_load_dwordx4 a[168:171], v2, s[8:11], s25 offen offset:2048 sc1
    buffer_load_dwordx4 a[172:175], v2, s[8:11], s25 offen offset:3072 sc1
    v_exp_f32 v170, v170
    v_exp_f32 v171, v171
    v_exp_f32 v172, v172
    v_exp_f32 v173, v173
    v_cvt_pk_bf16_f32 v158, v158, v159
    v_cvt_pk_bf16_f32 v159, v160, v161
    v_cvt_pk_bf16_f32 v160, v162, v163
    v_cvt_pk_bf16_f32 v161, v164, v165
    v_cvt_pk_bf16_f32 v162, v166, v167
    v_cvt_pk_bf16_f32 v163, v168, v169
    v_cvt_pk_bf16_f32 v164, v170, v171
    v_cvt_pk_bf16_f32 v165, v172, v173
    s_cmp_eq_u32 s40, 3
    s_cbranch_scc1 Lsw14
Lsr14:
    v_exp_f32 v174, v174
    v_exp_f32_e64 v175, v175
    s_waitcnt lgkmcnt(4)
    v_mfma_f32_32x32x16_bf16 v[222:237], a[108:111], v[158:161], v[222:237]
    ds_read_b64_tr_b16 a[100:101], v43 offset:21504
    buffer_load_dwordx4 a[176:179], v5, s[8:11], s25 offen offset:0 sc1
    v_exp_f32 v176, v176
    v_exp_f32 v177, v177
    v_exp_f32 v178, v178
    v_exp_f32 v179, v179
    v_exp_f32_e64 v180, v180
    v_mfma_f32_32x32x16_bf16 v[222:237], a[112:115], v[162:165], v[222:237]
    ds_read_b64_tr_b16 a[102:103], v43 offset:21888
    ds_read_b64_tr_b16 a[104:105], v43 offset:22272
    buffer_load_dwordx4 a[180:183], v2, s[8:11], s26 offen offset:0 sc1
    v_exp_f32 v181, v181
    v_exp_f32 v182, v182
    v_exp_f32 v183, v183
    v_exp_f32 v184, v184
    v_exp_f32_e64 v185, v185
    v_mfma_f32_32x32x8bf16_1k v[206:221], v[46:47], v[246:247], v[206:221]
    ds_read_b64_tr_b16 a[106:107], v43 offset:22656
    buffer_load_dwordx4 a[184:187], v2, s[8:11], s26 offen offset:1024 sc1
    v_exp_f32 v186, v186
    v_exp_f32 v187, v187
    v_exp_f32 v188, v188
    v_exp_f32 v189, v189
    v_cvt_pk_bf16_f32 v174, v174, v175
    v_cvt_pk_bf16_f32 v175, v176, v177
    v_cvt_pk_bf16_f32 v176, v178, v179
    v_cvt_pk_bf16_f32 v177, v180, v181
    v_cvt_pk_bf16_f32 v178, v182, v183
    v_cvt_pk_bf16_f32 v179, v184, v185
    v_cvt_pk_bf16_f32 v180, v186, v187
    v_cvt_pk_bf16_f32 v181, v188, v189
    v_rcp_f32 v72, v72
    s_nop 0
    v_mul_f32 v60, v60, v72
    v_mul_f32 v61, v61, v72
    v_mul_f32 v62, v62, v72
    v_mul_f32 v63, v63, v72
    v_mul_f32 v64, v64, v72
    v_mul_f32 v65, v65, v72
    v_mul_f32 v66, v66, v72
    v_mul_f32 v67, v67, v72
    v_mul_f32 v68, v68, v72
    v_mul_f32 v69, v69, v72
    v_mul_f32 v70, v70, v72
    v_mul_f32 v71, v71, v72
    v_cvt_pk_bf16_f32 v60, v60, v61
    v_cvt_pk_bf16_f32 v61, v62, v63
    v_cvt_pk_bf16_f32 v62, v64, v65
    v_cvt_pk_bf16_f32 v63, v66, v67
    v_cvt_pk_bf16_f32 v64, v68, v69
    v_cvt_pk_bf16_f32 v65, v70, v71
    buffer_store_dwordx4 v[60:63], v90, s[8:11], s54 offen sc1
    s_mov_b32 exec_hi, 0
    buffer_store_dwordx2 v[64:65], v91, s[8:11], s54 offen sc1
    s_mov_b32 exec_hi, -1
    v_exp_f32 v190, v190
    v_exp_f32_e64 v191, v191
    s_waitcnt lgkmcnt(4)
    v_mfma_f32_32x32x16_bf16 v[222:237], a[116:119], v[174:177], v[222:237]
    ds_read_b64_tr_b16 a[108:109], v43 offset:25088
    buffer_load_dwordx4 a[188:191], v2, s[8:11], s26 offen offset:2048 sc1
    v_exp_f32 v192, v192
    v_exp_f32 v193, v193
    v_exp_f32 v194, v194
    v_exp_f32 v195, v195
    v_exp_f32_e64 v196, v196
    v_mfma_f32_32x32x16_bf16 v[222:237], a[120:123], v[178:181], v[222:237]
    ds_read_b64_tr_b16 a[110:111], v43 offset:25472
    ds_read_b64_tr_b16 a[112:113], v43 offset:25856
    buffer_load_dwordx4 a[192:195], v2, s[8:11], s26 offen offset:3072 sc1
    v_exp_f32 v197, v197
    v_exp_f32 v198, v198
    v_exp_f32 v199, v199
    v_exp_f32 v200, v200
    v_exp_f32_e64 v201, v201
    v_mfma_f32_32x32x8bf16_1k v[74:89], v[46:47], v[246:247], v[74:89]
    ds_read_b64_tr_b16 a[114:115], v43 offset:26240
    buffer_load_dwordx4 a[196:199], v5, s[8:11], s26 offen offset:0 sc1
    v_exp_f32 v202, v202
    v_exp_f32 v203, v203
    v_exp_f32 v204, v204
    v_exp_f32 v205, v205
    v_cvt_pk_bf16_f32 v190, v190, v191
    v_cvt_pk_bf16_f32 v191, v192, v193
    v_cvt_pk_bf16_f32 v192, v194, v195
    v_cvt_pk_bf16_f32 v193, v196, v197
    v_cvt_pk_bf16_f32 v194, v198, v199
    v_cvt_pk_bf16_f32 v195, v200, v201
    v_cvt_pk_bf16_f32 v196, v202, v203
    v_cvt_pk_bf16_f32 v197, v204, v205
    v_exp_f32 v206, v206
    v_exp_f32 v207, v207
    s_waitcnt lgkmcnt(4)
    v_mfma_f32_32x32x16_bf16 v[222:237], a[100:103], v[190:193], v[222:237]
    ds_read_b64_tr_b16 a[116:117], v43 offset:28672
    v_exp_f32 v208, v208
    v_exp_f32 v209, v209
    v_exp_f32 v210, v210
    v_exp_f32 v211, v211
    v_exp_f32 v212, v212
    v_mfma_f32_32x32x16_bf16 v[222:237], a[104:107], v[194:197], v[222:237]
    ds_read_b64_tr_b16 a[118:119], v43 offset:29056
    ds_read_b64_tr_b16 a[120:121], v43 offset:29440
    v_exp_f32 v213, v213
    v_exp_f32 v214, v214
    v_exp_f32 v215, v215
    v_exp_f32 v216, v216
    v_exp_f32_e64 v217, v217
    ds_read_b64_tr_b16 a[122:123], v43 offset:29824
    v_exp_f32 v218, v218
    v_exp_f32 v219, v219
    v_exp_f32 v220, v220
    v_exp_f32 v221, v221
    v_cvt_pk_bf16_f32 v206, v206, v207
    v_cvt_pk_bf16_f32 v207, v208, v209
    v_cvt_pk_bf16_f32 v208, v210, v211
    v_cvt_pk_bf16_f32 v209, v212, v213
    v_cvt_pk_bf16_f32 v210, v214, v215
    v_cvt_pk_bf16_f32 v211, v216, v217
    v_cvt_pk_bf16_f32 v212, v218, v219
    v_cvt_pk_bf16_f32 v213, v220, v221
    v_exp_f32 v74, v74
    v_exp_f32 v75, v75
    s_waitcnt lgkmcnt(4)
    v_mfma_f32_32x32x16_bf16 v[222:237], a[108:111], v[206:209], v[222:237]
    v_exp_f32 v76, v76
    v_exp_f32 v77, v77
    v_exp_f32 v78, v78
    v_exp_f32 v79, v79
    v_exp_f32 v80, v80
    v_mfma_f32_32x32x16_bf16 v[222:237], a[112:115], v[210:213], v[222:237]
    v_exp_f32 v81, v81
    v_exp_f32 v82, v82
    v_exp_f32 v83, v83
    v_exp_f32 v84, v84
    v_exp_f32 v85, v85
    v_exp_f32 v86, v86
    v_exp_f32 v87, v87
    v_exp_f32 v88, v88
    v_exp_f32_e64 v89, v89
    v_cvt_pk_bf16_f32 v74, v74, v75
    v_cvt_pk_bf16_f32 v75, v76, v77
    v_cvt_pk_bf16_f32 v76, v78, v79
    v_cvt_pk_bf16_f32 v77, v80, v81
    v_cvt_pk_bf16_f32 v78, v82, v83
    v_cvt_pk_bf16_f32 v79, v84, v85
    v_cvt_pk_bf16_f32 v80, v86, v87
    v_cvt_pk_bf16_f32 v81, v88, v89
    s_waitcnt lgkmcnt(2)
    v_mfma_f32_32x32x16_bf16 v[222:237], a[116:119], v[74:77], v[222:237]
    s_waitcnt lgkmcnt(0)
    v_mfma_f32_32x32x16_bf16 v[222:237], a[120:123], v[78:81], v[222:237]
    s_nop 11
    v_rcp_f32 v234, v234
    s_nop 0
    v_mul_f32 v222, v222, v234
    v_mul_f32 v223, v223, v234
    v_mul_f32 v224, v224, v234
    v_mul_f32 v225, v225, v234
    v_mul_f32 v226, v226, v234
    v_mul_f32 v227, v227, v234
    v_mul_f32 v228, v228, v234
    v_mul_f32 v229, v229, v234
    v_mul_f32 v230, v230, v234
    v_mul_f32 v231, v231, v234
    v_mul_f32 v232, v232, v234
    v_mul_f32_e64 v233, v233, v234
    v_cvt_pk_bf16_f32 v222, v222, v223
    v_cvt_pk_bf16_f32 v223, v224, v225
    v_cvt_pk_bf16_f32 v224, v226, v227
    v_cvt_pk_bf16_f32 v225, v228, v229
    v_cvt_pk_bf16_f32 v226, v230, v231
    v_cvt_pk_bf16_f32 v227, v232, v233
    buffer_store_dwordx4 v[222:225], v90, s[8:11], s23 offen sc1
    s_mov_b32 exec_hi, 0
    buffer_store_dwordx2 v[226:227], v91, s[8:11], s23 offen sc1
    s_mov_b32 exec_hi, -1
    v_lshrrev_b32 v3, 4, v1
    v_and_b32 v4, 15, v1
    v_mul_u32_u24 v213, 1280, v4
    v_lshl_add_u32 v212, v3, 4, v213
    v_lshl_add_u32 v213, v3, 3, v213
    v_lshlrev_b32 v215, 4, v4
    v_lshlrev_b32 v219, 3, v4
    v_lshl_add_u32 v214, v3, 9, v215
    v_lshlrev_b32 v216, 5, v3
    v_lshlrev_b32 v217, 4, v3
    v_lshrrev_b32_e64 v4, 1, v3
    v_lshl_add_u32 v215, v4, 9, v215
    v_lshl_add_u32 v157, v3, 8, v219
    s_lshl_b32 s51, s19, 2
    s_add_u32 s51, s51, s40
    s_lshr_b32 s49, s51, 1
    s_mul_i32 s51, s51, 20480
    s_mul_i32 s48, s18, 160
    s_add_u32 s51, s51, s48
    v_add_u32 v216, 159744, v216
    v_add_u32 v217, 159744, v217
    s_mul_i32 s0, s17, 7
    s_add_u32 s48, s0, 6
    s_bitcmp0_b32 s17, 0
    s_cselect_b32 s0, s48, s0
    s_cmp_lt_u32 s17, 12
    s_cselect_b32 s0, s0, 0
    v_lshrrev_b32_e64 v3, 5, v0
    v_add_u32_e64 v241, s20, v3
    v_mov_b32_e64 v4, s0
    v_cmp_lt_u32 vcc, 5, v3
    v_lshlrev_b32_e64 v242, 3, v1
    v_lshlrev_b32_e64 v243, 10, v3
    v_cndmask_b32 v241, v241, v4, vcc
    v_lshlrev_b32_e64 v241, 8, v241
    v_and_b32 v4, 31, v0
    v_lshl_add_u32 v241, v4, 3, v241
    v_lshl_add_u32 v243, v4, 4, v243
    v_add_u32 v243, 143360, v243
    s_waitcnt vmcnt(0)
    s_mov_b64 exec, 0xf
    buffer_store_dword v6, v7, s[8:11], s58 offen offset:0 sc1
    s_mov_b64 exec, -1
    s_mov_b64 exec, 0xf
    buffer_store_dword v6, v7, s[8:11], s60 offen offset:0 sc1
    s_mov_b64 exec, -1
    v_bfe_u32 v3, v1, 3, 1
    v_lshlrev_b32 v3, 7, v3
    v_and_b32_e64 v4, 7, v1
    v_lshl_add_u32 v3, v4, 3, v3
    s_lshl_b32 s46, s19, 2
    s_add_u32 s46, s46, s40
    s_lshl_b32 s46, s46, 8
    s_add_u32 s46, s46, 0x80000
    buffer_load_dword v152, v3, s[8:11], s46 offen sc1
    buffer_load_dwordx4 v[178:181], v212, s[12:15], s51 offen
    buffer_load_dwordx4 v[182:185], v212, s[12:15], s51 offen offset:64
    buffer_load_dwordx2 v[186:187], v213, s[12:15], s51 offen offset:128
    ds_read_b128 v[158:161], v216 offset:0
    ds_read_b128 v[162:165], v216 offset:16
    ds_read_b128 v[166:169], v216 offset:128
    ds_read_b128 v[170:173], v216 offset:144
    ds_read_b128 v[174:177], v217 offset:256
    ds_read_b128 v[222:225], v216 offset:320
    ds_read_b128 v[226:229], v216 offset:336
    ds_read_b128 v[230:233], v216 offset:448
    ds_read_b128 v[234:237], v216 offset:464
    ds_read_b128 v[248:251], v217 offset:576
    v_lshlrev_b32 v245, 4, v1
    s_lshl_b32 s66, s49, 9
    s_add_u32 s66, s66, 0x2f40000
    s_lshl_b32 s41, s19, 2
    s_add_u32 s41, s41, s40
    s_mul_i32 s41, s41, 20480
    s_add_u32 s41, s41, 0xd00000
    s_add_u32 s48, s40, 0
    s_and_b32 s48, s48, 3
    s_mul_i32 s48, s48, 55296
    v_add_u32 v208, s48, v2
    s_add_u32 s48, s40, 1
    s_and_b32 s48, s48, 3
    s_mul_i32 s48, s48, 55296
    v_add_u32 v209, s48, v2
    s_add_u32 s48, s40, 2
    buffer_load_dwordx4 a[200:203], v2, s[8:11], s27 offen offset:0 sc1
    s_and_b32 s48, s48, 3
    s_mul_i32 s48, s48, 55296
    v_add_u32_e64 v210, s48, v2
    s_add_u32 s48, s40, 3
    s_and_b32 s48, s48, 3
    s_mul_i32 s48, s48, 55296
    v_add_u32_e64 v211, s48, v2
    v_add_u32_e64 v246, s44, v2
    v_add_u32 v247, 61440, v246
    s_mul_i32 s52, s49, 40960
    s_mul_i32 s48, s18, 5120
    s_add_u32 s52, s52, s48
    s_and_b32 s46, s40, 1
    s_lshl_b32 s48, s46, 8
    s_add_u32 s52, s52, s48
    buffer_load_dwordx4 a[204:207], v2, s[8:11], s27 offen offset:1024 sc1
    s_add_u32 s52, s52, 0x1000000
    s_add_u32 s53, s52, 4096
    s_lshl_b32 s61, s49, 11
    s_lshl_b32 s48, s18, 8
    s_add_u32 s61, s61, s48
    s_lshl_b32 s48, s46, 7
    s_add_u32 s61, s61, s48
    s_add_u32 s61, s61, 0x20000
    s_lshl_b32 s62, s49, 4
    s_lshl_b32 s48, s18, 1
    s_add_u32 s62, s62, s48
    s_add_u32 s62, s62, s46
    s_lshl_b32 s62, s62, 7
    s_add_u32 s62, s62, 0x2fc0000
    s_add_u32 s48, s40, 1
    buffer_load_dwordx4 a[208:211], v2, s[8:11], s27 offen offset:2048 sc1
    s_and_b32 s48, s48, 3
    s_mul_i32 s48, s48, 15360
    s_add_u32 s48, s48, 0
    v_add_u32 v220, s48, v2
    s_add_u32 s48, s40, 2
    s_and_b32 s48, s48, 3
    s_mul_i32 s48, s48, 15360
    s_add_u32 s48, s48, 5120
    v_add_u32 v221, s48, v2
    s_add_u32 s48, s40, 3
    s_and_b32 s48, s48, 3
    s_mul_i32 s48, s48, 15360
    s_add_u32 s48, s48, 10240
    v_add_u32 v238, s48, v2
    s_mul_i32 s48, s40, 15360
    s_add_u32 s48, s48, 0
    buffer_load_dwordx4 a[212:215], v2, s[8:11], s27 offen offset:3072 sc1
    v_add_u32 v218, s48, v2
    s_lshl_b32 s50, s16, 2
    s_add_u32 s50, s50, s40
    s_mul_i32 s1, s50, 40960
    s_add_u32 s1, s1, 0x1000000
    v_add_u32 v239, 61440, v2
    v_add_u32 v240, 122880, v2
    s_cmp_lt_u32 s17, 12
    s_cselect_b32 s3, s21, 0x10000000
    s_mul_i32 s48, s50, 110592
    s_add_u32 s48, s48, 0x1c00000
    s_lshl_b32 s63, s20, 9
    s_add_u32 s63, s63, s48
    s_lshl_b32 s64, s0, 9
    s_add_u32 s64, s64, s48
    s_cmp_lt_u32 s17, 12
    s_cselect_b32 s64, s64, 0x10000000
    buffer_load_dwordx4 a[216:219], v5, s[8:11], s27 offen offset:0 sc1
    s_lshl_b32 s67, s50, 11
    s_add_u32 s67, s67, 0x2fc0000
    s_lshr_b32 s65, s50, 1
    s_lshl_b32 s65, s65, 7
    s_lshl_b32 s48, s46, 4
    s_add_u32 s65, s65, s48
    s_add_u32 s65, s65, s17
    s_lshl_b32 s65, s65, 4
    s_add_u32 s65, s65, 0x2e00000
    v_bfe_u32 v3, v1, 4, 1
    v_mul_u32_u24 v244, 55296, v3
    v_and_b32 v4, 15, v1
    v_lshl_add_u32 v244, v4, 4, v244
    v_lshrrev_b32 v4, 5, v1
    v_lshl_add_u32 v244, v4, 8, v244
    buffer_load_dwordx4 a[220:223], v2, s[8:11], s28 offen offset:0 sc1
    s_barrier
    s_mov_b32 exec_hi, 0x0
    buffer_load_dword v8, v245, s[8:11], s66 offen offset:0 sc1
    s_mov_b64 exec, -1
    s_waitcnt vmcnt(9)
    v_lshlrev_b32 v188, 16, v178
    v_lshlrev_b32 v190, 16, v179
    v_lshlrev_b32 v192, 16, v180
    v_lshlrev_b32 v194, 16, v181
    s_waitcnt vmcnt(8)
    v_lshlrev_b32_e64 v196, 16, v182
    v_lshlrev_b32_e64 v198, 16, v183
    v_lshlrev_b32_e64 v200, 16, v184
    v_lshlrev_b32 v202, 16, v185
    s_waitcnt vmcnt(7)
    v_lshlrev_b32_e64 v204, 16, v186
    v_lshlrev_b32_e64 v206, 16, v187
    v_and_b32 v189, 0xffff0000, v178
    v_and_b32 v191, 0xffff0000, v179
    v_and_b32 v193, 0xffff0000, v180
    v_and_b32 v195, 0xffff0000, v181
    v_and_b32 v197, 0xffff0000, v182
    v_and_b32 v199, 0xffff0000, v183
    v_and_b32 v201, 0xffff0000, v184
    v_and_b32 v203, 0xffff0000, v185
    v_and_b32 v205, 0xffff0000, v186
    v_and_b32 v207, 0xffff0000, v187
    v_pk_add_f32 v[188:189], v[188:189], v[152:153] op_sel_hi:[1,0]
    v_pk_add_f32 v[190:191], v[190:191], v[152:153] op_sel_hi:[1,0]
    v_pk_add_f32 v[192:193], v[192:193], v[152:153] op_sel_hi:[1,0]
    v_pk_add_f32 v[194:195], v[194:195], v[152:153] op_sel_hi:[1,0]
    v_pk_add_f32 v[196:197], v[196:197], v[152:153] op_sel_hi:[1,0]
    v_pk_add_f32 v[198:199], v[198:199], v[152:153] op_sel_hi:[1,0]
    v_pk_add_f32 v[200:201], v[200:201], v[152:153] op_sel_hi:[1,0]
    v_pk_add_f32 v[202:203], v[202:203], v[152:153] op_sel_hi:[1,0]
    v_pk_add_f32 v[204:205], v[204:205], v[152:153] op_sel_hi:[1,0]
    v_pk_add_f32 v[206:207], v[206:207], v[152:153] op_sel_hi:[1,0]
    s_waitcnt vmcnt(0)
    v_cmp_ne_u32_e64 vcc, s45, v8
    s_nop 0
    s_and_b32 vcc_lo, vcc_lo, 0xffffffff
    s_cbranch_scc1 Ls_o
Lr_o:
    buffer_load_dwordx4 v[10:13], v2, s[8:11], s41 offen offset:0 sc1
    buffer_load_dwordx4 v[14:17], v2, s[8:11], s41 offen offset:1024 sc1
    buffer_load_dwordx4 v[18:21], v2, s[8:11], s41 offen offset:2048 sc1
    buffer_load_dwordx4 v[22:25], v2, s[8:11], s41 offen offset:3072 sc1
    s_add_u32 s41, s41, 4096
    buffer_load_dwordx4 v[26:29], v2, s[8:11], s41 offen offset:0 sc1
    buffer_load_dwordx4 v[30:33], v2, s[8:11], s41 offen offset:1024 sc1
    buffer_load_dwordx4 v[34:37], v2, s[8:11], s41 offen offset:2048 sc1
    buffer_load_dwordx4 v[38:41], v2, s[8:11], s41 offen offset:3072 sc1
    s_add_u32 s41, s41, 4096
    buffer_load_dwordx4 v[42:45], v2, s[8:11], s41 offen offset:0 sc1
    s_waitcnt lgkmcnt(0)
    ds_read_b128 v[92:95], v2 offset:0
    ds_read_b128 v[96:99], v2 offset:1024
    ds_read_b128 v[100:103], v2 offset:2048
    ds_read_b128 v[104:107], v2 offset:3072
    ds_read_b128 v[108:111], v2 offset:4096
    ds_read_b128 v[112:115], v2 offset:5120
    v_lshlrev_b32 v245, 7, v1
    s_lshl_b32 s66, s19, 11
    s_add_u32 s66, s66, 0x2e00000
    s_mov_b32 s12, s34
    s_mov_b32 s13, s35
    s_mov_b32 s14, 0x280000
    s_mov_b32 s15, 0x20000
    s_waitcnt vmcnt(8) lgkmcnt(4)
    v_mfma_f32_16x16x32_bf16 v[124:127], v[92:95], v[10:13], 0
    ds_read_b128 v[116:119], v2 offset:6144
    buffer_load_dwordx4 v[46:49], v2, s[8:11], s41 offen offset:1024 sc1
    v_mfma_f32_16x16x32_bf16 v[128:131], v[96:99], v[10:13], 0
    ds_read_b128 v[120:123], v2 offset:7168
    s_waitcnt lgkmcnt(4)
    v_mfma_f32_16x16x32_bf16 v[132:135], v[100:103], v[10:13], 0
    ds_read_b128 v[92:95], v2 offset:8192
    v_mfma_f32_16x16x32_bf16 v[136:139], v[104:107], v[10:13], 0
    ds_read_b128 v[96:99], v2 offset:9216
    s_waitcnt lgkmcnt(4)
    v_mfma_f32_16x16x32_bf16 v[140:143], v[108:111], v[10:13], 0
    ds_read_b128 v[100:103], v2 offset:10240
    s_waitcnt vmcnt(8)
    v_mfma_f32_16x16x32_bf16 v[124:127], v[112:115], v[14:17], v[124:127]
    ds_read_b128 v[104:107], v2 offset:11264
    buffer_load_dwordx4 v[50:53], v2, s[8:11], s41 offen offset:2048 sc1
    s_waitcnt lgkmcnt(4)
    v_mfma_f32_16x16x32_bf16 v[128:131], v[116:119], v[14:17], v[128:131]
    ds_read_b128 v[108:111], v2 offset:12288
    v_mfma_f32_16x16x32_bf16 v[132:135], v[120:123], v[14:17], v[132:135]
    ds_read_b128 v[112:115], v2 offset:13312
    s_waitcnt lgkmcnt(4)
    v_mfma_f32_16x16x32_bf16 v[136:139], v[92:95], v[14:17], v[136:139]
    ds_read_b128 v[116:119], v2 offset:14336
    v_mfma_f32_16x16x32_bf16 v[140:143], v[96:99], v[14:17], v[140:143]
    ds_read_b128 v[120:123], v2 offset:15360
    s_waitcnt vmcnt(8) lgkmcnt(4)
    v_mfma_f32_16x16x32_bf16 v[124:127], v[100:103], v[18:21], v[124:127]
    ds_read_b128 v[92:95], v2 offset:16384
    buffer_load_dwordx4 v[54:57], v2, s[8:11], s41 offen offset:3072 sc1
    v_mfma_f32_16x16x32_bf16 v[128:131], v[104:107], v[18:21], v[128:131]
    ds_read_b128 v[96:99], v2 offset:17408
    s_waitcnt lgkmcnt(4)
    v_mfma_f32_16x16x32_bf16 v[132:135], v[108:111], v[18:21], v[132:135]
    ds_read_b128 v[100:103], v2 offset:18432
    v_mfma_f32_16x16x32_bf16 v[136:139], v[112:115], v[18:21], v[136:139]
    ds_read_b128 v[104:107], v2 offset:19456
    s_waitcnt lgkmcnt(4)
    v_mfma_f32_16x16x32_bf16 v[140:143], v[116:119], v[18:21], v[140:143]
    ds_read_b128 v[108:111], v2 offset:20480
    s_waitcnt vmcnt(8)
    v_mfma_f32_16x16x32_bf16 v[124:127], v[120:123], v[22:25], v[124:127]
    ds_read_b128 v[112:115], v2 offset:21504
    s_add_u32 s41, s41, 4096
    buffer_load_dwordx4 v[58:61], v2, s[8:11], s41 offen offset:0 sc1
    s_waitcnt lgkmcnt(4)
    v_mfma_f32_16x16x32_bf16 v[128:131], v[92:95], v[22:25], v[128:131]
    ds_read_b128 v[116:119], v2 offset:22528
    v_mfma_f32_16x16x32_bf16 v[132:135], v[96:99], v[22:25], v[132:135]
    ds_read_b128 v[120:123], v2 offset:23552
    s_waitcnt lgkmcnt(4)
    v_mfma_f32_16x16x32_bf16 v[136:139], v[100:103], v[22:25], v[136:139]
    ds_read_b128 v[92:95], v2 offset:24576
    v_mfma_f32_16x16x32_bf16 v[140:143], v[104:107], v[22:25], v[140:143]
    ds_read_b128 v[96:99], v2 offset:25600
    s_waitcnt vmcnt(8) lgkmcnt(4)
    v_mfma_f32_16x16x32_bf16 v[124:127], v[108:111], v[26:29], v[124:127]
    ds_read_b128 v[100:103], v2 offset:26624
    buffer_load_dwordx4 v[62:65], v2, s[8:11], s41 offen offset:1024 sc1
    v_mfma_f32_16x16x32_bf16 v[128:131], v[112:115], v[26:29], v[128:131]
    ds_read_b128 v[104:107], v2 offset:27648
    s_waitcnt lgkmcnt(4)
    v_mfma_f32_16x16x32_bf16 v[132:135], v[116:119], v[26:29], v[132:135]
    ds_read_b128 v[108:111], v2 offset:28672
    v_mfma_f32_16x16x32_bf16 v[136:139], v[120:123], v[26:29], v[136:139]
    ds_read_b128 v[112:115], v2 offset:29696
    s_waitcnt lgkmcnt(4)
    v_mfma_f32_16x16x32_bf16 v[140:143], v[92:95], v[26:29], v[140:143]
    ds_read_b128 v[116:119], v2 offset:30720
    s_waitcnt vmcnt(8)
    v_mfma_f32_16x16x32_bf16 v[124:127], v[96:99], v[30:33], v[124:127]
    ds_read_b128 v[120:123], v2 offset:31744
    buffer_load_dwordx4 v[66:69], v2, s[8:11], s41 offen offset:2048 sc1
    s_waitcnt lgkmcnt(4)
    v_mfma_f32_16x16x32_bf16 v[128:131], v[100:103], v[30:33], v[128:131]
    ds_read_b128 v[92:95], v2 offset:32768
    v_mfma_f32_16x16x32_bf16 v[132:135], v[104:107], v[30:33], v[132:135]
    ds_read_b128 v[96:99], v2 offset:33792
    s_waitcnt lgkmcnt(4)
    v_mfma_f32_16x16x32_bf16 v[136:139], v[108:111], v[30:33], v[136:139]
    ds_read_b128 v[100:103], v2 offset:34816
    v_mfma_f32_16x16x32_bf16 v[140:143], v[112:115], v[30:33], v[140:143]
    ds_read_b128 v[104:107], v2 offset:35840
    s_waitcnt vmcnt(8) lgkmcnt(4)
    v_mfma_f32_16x16x32_bf16 v[124:127], v[116:119], v[34:37], v[124:127]
    ds_read_b128 v[108:111], v2 offset:36864
    buffer_load_dwordx4 v[70:73], v2, s[8:11], s41 offen offset:3072 sc1
    v_mfma_f32_16x16x32_bf16 v[128:131], v[120:123], v[34:37], v[128:131]
    ds_read_b128 v[112:115], v2 offset:37888
    s_waitcnt lgkmcnt(4)
    v_mfma_f32_16x16x32_bf16 v[132:135], v[92:95], v[34:37], v[132:135]
    ds_read_b128 v[116:119], v2 offset:38912
    v_mfma_f32_16x16x32_bf16 v[136:139], v[96:99], v[34:37], v[136:139]
    ds_read_b128 v[120:123], v2 offset:39936
    s_waitcnt lgkmcnt(4)
    v_mfma_f32_16x16x32_bf16 v[140:143], v[100:103], v[34:37], v[140:143]
    ds_read_b128 v[92:95], v2 offset:40960
    s_waitcnt vmcnt(8)
    v_mfma_f32_16x16x32_bf16 v[124:127], v[104:107], v[38:41], v[124:127]
    ds_read_b128 v[96:99], v2 offset:41984
    s_add_u32 s41, s41, 4096
    buffer_load_dwordx2 v[74:75], v157, s[8:11], s41 offen offset:0 sc1
    buffer_load_dwordx2 v[76:77], v157, s[8:11], s41 offen offset:128 sc1
    s_waitcnt lgkmcnt(4)
    v_mfma_f32_16x16x32_bf16 v[128:131], v[108:111], v[38:41], v[128:131]
    ds_read_b128 v[100:103], v2 offset:43008
    v_mfma_f32_16x16x32_bf16 v[132:135], v[112:115], v[38:41], v[132:135]
    ds_read_b128 v[104:107], v2 offset:44032
    s_waitcnt lgkmcnt(4)
    v_mfma_f32_16x16x32_bf16 v[136:139], v[116:119], v[38:41], v[136:139]
    ds_read_b128 v[108:111], v2 offset:45056
    v_mfma_f32_16x16x32_bf16 v[140:143], v[120:123], v[38:41], v[140:143]
    ds_read_b128 v[112:115], v2 offset:46080
    s_waitcnt vmcnt(9) lgkmcnt(4)
    v_mfma_f32_16x16x32_bf16 v[124:127], v[92:95], v[42:45], v[124:127]
    ds_read_b128 v[116:119], v2 offset:47104
    buffer_load_dwordx2 v[78:79], v157, s[8:11], s41 offen offset:1024 sc1
    buffer_load_dwordx2 v[80:81], v157, s[8:11], s41 offen offset:1152 sc1
    v_mfma_f32_16x16x32_bf16 v[128:131], v[96:99], v[42:45], v[128:131]
    ds_read_b128 v[120:123], v2 offset:48128
    s_waitcnt lgkmcnt(4)
    v_mfma_f32_16x16x32_bf16 v[132:135], v[100:103], v[42:45], v[132:135]
    ds_read_b128 v[92:95], v2 offset:49152
    v_mfma_f32_16x16x32_bf16 v[136:139], v[104:107], v[42:45], v[136:139]
    ds_read_b128 v[96:99], v2 offset:50176
    s_waitcnt lgkmcnt(4)
    v_mfma_f32_16x16x32_bf16 v[140:143], v[108:111], v[42:45], v[140:143]
    ds_read_b128 v[100:103], v2 offset:51200
    s_waitcnt vmcnt(10)
    v_mfma_f32_16x16x32_bf16 v[124:127], v[112:115], v[46:49], v[124:127]
    ds_read_b128 v[104:107], v2 offset:52224
    buffer_load_dwordx2 v[82:83], v157, s[8:11], s41 offen offset:2048 sc1
    buffer_load_dwordx2 v[84:85], v157, s[8:11], s41 offen offset:2176 sc1
    s_waitcnt lgkmcnt(4)
    v_mfma_f32_16x16x32_bf16 v[128:131], v[116:119], v[46:49], v[128:131]
    ds_read_b128 v[108:111], v2 offset:53248
    v_mfma_f32_16x16x32_bf16 v[132:135], v[120:123], v[46:49], v[132:135]
    ds_read_b128 v[112:115], v2 offset:54272
    s_waitcnt lgkmcnt(4)
    v_mfma_f32_16x16x32_bf16 v[136:139], v[92:95], v[46:49], v[136:139]
    ds_read_b128 v[116:119], v2 offset:55296
    v_mfma_f32_16x16x32_bf16 v[140:143], v[96:99], v[46:49], v[140:143]
    ds_read_b128 v[120:123], v2 offset:56320
    s_waitcnt vmcnt(11) lgkmcnt(4)
    v_mfma_f32_16x16x32_bf16 v[124:127], v[100:103], v[50:53], v[124:127]
    ds_read_b128 v[92:95], v2 offset:57344
    buffer_load_dwordx2 v[86:87], v157, s[8:11], s41 offen offset:3072 sc1
    buffer_load_dwordx2 v[88:89], v157, s[8:11], s41 offen offset:3200 sc1
    v_mfma_f32_16x16x32_bf16 v[128:131], v[104:107], v[50:53], v[128:131]
    ds_read_b128 v[96:99], v2 offset:58368
    s_waitcnt lgkmcnt(4)
    v_mfma_f32_16x16x32_bf16 v[132:135], v[108:111], v[50:53], v[132:135]
    ds_read_b128 v[100:103], v2 offset:59392
    v_mfma_f32_16x16x32_bf16 v[136:139], v[112:115], v[50:53], v[136:139]
    ds_read_b128 v[104:107], v2 offset:60416
    s_waitcnt lgkmcnt(4)
    v_mfma_f32_16x16x32_bf16 v[140:143], v[116:119], v[50:53], v[140:143]
    ds_read_b128 v[108:111], v239 offset:0
    s_waitcnt vmcnt(12)
    v_mfma_f32_16x16x32_bf16 v[124:127], v[120:123], v[54:57], v[124:127]
    ds_read_b128 v[112:115], v239 offset:1024
    buffer_load_dwordx4 a[224:227], v2, s[8:11], s28 offen offset:1024 sc1
    s_waitcnt lgkmcnt(4)
    v_mfma_f32_16x16x32_bf16 v[128:131], v[92:95], v[54:57], v[128:131]
    ds_read_b128 v[116:119], v239 offset:2048
    v_mfma_f32_16x16x32_bf16 v[132:135], v[96:99], v[54:57], v[132:135]
    ds_read_b128 v[120:123], v239 offset:3072
    s_waitcnt lgkmcnt(4)
    v_mfma_f32_16x16x32_bf16 v[136:139], v[100:103], v[54:57], v[136:139]
    ds_read_b128 v[92:95], v239 offset:4096
    v_mfma_f32_16x16x32_bf16 v[140:143], v[104:107], v[54:57], v[140:143]
    ds_read_b128 v[96:99], v239 offset:5120
    s_waitcnt vmcnt(12) lgkmcnt(4)
    v_mfma_f32_16x16x32_bf16 v[124:127], v[108:111], v[58:61], v[124:127]
    ds_read_b128 v[100:103], v239 offset:6144
    buffer_load_dwordx4 a[228:231], v2, s[8:11], s28 offen offset:2048 sc1
    v_mfma_f32_16x16x32_bf16 v[128:131], v[112:115], v[58:61], v[128:131]
    ds_read_b128 v[104:107], v239 offset:7168
    s_waitcnt lgkmcnt(4)
    v_mfma_f32_16x16x32_bf16 v[132:135], v[116:119], v[58:61], v[132:135]
    ds_read_b128 v[108:111], v239 offset:8192
    v_mfma_f32_16x16x32_bf16 v[136:139], v[120:123], v[58:61], v[136:139]
    ds_read_b128 v[112:115], v239 offset:9216
    s_waitcnt lgkmcnt(4)
    v_mfma_f32_16x16x32_bf16 v[140:143], v[92:95], v[58:61], v[140:143]
    ds_read_b128 v[116:119], v239 offset:10240
    s_waitcnt vmcnt(12)
    v_mfma_f32_16x16x32_bf16 v[124:127], v[96:99], v[62:65], v[124:127]
    ds_read_b128 v[120:123], v239 offset:11264
    buffer_load_dwordx4 a[232:235], v2, s[8:11], s28 offen offset:3072 sc1
    s_waitcnt lgkmcnt(4)
    v_mfma_f32_16x16x32_bf16 v[128:131], v[100:103], v[62:65], v[128:131]
    ds_read_b128 v[92:95], v239 offset:12288
    v_mfma_f32_16x16x32_bf16 v[132:135], v[104:107], v[62:65], v[132:135]
    ds_read_b128 v[96:99], v239 offset:13312
    s_waitcnt lgkmcnt(4)
    v_mfma_f32_16x16x32_bf16 v[136:139], v[108:111], v[62:65], v[136:139]
    ds_read_b128 v[100:103], v239 offset:14336
    v_mfma_f32_16x16x32_bf16 v[140:143], v[112:115], v[62:65], v[140:143]
    ds_read_b128 v[104:107], v239 offset:15360
    s_waitcnt vmcnt(12) lgkmcnt(4)
    v_mfma_f32_16x16x32_bf16 v[124:127], v[116:119], v[66:69], v[124:127]
    ds_read_b128 v[108:111], v239 offset:16384
    buffer_load_dwordx4 a[236:239], v5, s[8:11], s28 offen offset:0 sc1
    v_mfma_f32_16x16x32_bf16 v[128:131], v[120:123], v[66:69], v[128:131]
    ds_read_b128 v[112:115], v239 offset:17408
    s_waitcnt lgkmcnt(4)
    v_mfma_f32_16x16x32_bf16 v[132:135], v[92:95], v[66:69], v[132:135]
    ds_read_b128 v[116:119], v239 offset:18432
    v_mfma_f32_16x16x32_bf16 v[136:139], v[96:99], v[66:69], v[136:139]
    ds_read_b128 v[120:123], v239 offset:19456
    s_waitcnt lgkmcnt(4)
    v_mfma_f32_16x16x32_bf16 v[140:143], v[100:103], v[66:69], v[140:143]
    ds_read_b128 v[92:95], v239 offset:20480
    s_waitcnt vmcnt(12)
    v_mfma_f32_16x16x32_bf16 v[124:127], v[104:107], v[70:73], v[124:127]
    ds_read_b128 v[96:99], v239 offset:21504
    s_add_u32 s43, s25, 5120
    buffer_load_dwordx4 a[240:243], v2, s[8:11], s43 offen offset:0 sc1
    s_waitcnt lgkmcnt(4)
    v_mfma_f32_16x16x32_bf16 v[128:131], v[108:111], v[70:73], v[128:131]
    ds_read_b128 v[100:103], v239 offset:22528
    v_mfma_f32_16x16x32_bf16 v[132:135], v[112:115], v[70:73], v[132:135]
    ds_read_b128 v[104:107], v239 offset:23552
    s_waitcnt lgkmcnt(4)
    v_mfma_f32_16x16x32_bf16 v[136:139], v[116:119], v[70:73], v[136:139]
    ds_read_b128 v[108:111], v239 offset:24576
    v_mfma_f32_16x16x32_bf16 v[140:143], v[120:123], v[70:73], v[140:143]
    ds_read_b128 v[112:115], v239 offset:25600
    s_waitcnt vmcnt(11) lgkmcnt(4)
    v_mfma_f32_16x16x32_bf16 v[124:127], v[92:95], v[74:77], v[124:127]
    ds_read_b128 v[116:119], v239 offset:26624
    buffer_load_dwordx4 a[244:247], v2, s[8:11], s43 offen offset:1024 sc1
    v_mfma_f32_16x16x32_bf16 v[128:131], v[96:99], v[74:77], v[128:131]
    ds_read_b128 v[120:123], v239 offset:27648
    s_waitcnt lgkmcnt(4)
    v_mfma_f32_16x16x32_bf16 v[132:135], v[100:103], v[74:77], v[132:135]
    ds_read_b128 v[92:95], v239 offset:28672
    v_mfma_f32_16x16x32_bf16 v[136:139], v[104:107], v[74:77], v[136:139]
    ds_read_b128 v[96:99], v239 offset:29696
    s_waitcnt lgkmcnt(4)
    v_mfma_f32_16x16x32_bf16 v[140:143], v[108:111], v[74:77], v[140:143]
    ds_read_b128 v[100:103], v239 offset:30720
    s_waitcnt vmcnt(10)
    v_mfma_f32_16x16x32_bf16 v[124:127], v[112:115], v[78:81], v[124:127]
    ds_read_b128 v[104:107], v239 offset:31744
    buffer_load_dwordx4 a[248:251], v2, s[8:11], s43 offen offset:2048 sc1
    s_waitcnt lgkmcnt(4)
    v_mfma_f32_16x16x32_bf16 v[128:131], v[116:119], v[78:81], v[128:131]
    ds_read_b128 v[108:111], v239 offset:32768
    v_mfma_f32_16x16x32_bf16 v[132:135], v[120:123], v[78:81], v[132:135]
    ds_read_b128 v[112:115], v239 offset:33792
    s_waitcnt lgkmcnt(4)
    v_mfma_f32_16x16x32_bf16 v[136:139], v[92:95], v[78:81], v[136:139]
    ds_read_b128 v[116:119], v239 offset:34816
    v_mfma_f32_16x16x32_bf16 v[140:143], v[96:99], v[78:81], v[140:143]
    ds_read_b128 v[120:123], v239 offset:35840
    s_waitcnt vmcnt(9) lgkmcnt(4)
    v_mfma_f32_16x16x32_bf16 v[124:127], v[100:103], v[82:85], v[124:127]
    ds_read_b128 v[92:95], v239 offset:36864
    buffer_load_dwordx4 a[252:255], v2, s[8:11], s43 offen offset:3072 sc1
    v_mfma_f32_16x16x32_bf16 v[128:131], v[104:107], v[82:85], v[128:131]
    ds_read_b128 v[96:99], v239 offset:37888
    s_waitcnt lgkmcnt(4)
    v_mfma_f32_16x16x32_bf16 v[132:135], v[108:111], v[82:85], v[132:135]
    ds_read_b128 v[100:103], v239 offset:38912
    v_mfma_f32_16x16x32_bf16 v[136:139], v[112:115], v[82:85], v[136:139]
    ds_read_b128 v[104:107], v239 offset:39936
    s_waitcnt lgkmcnt(4)
    v_mfma_f32_16x16x32_bf16 v[140:143], v[116:119], v[82:85], v[140:143]
    s_waitcnt vmcnt(8)
    v_mfma_f32_16x16x32_bf16 v[124:127], v[120:123], v[86:89], v[124:127]
    s_waitcnt lgkmcnt(2)
    v_mfma_f32_16x16x32_bf16 v[128:131], v[92:95], v[86:89], v[128:131]
    v_mfma_f32_16x16x32_bf16 v[132:135], v[96:99], v[86:89], v[132:135]
    s_waitcnt lgkmcnt(0)
    v_mfma_f32_16x16x32_bf16 v[136:139], v[100:103], v[86:89], v[136:139]
    v_mfma_f32_16x16x32_bf16 v[140:143], v[104:107], v[86:89], v[140:143]
    s_nop 1
    v_pk_fma_f32 v[188:189], v[124:125], v[158:159], v[188:189]
    v_pk_fma_f32 v[190:191], v[126:127], v[160:161], v[190:191]
    v_pk_fma_f32 v[192:193], v[128:129], v[162:163], v[192:193]
    v_pk_fma_f32 v[194:195], v[130:131], v[164:165], v[194:195]
    v_pk_mul_f32 v[222:223], v[222:223], v[188:189]
    v_pk_mul_f32 v[224:225], v[224:225], v[190:191]
    v_pk_mul_f32 v[226:227], v[226:227], v[192:193]
    v_pk_mul_f32 v[228:229], v[228:229], v[194:195]
    v_cvt_pk_bf16_f32 v158, v222, v223
    v_cvt_pk_bf16_f32 v159, v224, v225
    v_cvt_pk_bf16_f32 v160, v226, v227
    v_cvt_pk_bf16_f32 v161, v228, v229
    buffer_store_dwordx4 v[158:161], v214, s[8:11], s52 offen sc1
    v_pk_fma_f32 v[196:197], v[132:133], v[166:167], v[196:197]
    v_pk_fma_f32 v[198:199], v[134:135], v[168:169], v[198:199]
    v_pk_fma_f32 v[200:201], v[136:137], v[170:171], v[200:201]
    v_pk_fma_f32 v[202:203], v[138:139], v[172:173], v[202:203]
    v_pk_mul_f32 v[230:231], v[230:231], v[196:197]
    v_pk_mul_f32 v[232:233], v[232:233], v[198:199]
    v_pk_mul_f32 v[234:235], v[234:235], v[200:201]
    v_pk_mul_f32 v[236:237], v[236:237], v[202:203]
    v_cvt_pk_bf16_f32 v162, v230, v231
    v_cvt_pk_bf16_f32 v163, v232, v233
    v_cvt_pk_bf16_f32 v164, v234, v235
    v_cvt_pk_bf16_f32 v165, v236, v237
    buffer_store_dwordx4 v[162:165], v214, s[8:11], s52 offen offset:2048 sc1
    v_pk_fma_f32 v[204:205], v[140:141], v[174:175], v[204:205]
    v_pk_fma_f32 v[206:207], v[142:143], v[176:177], v[206:207]
    v_pk_mul_f32 v[248:249], v[248:249], v[204:205]
    v_pk_mul_f32 v[250:251], v[250:251], v[206:207]
    v_cvt_pk_bf16_f32 v166, v248, v249
    v_cvt_pk_bf16_f32 v167, v250, v251
    v_mov_b32 v168, v166
    v_mov_b32 v169, v167
    s_nop 0
    v_permlane16_swap_b32 v166, v168
    v_permlane16_swap_b32 v167, v169
    s_mov_b32 exec_lo, 0xffff
    s_mov_b32 exec_hi, 0xffff
    buffer_store_dwordx4 v[166:169], v215, s[8:11], s53 offen sc1
    s_mov_b64 exec, -1
    v_pk_add_f32 v[146:147], v[188:189], v[190:191]
    v_pk_mul_f32 v[148:149], v[188:189], v[188:189]
    v_pk_fma_f32 v[148:149], v[190:191], v[190:191], v[148:149]
    v_pk_fma_f32 v[148:149], v[192:193], v[192:193], v[148:149]
    v_pk_add_f32 v[146:147], v[146:147], v[192:193]
    v_pk_fma_f32 v[148:149], v[194:195], v[194:195], v[148:149]
    v_pk_add_f32 v[146:147], v[146:147], v[194:195]
    v_pk_fma_f32 v[148:149], v[196:197], v[196:197], v[148:149]
    v_pk_add_f32 v[146:147], v[146:147], v[196:197]
    v_pk_fma_f32 v[148:149], v[198:199], v[198:199], v[148:149]
    v_pk_add_f32 v[146:147], v[146:147], v[198:199]
    v_pk_fma_f32 v[148:149], v[200:201], v[200:201], v[148:149]
    v_pk_add_f32 v[146:147], v[146:147], v[200:201]
    v_pk_fma_f32 v[148:149], v[202:203], v[202:203], v[148:149]
    v_pk_add_f32 v[146:147], v[146:147], v[202:203]
    v_pk_fma_f32 v[148:149], v[204:205], v[204:205], v[148:149]
    v_pk_add_f32 v[146:147], v[146:147], v[204:205]
    v_pk_fma_f32 v[148:149], v[206:207], v[206:207], v[148:149]
    v_pk_add_f32 v[146:147], v[146:147], v[206:207]
    v_add_f32_e64 v144, v146, v147
    v_add_f32_e64 v145, v148, v149
    s_nop 1
    v_permlane32_swap_b32 v144, v145
    v_add_f32_e64 v144, v144, v145
    v_mov_b32 v145, v144
    s_nop 1
    v_permlane16_swap_b32 v144, v145
    v_add_f32_e64 v144, v144, v145
    v_mov_b32_e64 v145, v144
    s_nop 1
    v_permlane32_swap_b32 v144, v145
    s_mov_b64 exec, 0xffff
    buffer_store_dwordx2 v[144:145], v219, s[8:11], s61 offen sc1
    s_mov_b64 exec, -1
    s_barrier
    ds_write_b128 v246, a[0:3] offset:0
    ds_write_b128 v246, a[4:7] offset:1024
    ds_write_b128 v246, a[8:11] offset:2048
    ds_write_b128 v246, a[12:15] offset:3072
    s_waitcnt vmcnt(0)
    s_mov_b32 exec_hi, 0
    buffer_store_dword v6, v7, s[8:11], s62 offen offset:0 sc1
    s_mov_b64 exec, -1
    ds_write_b128 v246, a[16:19] offset:4096
    s_mov_b32 s46, 0x40000
    buffer_load_dwordx2 v[92:93], v241, s[8:11], s46 offen sc1
    ds_write_b128 v246, a[20:23] offset:20480
    s_mov_b32 s46, 0x46c00
    buffer_load_dwordx2 v[94:95], v241, s[8:11], s46 offen sc1
    ds_write_b128 v246, a[24:27] offset:21504
    s_mov_b32 s46, 0x4d800
    buffer_load_dwordx2 v[96:97], v241, s[8:11], s46 offen sc1
    s_mov_b32 s46, 0x54400
    buffer_load_dwordx2 v[98:99], v241, s[8:11], s46 offen sc1
    ds_write_b128 v246, a[28:31] offset:22528
    s_mov_b32 s46, 0x5b000
    buffer_load_dwordx2 v[100:101], v241, s[8:11], s46 offen sc1
    ds_write_b128 v246, a[32:35] offset:23552
    s_mov_b32 s46, 0x61c00
    buffer_load_dwordx2 v[102:103], v241, s[8:11], s46 offen sc1
    ds_write_b128 v246, a[36:39] offset:24576
    s_mov_b32 s46, 0x68800
    buffer_load_dwordx2 v[104:105], v241, s[8:11], s46 offen sc1
    s_mov_b32 s46, 0x6f400
    buffer_load_dwordx2 v[106:107], v241, s[8:11], s46 offen sc1
    ds_write_b128 v246, a[40:43] offset:40960
    s_add_u32 m0, s44, 102400
    s_add_u32 s42, s21, 102400
    buffer_load_dwordx4 v2, s[8:11], s42 offen offset:0 sc1 lds
    ds_write_b128 v246, a[44:47] offset:41984
    buffer_load_dwordx4 v2, s[8:11], s42 offen offset:1024 sc1 lds
    ds_write_b128 v246, a[48:51] offset:43008
    buffer_load_dwordx4 v2, s[8:11], s42 offen offset:2048 sc1 lds
    buffer_load_dwordx4 v2, s[8:11], s42 offen offset:3072 sc1 lds
    ds_write_b128 v246, a[52:55] offset:44032
    s_add_u32 m0, s44, 106496
    s_add_u32 s42, s21, 106496
    buffer_load_dwordx4 v2, s[8:11], s42 offen offset:0 sc1 lds
    ds_write_b128 v246, a[56:59] offset:45056
    s_add_u32 m0, s44, 122880
    s_add_u32 s42, s21, 122880
    buffer_load_dwordx4 v2, s[8:11], s42 offen offset:0 sc1 lds
    ds_write_b128 v247, a[60:63] offset:0
    buffer_load_dwordx4 v2, s[8:11], s42 offen offset:1024 sc1 lds
    buffer_load_dwordx4 v2, s[8:11], s42 offen offset:2048 sc1 lds
    ds_write_b128 v247, a[64:67] offset:1024
    s_mov_b64 exec, 0xffff
    s_nop 0
    buffer_load_dword v8, v245, s[8:11], s67 offen offset:0 sc1
    s_mov_b64 exec, -1
    buffer_load_dwordx4 v2, s[8:11], s42 offen offset:3072 sc1 lds
    ds_write_b128 v247, a[68:71] offset:2048
    s_add_u32 m0, s44, 126976
    s_add_u32 s42, s21, 126976
    buffer_load_dwordx4 v2, s[8:11], s42 offen offset:0 sc1 lds
    ds_write_b128 v247, a[72:75] offset:3072
    buffer_load_dwordx4 v[74:77], v2, s[8:11], s29 offen offset:0 sc1
    buffer_load_dwordx4 v[78:81], v2, s[8:11], s29 offen offset:1024 sc1
    ds_write_b128 v247, a[76:79] offset:4096
    buffer_load_dwordx4 v[82:85], v2, s[8:11], s29 offen offset:2048 sc1
    ds_write_b128 v247, a[80:83] offset:20480
    buffer_load_dwordx4 v[86:89], v2, s[8:11], s29 offen offset:3072 sc1
    ds_write_b128 v247, a[84:87] offset:21504
    buffer_load_dwordx4 v[222:225], v5, s[8:11], s29 offen offset:0 sc1
    buffer_load_dwordx4 v[226:229], v2, s[8:11], s30 offen offset:0 sc1
    ds_write_b128 v247, a[88:91] offset:22528
    buffer_load_dwordx4 v[230:233], v2, s[8:11], s30 offen offset:1024 sc1
    ds_write_b128 v247, a[92:95] offset:23552
    buffer_load_dwordx4 v[234:237], v2, s[8:11], s30 offen offset:2048 sc1
    ds_write_b128 v247, a[96:99] offset:24576
    buffer_load_dwordx4 v[248:251], v2, s[8:11], s30 offen offset:3072 sc1
    buffer_load_dwordx4 v[252:255], v5, s[8:11], s30 offen offset:0 sc1
    v_pk_add_f32 v[188:189], v[188:189], v[152:153] op_sel_hi:[1,0] neg_lo:[0,1] neg_hi:[0,1]
    v_pk_add_f32 v[190:191], v[190:191], v[152:153] op_sel_hi:[1,0] neg_lo:[0,1] neg_hi:[0,1]
    v_pk_add_f32 v[192:193], v[192:193], v[152:153] op_sel_hi:[1,0] neg_lo:[0,1] neg_hi:[0,1]
    v_pk_add_f32 v[194:195], v[194:195], v[152:153] op_sel_hi:[1,0] neg_lo:[0,1] neg_hi:[0,1]
    v_pk_add_f32 v[196:197], v[196:197], v[152:153] op_sel_hi:[1,0] neg_lo:[0,1] neg_hi:[0,1]
    v_pk_add_f32 v[198:199], v[198:199], v[152:153] op_sel_hi:[1,0] neg_lo:[0,1] neg_hi:[0,1]
    v_pk_add_f32 v[200:201], v[200:201], v[152:153] op_sel_hi:[1,0] neg_lo:[0,1] neg_hi:[0,1]
    v_pk_add_f32 v[202:203], v[202:203], v[152:153] op_sel_hi:[1,0] neg_lo:[0,1] neg_hi:[0,1]
    v_pk_add_f32 v[204:205], v[204:205], v[152:153] op_sel_hi:[1,0] neg_lo:[0,1] neg_hi:[0,1]
    v_pk_add_f32 v[206:207], v[206:207], v[152:153] op_sel_hi:[1,0] neg_lo:[0,1] neg_hi:[0,1]
    v_cvt_pk_bf16_f32 v178, v188, v189
    v_cvt_pk_bf16_f32 v179, v190, v191
    v_cvt_pk_bf16_f32 v180, v192, v193
    v_cvt_pk_bf16_f32 v181, v194, v195
    v_cvt_pk_bf16_f32 v182, v196, v197
    v_cvt_pk_bf16_f32 v183, v198, v199
    v_cvt_pk_bf16_f32 v184, v200, v201
    v_cvt_pk_bf16_f32 v185, v202, v203
    v_cvt_pk_bf16_f32 v186, v204, v205
    v_cvt_pk_bf16_f32 v187, v206, v207
    s_waitcnt vmcnt(24)
    v_add_f32 v92, v92, v100
    v_add_f32 v93, v93, v101
    s_waitcnt vmcnt(23)
    v_add_f32 v94, v94, v102
    v_add_f32 v95, v95, v103
    s_waitcnt vmcnt(22)
    v_add_f32 v96, v96, v104
    v_add_f32 v97, v97, v105
    s_waitcnt vmcnt(21)
    v_add_f32 v98, v98, v106
    v_add_f32 v99, v99, v107
    v_add_f32 v92, v92, v96
    v_add_f32 v93, v93, v97
    v_add_f32 v94, v94, v98
    v_add_f32 v95, v95, v99
    v_add_f32 v92, v92, v94
    v_add_f32 v93, v93, v95
    v_and_b32 v148, 0xffff0000, v92
    v_sub_f32_e64 v149, v92, v148
    v_and_b32 v150, 0xffff0000, v93
    v_sub_f32_e64 v151, v93, v150
    v_perm_b32 v108, v148, v148, s59
    v_perm_b32 v109, v150, v149, s59
    v_perm_b32 v110, v151, v150, s59
    v_mov_b32_e64 v111, 0
    v_mov_b32_e64 v112, 0
    v_mov_b32_e64 v113, 0
    v_mov_b32_e64 v114, 0
    v_mov_b32_e64 v115, 0
    ds_write_b128 v243, v[108:111]
    ds_write_b128 v243, v[112:115] offset:512
    s_waitcnt lgkmcnt(0)
    s_waitcnt vmcnt(12)
    v_cmp_ne_u32 vcc, s45, v8
    s_nop 0
    s_and_b32 vcc_lo, vcc_lo, 0xffff
    s_cbranch_scc1 Ls_x
Lr_x:
    v_lshlrev_b32_e64 v245, 4, v1
    s_add_u32 s41, s1, 0
    buffer_load_dwordx4 a[0:3], v2, s[8:11], s41 offen offset:0 sc1
    buffer_load_dwordx4 a[4:7], v2, s[8:11], s41 offen offset:1024 sc1
    buffer_load_dwordx4 a[8:11], v2, s[8:11], s41 offen offset:2048 sc1
    buffer_load_dwordx4 a[12:15], v2, s[8:11], s41 offen offset:3072 sc1
    s_add_u32 s41, s1, 4096
    buffer_load_dwordx4 a[16:19], v2, s[8:11], s41 offen offset:0 sc1
    buffer_load_dwordx4 a[20:23], v2, s[8:11], s41 offen offset:1024 sc1
    buffer_load_dwordx4 a[24:27], v2, s[8:11], s41 offen offset:2048 sc1
    buffer_load_dwordx4 a[28:31], v2, s[8:11], s41 offen offset:3072 sc1
    s_barrier
    ds_read_b128 v[92:95], v2 offset:0
    ds_read_b128 v[96:99], v2 offset:1024
    ds_read_b128 v[100:103], v2 offset:2048
    ds_read_b128 v[104:107], v2 offset:3072
    ds_read_b128 v[108:111], v2 offset:4096
    ds_read_b128 v[112:115], v2 offset:5120
    s_waitcnt vmcnt(7) lgkmcnt(4)
    v_mfma_f32_32x32x16_bf16 v[10:25], v[92:95], a[0:3], 0
    ds_read_b128 v[116:119], v2 offset:6144
    s_add_u32 s41, s1, 8192
    buffer_load_dwordx4 a[32:35], v2, s[8:11], s41 offen offset:0 sc1
    v_mfma_f32_32x32x16_bf16 v[26:41], v[96:99], a[0:3], 0
    ds_read_b128 v[120:123], v2 offset:7168
    buffer_load_dwordx4 a[36:39], v2, s[8:11], s41 offen offset:1024 sc1
    s_waitcnt lgkmcnt(4)
    v_mfma_f32_32x32x16_bf16 v[42:57], v[100:103], a[0:3], 0
    ds_read_b128 v[92:95], v2 offset:8192
    s_waitcnt vmcnt(8)
    v_mfma_f32_32x32x16_bf16 v[10:25], v[104:107], a[4:7], v[10:25]
    ds_read_b128 v[96:99], v2 offset:9216
    buffer_load_dwordx4 a[40:43], v2, s[8:11], s41 offen offset:2048 sc1
    s_waitcnt lgkmcnt(4)
    v_mfma_f32_32x32x16_bf16 v[26:41], v[108:111], a[4:7], v[26:41]
    ds_read_b128 v[100:103], v2 offset:10240
    v_mfma_f32_32x32x16_bf16 v[42:57], v[112:115], a[4:7], v[42:57]
    ds_read_b128 v[104:107], v2 offset:11264
    s_waitcnt vmcnt(8) lgkmcnt(4)
    v_mfma_f32_32x32x16_bf16 v[10:25], v[116:119], a[8:11], v[10:25]
    ds_read_b128 v[108:111], v2 offset:12288
    buffer_load_dwordx4 a[44:47], v2, s[8:11], s41 offen offset:3072 sc1
    v_mfma_f32_32x32x16_bf16 v[26:41], v[120:123], a[8:11], v[26:41]
    ds_read_b128 v[112:115], v2 offset:13312
    s_waitcnt lgkmcnt(4)
    v_mfma_f32_32x32x16_bf16 v[42:57], v[92:95], a[8:11], v[42:57]
    ds_read_b128 v[116:119], v2 offset:14336
    s_waitcnt vmcnt(8)
    v_mfma_f32_32x32x16_bf16 v[10:25], v[96:99], a[12:15], v[10:25]
    ds_read_b128 v[120:123], v2 offset:15360
    s_add_u32 s41, s1, 12288
    buffer_load_dwordx4 a[48:51], v2, s[8:11], s41 offen offset:0 sc1
    s_waitcnt lgkmcnt(4)
    v_mfma_f32_32x32x16_bf16 v[26:41], v[100:103], a[12:15], v[26:41]
    ds_read_b128 v[92:95], v2 offset:16384
    v_mfma_f32_32x32x16_bf16 v[42:57], v[104:107], a[12:15], v[42:57]
    ds_read_b128 v[96:99], v2 offset:17408
    s_waitcnt vmcnt(8) lgkmcnt(4)
    v_mfma_f32_32x32x16_bf16 v[10:25], v[108:111], a[16:19], v[10:25]
    ds_read_b128 v[100:103], v2 offset:18432
    buffer_load_dwordx4 a[52:55], v2, s[8:11], s41 offen offset:1024 sc1
    v_mfma_f32_32x32x16_bf16 v[26:41], v[112:115], a[16:19], v[26:41]
    ds_read_b128 v[104:107], v2 offset:19456
    s_waitcnt lgkmcnt(4)
    v_mfma_f32_32x32x16_bf16 v[42:57], v[116:119], a[16:19], v[42:57]
    s_barrier
    ds_read_b128 v[108:111], v2 offset:20480
    s_waitcnt vmcnt(8)
    v_mfma_f32_32x32x16_bf16 v[10:25], v[120:123], a[20:23], v[10:25]
    ds_read_b128 v[112:115], v2 offset:21504
    s_lshl_b32 s46, s50, 11
    s_add_u32 s46, s46, 0x20000
    buffer_load_dwordx2 v[188:189], v242, s[8:11], s46 offen offset:0 sc1
    s_waitcnt lgkmcnt(4)
    v_mfma_f32_32x32x16_bf16 v[26:41], v[92:95], a[20:23], v[26:41]
    ds_read_b128 v[116:119], v2 offset:22528
    v_mfma_f32_32x32x16_bf16 v[42:57], v[96:99], a[20:23], v[42:57]
    ds_read_b128 v[120:123], v2 offset:23552
    buffer_load_dwordx2 v[190:191], v242, s[8:11], s46 offen offset:512 sc1
    s_waitcnt vmcnt(9) lgkmcnt(4)
    v_mfma_f32_32x32x16_bf16 v[10:25], v[100:103], a[24:27], v[10:25]
    ds_read_b128 v[92:95], v2 offset:24576
    v_mfma_f32_32x32x16_bf16 v[26:41], v[104:107], a[24:27], v[26:41]
    ds_read_b128 v[96:99], v2 offset:25600
    s_waitcnt lgkmcnt(4)
    v_mfma_f32_32x32x16_bf16 v[42:57], v[108:111], a[24:27], v[42:57]
    ds_read_b128 v[100:103], v2 offset:26624
    buffer_load_dwordx2 v[192:193], v242, s[8:11], s46 offen offset:1024 sc1
    s_waitcnt vmcnt(9)
    v_mfma_f32_32x32x16_bf16 v[10:25], v[112:115], a[28:31], v[10:25]
    ds_read_b128 v[104:107], v2 offset:27648
    s_waitcnt lgkmcnt(4)
    v_mfma_f32_32x32x16_bf16 v[26:41], v[116:119], a[28:31], v[26:41]
    ds_read_b128 v[108:111], v2 offset:28672
    buffer_load_dwordx2 v[194:195], v242, s[8:11], s46 offen offset:1536 sc1
    v_mfma_f32_32x32x16_bf16 v[42:57], v[120:123], a[28:31], v[42:57]
    ds_read_b128 v[112:115], v2 offset:29696
    buffer_load_dwordx4 a[56:59], v2, s[8:11], s41 offen offset:2048 sc1
    s_waitcnt vmcnt(10) lgkmcnt(4)
    v_mfma_f32_32x32x16_bf16 v[10:25], v[92:95], a[32:35], v[10:25]
    ds_read_b128 v[116:119], v2 offset:30720
    buffer_load_dwordx4 a[60:63], v2, s[8:11], s41 offen offset:3072 sc1
    v_mfma_f32_32x32x16_bf16 v[26:41], v[96:99], a[32:35], v[26:41]
    ds_read_b128 v[120:123], v2 offset:31744
    s_add_u32 s41, s1, 16384
    buffer_load_dwordx4 a[64:67], v2, s[8:11], s41 offen offset:0 sc1
    s_waitcnt lgkmcnt(4)
    v_mfma_f32_32x32x16_bf16 v[42:57], v[100:103], a[32:35], v[42:57]
    ds_read_b128 v[92:95], v2 offset:32768
    buffer_load_dwordx4 a[68:71], v2, s[8:11], s41 offen offset:1024 sc1
    s_waitcnt vmcnt(12)
    v_mfma_f32_32x32x16_bf16 v[10:25], v[104:107], a[36:39], v[10:25]
    ds_read_b128 v[96:99], v2 offset:33792
    buffer_load_dwordx4 a[72:75], v2, s[8:11], s41 offen offset:2048 sc1
    s_waitcnt lgkmcnt(4)
    v_mfma_f32_32x32x16_bf16 v[26:41], v[108:111], a[36:39], v[26:41]
    ds_read_b128 v[100:103], v2 offset:34816
    v_mfma_f32_32x32x16_bf16 v[42:57], v[112:115], a[36:39], v[42:57]
    ds_read_b128 v[104:107], v2 offset:35840
    s_waitcnt vmcnt(12) lgkmcnt(4)
    v_mfma_f32_32x32x16_bf16 v[10:25], v[116:119], a[40:43], v[10:25]
    ds_read_b128 v[108:111], v2 offset:36864
    buffer_load_dwordx4 a[76:79], v2, s[8:11], s41 offen offset:3072 sc1
    v_mfma_f32_32x32x16_bf16 v[26:41], v[120:123], a[40:43], v[26:41]
    ds_read_b128 v[112:115], v2 offset:37888
    s_waitcnt lgkmcnt(4)
    v_mfma_f32_32x32x16_bf16 v[42:57], v[92:95], a[40:43], v[42:57]
    ds_read_b128 v[116:119], v2 offset:38912
    s_waitcnt vmcnt(12)
    v_mfma_f32_32x32x16_bf16 v[10:25], v[96:99], a[44:47], v[10:25]
    ds_read_b128 v[120:123], v2 offset:39936
    s_add_u32 s41, s1, 20480
    buffer_load_dwordx4 a[80:83], v2, s[8:11], s41 offen offset:0 sc1
    s_waitcnt lgkmcnt(4)
    v_mfma_f32_32x32x16_bf16 v[26:41], v[100:103], a[44:47], v[26:41]
    s_barrier
    ds_read_b128 v[92:95], v2 offset:40960
    v_mfma_f32_32x32x16_bf16 v[42:57], v[104:107], a[44:47], v[42:57]
    ds_read_b128 v[96:99], v2 offset:41984
    s_waitcnt vmcnt(12) lgkmcnt(4)
    v_mfma_f32_32x32x16_bf16 v[10:25], v[108:111], a[48:51], v[10:25]
    ds_read_b128 v[100:103], v2 offset:43008
    buffer_load_dwordx4 a[84:87], v2, s[8:11], s41 offen offset:1024 sc1
    v_mfma_f32_32x32x16_bf16 v[26:41], v[112:115], a[48:51], v[26:41]
    ds_read_b128 v[104:107], v2 offset:44032
    s_waitcnt lgkmcnt(4)
    v_mfma_f32_32x32x16_bf16 v[42:57], v[116:119], a[48:51], v[42:57]
    ds_read_b128 v[108:111], v2 offset:45056
    s_waitcnt vmcnt(12)
    v_mfma_f32_32x32x16_bf16 v[10:25], v[120:123], a[52:55], v[10:25]
    ds_read_b128 v[112:115], v2 offset:46080
    buffer_load_dwordx4 a[88:91], v2, s[8:11], s41 offen offset:2048 sc1
    s_waitcnt lgkmcnt(4)
    v_mfma_f32_32x32x16_bf16 v[26:41], v[92:95], a[52:55], v[26:41]
    ds_read_b128 v[116:119], v2 offset:47104
    v_mfma_f32_32x32x16_bf16 v[42:57], v[96:99], a[52:55], v[42:57]
    ds_read_b128 v[120:123], v2 offset:48128
    s_waitcnt vmcnt(8) lgkmcnt(4)
    v_mfma_f32_32x32x16_bf16 v[10:25], v[100:103], a[56:59], v[10:25]
    ds_read_b128 v[92:95], v2 offset:49152
    buffer_load_dwordx4 a[92:95], v2, s[8:11], s41 offen offset:3072 sc1
    v_mfma_f32_32x32x16_bf16 v[26:41], v[104:107], a[56:59], v[26:41]
    ds_read_b128 v[96:99], v2 offset:50176
    s_waitcnt lgkmcnt(4)
    v_mfma_f32_32x32x16_bf16 v[42:57], v[108:111], a[56:59], v[42:57]
    ds_read_b128 v[100:103], v2 offset:51200
    s_waitcnt vmcnt(8)
    v_mfma_f32_32x32x16_bf16 v[10:25], v[112:115], a[60:63], v[10:25]
    ds_read_b128 v[104:107], v2 offset:52224
    s_add_u32 s41, s1, 24576
    buffer_load_dwordx4 a[96:99], v2, s[8:11], s41 offen offset:0 sc1
    s_waitcnt lgkmcnt(4)
    v_mfma_f32_32x32x16_bf16 v[26:41], v[116:119], a[60:63], v[26:41]
    ds_read_b128 v[108:111], v2 offset:53248
    v_mfma_f32_32x32x16_bf16 v[42:57], v[120:123], a[60:63], v[42:57]
    ds_read_b128 v[112:115], v2 offset:54272
    s_waitcnt vmcnt(8) lgkmcnt(4)
    v_mfma_f32_32x32x16_bf16 v[10:25], v[92:95], a[64:67], v[10:25]
    ds_read_b128 v[116:119], v2 offset:55296
    buffer_load_dwordx4 a[100:103], v2, s[8:11], s41 offen offset:1024 sc1
    v_mfma_f32_32x32x16_bf16 v[26:41], v[96:99], a[64:67], v[26:41]
    ds_read_b128 v[120:123], v2 offset:56320
    s_waitcnt lgkmcnt(4)
    v_mfma_f32_32x32x16_bf16 v[42:57], v[100:103], a[64:67], v[42:57]
    ds_read_b128 v[92:95], v2 offset:57344
    s_waitcnt vmcnt(8)
    v_mfma_f32_32x32x16_bf16 v[10:25], v[104:107], a[68:71], v[10:25]
    ds_read_b128 v[96:99], v2 offset:58368
    buffer_load_dwordx4 a[104:107], v2, s[8:11], s41 offen offset:2048 sc1
    s_waitcnt lgkmcnt(4)
    v_mfma_f32_32x32x16_bf16 v[26:41], v[108:111], a[68:71], v[26:41]
    ds_read_b128 v[100:103], v2 offset:59392
    v_mfma_f32_32x32x16_bf16 v[42:57], v[112:115], a[68:71], v[42:57]
    ds_read_b128 v[104:107], v2 offset:60416
    s_waitcnt vmcnt(8) lgkmcnt(4)
    v_mfma_f32_32x32x16_bf16 v[10:25], v[116:119], a[72:75], v[10:25]
    s_barrier
    ds_read_b128 v[108:111], v239 offset:0
    buffer_load_dwordx4 a[108:111], v2, s[8:11], s41 offen offset:3072 sc1
    v_mfma_f32_32x32x16_bf16 v[26:41], v[120:123], a[72:75], v[26:41]
    ds_read_b128 v[112:115], v239 offset:1024
    s_waitcnt lgkmcnt(4)
    v_mfma_f32_32x32x16_bf16 v[42:57], v[92:95], a[72:75], v[42:57]
    ds_read_b128 v[116:119], v239 offset:2048
    s_waitcnt vmcnt(8)
    v_mfma_f32_32x32x16_bf16 v[10:25], v[96:99], a[76:79], v[10:25]
    ds_read_b128 v[120:123], v239 offset:3072
    s_add_u32 s41, s1, 28672
    buffer_load_dwordx4 a[112:115], v2, s[8:11], s41 offen offset:0 sc1
    s_waitcnt lgkmcnt(4)
    v_mfma_f32_32x32x16_bf16 v[26:41], v[100:103], a[76:79], v[26:41]
    ds_read_b128 v[92:95], v239 offset:4096
    v_mfma_f32_32x32x16_bf16 v[42:57], v[104:107], a[76:79], v[42:57]
    ds_read_b128 v[96:99], v239 offset:5120
    s_waitcnt vmcnt(8) lgkmcnt(4)
    v_mfma_f32_32x32x16_bf16 v[10:25], v[108:111], a[80:83], v[10:25]
    ds_read_b128 v[100:103], v239 offset:6144
    buffer_load_dwordx4 a[116:119], v2, s[8:11], s41 offen offset:1024 sc1
    v_add_f32 v188, v188, v192
    v_add_f32 v189, v189, v193
    v_add_f32 v190, v190, v194
    v_mfma_f32_32x32x16_bf16 v[26:41], v[112:115], a[80:83], v[26:41]
    ds_read_b128 v[104:107], v239 offset:7168
    v_add_f32 v191, v191, v195
    v_add_f32_e64 v188, v188, v190
    v_add_f32 v189, v189, v191
    v_mov_b32_e64 v190, v188
    v_mov_b32_e64 v191, v189
    s_waitcnt lgkmcnt(4)
    v_mfma_f32_32x32x16_bf16 v[42:57], v[116:119], a[80:83], v[42:57]
    ds_read_b128 v[108:111], v239 offset:8192
    v_mov_b32 v157, 0x3727c5ac
    v_mov_b32_e64 v155, 0
    v_permlane32_swap_b32 v188, v190
    v_permlane32_swap_b32 v189, v191
    v_add_f32 v188, v188, v190
    s_waitcnt vmcnt(8)
    v_mfma_f32_32x32x16_bf16 v[10:25], v[120:123], a[84:87], v[10:25]
    ds_read_b128 v[112:115], v239 offset:9216
    buffer_load_dwordx4 a[120:123], v2, s[8:11], s41 offen offset:2048 sc1
    v_add_f32 v189, v189, v191
    v_mul_f32 v188, 0xbacccccd, v188
    v_fmac_f32 v157, 0x3acccccd, v189
    s_waitcnt lgkmcnt(4)
    v_mfma_f32_32x32x16_bf16 v[26:41], v[92:95], a[84:87], v[26:41]
    ds_read_b128 v[116:119], v239 offset:10240
    v_fma_f32 v157, -v188, v188, v157
    v_max_f32 v157, 0x3727c5ac, v157
    v_rsq_f32_e64 v156, v157
    v_and_b32 v128, 0xffff0000, v188
    v_mfma_f32_32x32x16_bf16 v[42:57], v[96:99], a[84:87], v[42:57]
    ds_read_b128 v[120:123], v239 offset:11264
    buffer_load_dwordx4 a[124:127], v2, s[8:11], s41 offen offset:3072 sc1
    v_sub_f32 v129, v188, v128
    v_mul_f32_e64 v189, v157, v156
    v_mul_f32 v156, 0xbfb8aa3b, v156
    s_waitcnt vmcnt(9) lgkmcnt(4)
    v_mfma_f32_32x32x16_bf16 v[10:25], v[100:103], a[88:91], v[10:25]
    ds_read_b128 v[92:95], v239 offset:12288
    v_and_b32 v130, 0xffff0000, v189
    v_sub_f32 v131, v189, v130
    v_perm_b32 v152, v129, v128, s59
    v_perm_b32 v153, v130, v128, s59
    v_perm_b32 v154, v130, v131, s59
    v_mfma_f32_32x32x16_bf16 v[26:41], v[104:107], a[88:91], v[26:41]
    ds_read_b128 v[96:99], v239 offset:13312
    s_waitcnt lgkmcnt(4)
    v_mfma_f32_32x32x16_bf16 v[42:57], v[108:111], a[88:91], v[42:57]
    ds_read_b128 v[100:103], v239 offset:14336
    s_add_u32 s41, s1, 32768
    buffer_load_dwordx4 a[128:131], v2, s[8:11], s41 offen offset:0 sc1
    s_waitcnt vmcnt(9)
    v_mfma_f32_32x32x16_bf16 v[10:25], v[112:115], a[92:95], v[10:25]
    ds_read_b128 v[104:107], v239 offset:15360
    s_waitcnt lgkmcnt(4)
    v_mfma_f32_32x32x16_bf16 v[26:41], v[116:119], a[92:95], v[26:41]
    ds_read_b128 v[108:111], v239 offset:16384
    buffer_load_dwordx4 a[132:135], v2, s[8:11], s41 offen offset:1024 sc1
    v_mfma_f32_32x32x16_bf16 v[42:57], v[120:123], a[92:95], v[42:57]
    ds_read_b128 v[112:115], v239 offset:17408
    s_waitcnt vmcnt(9) lgkmcnt(4)
    v_mfma_f32_32x32x16_bf16 v[10:25], v[92:95], a[96:99], v[10:25]
    ds_read_b128 v[116:119], v239 offset:18432
    buffer_load_dwordx4 a[136:139], v2, s[8:11], s41 offen offset:2048 sc1
    v_mfma_f32_32x32x16_bf16 v[26:41], v[96:99], a[96:99], v[26:41]
    ds_read_b128 v[120:123], v239 offset:19456
    s_waitcnt lgkmcnt(4)
    v_mfma_f32_32x32x16_bf16 v[42:57], v[100:103], a[96:99], v[42:57]
    s_barrier
    ds_read_b128 v[92:95], v239 offset:20480
    s_waitcnt vmcnt(9)
    v_mfma_f32_32x32x16_bf16 v[10:25], v[104:107], a[100:103], v[10:25]
    ds_read_b128 v[96:99], v239 offset:21504
    buffer_load_dwordx4 a[140:143], v2, s[8:11], s41 offen offset:3072 sc1
    s_waitcnt lgkmcnt(4)
    v_mfma_f32_32x32x16_bf16 v[26:41], v[108:111], a[100:103], v[26:41]
    ds_read_b128 v[100:103], v239 offset:22528
    v_mfma_f32_32x32x16_bf16 v[42:57], v[112:115], a[100:103], v[42:57]
    ds_read_b128 v[104:107], v239 offset:23552
    s_add_u32 s41, s1, 36864
    buffer_load_dwordx4 a[144:147], v2, s[8:11], s41 offen offset:0 sc1
    s_waitcnt vmcnt(10) lgkmcnt(4)
    v_mfma_f32_32x32x16_bf16 v[10:25], v[116:119], a[104:107], v[10:25]
    ds_read_b128 v[108:111], v239 offset:24576
    v_mfma_f32_32x32x16_bf16 v[26:41], v[120:123], a[104:107], v[26:41]
    ds_read_b128 v[112:115], v239 offset:25600
    s_waitcnt lgkmcnt(4)
    v_mfma_f32_32x32x16_bf16 v[42:57], v[92:95], a[104:107], v[42:57]
    ds_read_b128 v[116:119], v239 offset:26624
    buffer_load_dwordx4 a[148:151], v2, s[8:11], s41 offen offset:1024 sc1
    s_waitcnt vmcnt(10)
    v_mfma_f32_32x32x16_bf16 v[10:25], v[96:99], a[108:111], v[10:25]
    ds_read_b128 v[120:123], v239 offset:27648
    s_waitcnt lgkmcnt(4)
    v_mfma_f32_32x32x16_bf16 v[26:41], v[100:103], a[108:111], v[26:41]
    ds_read_b128 v[92:95], v239 offset:28672
    buffer_load_dwordx4 a[152:155], v2, s[8:11], s41 offen offset:2048 sc1
    v_mfma_f32_32x32x16_bf16 v[42:57], v[104:107], a[108:111], v[42:57]
    ds_read_b128 v[96:99], v239 offset:29696
    s_waitcnt vmcnt(10) lgkmcnt(4)
    v_mfma_f32_32x32x16_bf16 v[10:25], v[108:111], a[112:115], v[10:25]
    ds_read_b128 v[100:103], v239 offset:30720
    v_mfma_f32_32x32x16_bf16 v[26:41], v[112:115], a[112:115], v[26:41]
    ds_read_b128 v[104:107], v239 offset:31744
    buffer_load_dwordx4 a[156:159], v2, s[8:11], s41 offen offset:3072 sc1
    s_waitcnt lgkmcnt(4)
    v_mfma_f32_32x32x16_bf16 v[42:57], v[116:119], a[112:115], v[42:57]
    ds_read_b128 v[108:111], v239 offset:32768
    s_waitcnt vmcnt(10)
    v_mfma_f32_32x32x16_bf16 v[10:25], v[120:123], a[116:119], v[10:25]
    ds_read_b128 v[112:115], v239 offset:33792
    s_add_u32 m0, s44, 0
    s_add_u32 s42, s21, 143360
    buffer_load_dwordx4 v2, s[8:11], s42 offen offset:0 sc1 lds
    s_waitcnt lgkmcnt(4)
    v_mfma_f32_32x32x16_bf16 v[26:41], v[92:95], a[116:119], v[26:41]
    ds_read_b128 v[116:119], v239 offset:34816
    v_mfma_f32_32x32x16_bf16 v[42:57], v[96:99], a[116:119], v[42:57]
    ds_read_b128 v[120:123], v239 offset:35840
    buffer_load_dwordx4 v2, s[8:11], s42 offen offset:1024 sc1 lds
    s_waitcnt vmcnt(11) lgkmcnt(4)
    v_mfma_f32_32x32x16_bf16 v[10:25], v[100:103], a[120:123], v[10:25]
    ds_read_b128 v[92:95], v239 offset:36864
    v_mfma_f32_32x32x16_bf16 v[26:41], v[104:107], a[120:123], v[26:41]
    ds_read_b128 v[96:99], v239 offset:37888
    s_waitcnt lgkmcnt(4)
    v_mfma_f32_32x32x16_bf16 v[42:57], v[108:111], a[120:123], v[42:57]
    ds_read_b128 v[100:103], v239 offset:38912
    buffer_load_dwordx4 v2, s[8:11], s42 offen offset:2048 sc1 lds
    s_waitcnt vmcnt(11)
    v_mfma_f32_32x32x16_bf16 v[10:25], v[112:115], a[124:127], v[10:25]
    ds_read_b128 v[104:107], v239 offset:39936
    s_waitcnt lgkmcnt(4)
    v_mfma_f32_32x32x16_bf16 v[26:41], v[116:119], a[124:127], v[26:41]
    s_barrier
    ds_read_b128 v[108:111], v239 offset:40960
    buffer_load_dwordx4 v2, s[8:11], s42 offen offset:3072 sc1 lds
    v_mfma_f32_32x32x16_bf16 v[42:57], v[120:123], a[124:127], v[42:57]
    ds_read_b128 v[112:115], v239 offset:41984
    s_waitcnt vmcnt(11) lgkmcnt(4)
    v_mfma_f32_32x32x16_bf16 v[10:25], v[92:95], a[128:131], v[10:25]
    ds_read_b128 v[116:119], v239 offset:43008
    v_mfma_f32_32x32x16_bf16 v[26:41], v[96:99], a[128:131], v[26:41]
    ds_read_b128 v[120:123], v239 offset:44032
    s_add_u32 m0, s44, 4096
    s_add_u32 s42, s21, 147456
    buffer_load_dwordx4 v2, s[8:11], s42 offen offset:0 sc1 lds
    s_waitcnt lgkmcnt(4)
    v_mfma_f32_32x32x16_bf16 v[42:57], v[100:103], a[128:131], v[42:57]
    ds_read_b128 v[92:95], v239 offset:45056
    s_waitcnt vmcnt(11)
    v_mfma_f32_32x32x16_bf16 v[10:25], v[104:107], a[132:135], v[10:25]
    ds_read_b128 v[96:99], v239 offset:46080
    s_add_u32 m0, s44, 20480
    s_add_u32 s42, s21, 163840
    buffer_load_dwordx4 v2, s[8:11], s42 offen offset:0 sc1 lds
    s_waitcnt lgkmcnt(4)
    v_mfma_f32_32x32x16_bf16 v[26:41], v[108:111], a[132:135], v[26:41]
    ds_read_b128 v[100:103], v239 offset:47104
    v_mfma_f32_32x32x16_bf16 v[42:57], v[112:115], a[132:135], v[42:57]
    ds_read_b128 v[104:107], v239 offset:48128
    buffer_load_dwordx4 v2, s[8:11], s42 offen offset:1024 sc1 lds
    s_waitcnt vmcnt(12) lgkmcnt(4)
    v_mfma_f32_32x32x16_bf16 v[10:25], v[116:119], a[136:139], v[10:25]
    ds_read_b128 v[108:111], v239 offset:49152
    v_mfma_f32_32x32x16_bf16 v[26:41], v[120:123], a[136:139], v[26:41]
    ds_read_b128 v[112:115], v239 offset:50176
    s_waitcnt lgkmcnt(4)
    v_mfma_f32_32x32x16_bf16 v[42:57], v[92:95], a[136:139], v[42:57]
    ds_read_b128 v[116:119], v239 offset:51200
    buffer_load_dwordx4 v2, s[8:11], s42 offen offset:2048 sc1 lds
    s_waitcnt vmcnt(12)
    v_mfma_f32_32x32x16_bf16 v[10:25], v[96:99], a[140:143], v[10:25]
    ds_read_b128 v[120:123], v239 offset:52224
    s_waitcnt lgkmcnt(4)
    v_mfma_f32_32x32x16_bf16 v[26:41], v[100:103], a[140:143], v[26:41]
    ds_read_b128 v[92:95], v239 offset:53248
    buffer_load_dwordx4 v2, s[8:11], s42 offen offset:3072 sc1 lds
    v_mfma_f32_32x32x16_bf16 v[42:57], v[104:107], a[140:143], v[42:57]
    ds_read_b128 v[96:99], v239 offset:54272
    s_waitcnt vmcnt(12) lgkmcnt(4)
    v_mfma_f32_32x32x16_bf16 v[10:25], v[108:111], a[144:147], v[10:25]
    ds_read_b128 v[100:103], v239 offset:55296
    v_mfma_f32_32x32x16_bf16 v[26:41], v[112:115], a[144:147], v[26:41]
    ds_read_b128 v[104:107], v239 offset:56320
    s_add_u32 m0, s44, 24576
    s_add_u32 s42, s21, 167936
    buffer_load_dwordx4 v2, s[8:11], s42 offen offset:0 sc1 lds
    s_waitcnt lgkmcnt(4)
    v_mfma_f32_32x32x16_bf16 v[42:57], v[116:119], a[144:147], v[42:57]
    ds_read_b128 v[108:111], v239 offset:57344
    s_waitcnt vmcnt(12)
    v_mfma_f32_32x32x16_bf16 v[10:25], v[120:123], a[148:151], v[10:25]
    ds_read_b128 v[112:115], v239 offset:58368
    s_add_u32 m0, s44, 40960
    s_add_u32 s42, s21, 184320
    buffer_load_dwordx4 v2, s[8:11], s42 offen offset:0 sc1 lds
    s_waitcnt lgkmcnt(4)
    v_mfma_f32_32x32x16_bf16 v[26:41], v[92:95], a[148:151], v[26:41]
    ds_read_b128 v[116:119], v239 offset:59392
    v_mfma_f32_32x32x16_bf16 v[42:57], v[96:99], a[148:151], v[42:57]
    ds_read_b128 v[120:123], v239 offset:60416
    buffer_load_dwordx4 v2, s[8:11], s42 offen offset:1024 sc1 lds
    s_waitcnt vmcnt(13) lgkmcnt(4)
    v_mfma_f32_32x32x16_bf16 v[10:25], v[100:103], a[152:155], v[10:25]
    s_barrier
    ds_read_b128 v[92:95], v240 offset:20480
    v_mfma_f32_32x32x16_bf16 v[26:41], v[104:107], a[152:155], v[26:41]
    ds_read_b128 v[96:99], v240 offset:21504
    s_waitcnt lgkmcnt(4)
    v_mfma_f32_32x32x16_bf16 v[42:57], v[108:111], a[152:155], v[42:57]
    ds_read_b128 v[100:103], v240 offset:22528
    buffer_load_dwordx4 v2, s[8:11], s42 offen offset:2048 sc1 lds
    s_waitcnt vmcnt(13)
    v_mfma_f32_32x32x16_bf16 v[10:25], v[112:115], a[156:159], v[10:25]
    ds_read_b128 v[104:107], v240 offset:0
    s_waitcnt lgkmcnt(4)
    v_mfma_f32_32x32x16_bf16 v[26:41], v[116:119], a[156:159], v[26:41]
    ds_read_b128 v[108:111], v240 offset:1024
    buffer_load_dwordx4 v2, s[8:11], s42 offen offset:3072 sc1 lds
    v_mfma_f32_32x32x16_bf16 v[42:57], v[120:123], a[156:159], v[42:57]
    ds_read_b128 v[112:115], v240 offset:2048
    s_waitcnt lgkmcnt(4)
    v_mfma_f32_32x32x16_bf16 v[10:25], v[92:95], v[152:155], v[10:25]
    ds_read_b128 v[116:119], v240 offset:3072
    v_mfma_f32_32x32x16_bf16 v[26:41], v[96:99], v[152:155], v[26:41]
    ds_read_b128 v[120:123], v240 offset:4096
    s_add_u32 m0, s44, 45056
    s_add_u32 s42, s21, 188416
    buffer_load_dwordx4 v2, s[8:11], s42 offen offset:0 sc1 lds
    s_waitcnt lgkmcnt(4)
    v_mfma_f32_32x32x16_bf16 v[42:57], v[100:103], v[152:155], v[42:57]
    ds_read_b128 v[92:95], v240 offset:5120
    v_mfma_f32_32x32x16_bf16 v[58:73], v[104:107], a[0:3], 0
    ds_read_b128 v[96:99], v240 offset:6144
    s_add_u32 m0, s44, 61440
    s_add_u32 s42, s21, 204800
    buffer_load_dwordx4 v2, s[8:11], s42 offen offset:0 sc1 lds
    s_waitcnt lgkmcnt(4)
    v_mfma_f32_32x32x16_bf16 v[58:73], v[108:111], a[4:7], v[58:73]
    ds_read_b128 v[100:103], v240 offset:7168
    v_mfma_f32_32x32x16_bf16 v[58:73], v[112:115], a[8:11], v[58:73]
    ds_read_b128 v[104:107], v240 offset:8192
    buffer_load_dwordx4 v2, s[8:11], s42 offen offset:1024 sc1 lds
    v_mul_f32 v144, v156, v10
    v_mul_f32 v145, v156, v11
    v_mul_f32_e64 v146, v156, v12
    s_waitcnt lgkmcnt(4)
    v_mfma_f32_32x32x16_bf16 v[58:73], v[116:119], a[12:15], v[58:73]
    ds_read_b128 v[108:111], v240 offset:9216
    v_mul_f32 v147, v156, v13
    v_mul_f32 v148, v156, v14
    v_mul_f32 v149, v156, v15
    v_mul_f32 v150, v156, v16
    v_mul_f32_e64 v151, v156, v17
    v_mfma_f32_32x32x16_bf16 v[58:73], v[120:123], a[16:19], v[58:73]
    ds_read_b128 v[112:115], v240 offset:10240
    v_exp_f32 v144, v144
    v_mul_f32 v10, v10, v18
    v_exp_f32 v145, v145
    s_waitcnt lgkmcnt(4)
    v_mfma_f32_32x32x16_bf16 v[58:73], v[92:95], a[20:23], v[58:73]
    ds_read_b128 v[116:119], v240 offset:11264
    buffer_load_dwordx4 v2, s[8:11], s42 offen offset:2048 sc1 lds
    v_mul_f32 v11, v11, v19
    v_exp_f32 v146, v146
    v_mfma_f32_32x32x16_bf16 v[58:73], v[96:99], a[24:27], v[58:73]
    ds_read_b128 v[120:123], v240 offset:12288
    v_mul_f32 v12, v12, v20
    v_exp_f32 v147, v147
    v_mul_f32 v13, v13, v21
    s_waitcnt lgkmcnt(4)
    v_mfma_f32_32x32x16_bf16 v[58:73], v[100:103], a[28:31], v[58:73]
    ds_read_b128 v[92:95], v240 offset:13312
    buffer_load_dwordx4 v2, s[8:11], s42 offen offset:3072 sc1 lds
    v_exp_f32 v148, v148
    v_mul_f32 v14, v14, v22
    v_mfma_f32_32x32x16_bf16 v[58:73], v[104:107], a[32:35], v[58:73]
    ds_read_b128 v[96:99], v240 offset:14336
    v_exp_f32 v149, v149
    v_mul_f32 v15, v15, v23
    v_exp_f32 v150, v150
    s_waitcnt lgkmcnt(4)
    v_mfma_f32_32x32x16_bf16 v[58:73], v[108:111], a[36:39], v[58:73]
    ds_read_b128 v[100:103], v240 offset:15360
    v_mul_f32_e64 v16, v16, v24
    v_exp_f32_e64 v151, v151
    v_mul_f32 v17, v17, v25
    v_fma_f32 v144, v144, v157, v157
    v_mfma_f32_32x32x16_bf16 v[58:73], v[112:115], a[40:43], v[58:73]
    ds_read_b128 v[104:107], v240 offset:16384
    s_add_u32 m0, s44, 65536
    s_add_u32 s42, s21, 208896
    buffer_load_dwordx4 v2, s[8:11], s42 offen offset:0 sc1 lds
    v_fma_f32 v145, v145, v157, v157
    s_waitcnt lgkmcnt(4)
    v_mfma_f32_32x32x16_bf16 v[58:73], v[116:119], a[44:47], v[58:73]
    ds_read_b128 v[108:111], v240 offset:17408
    v_fma_f32 v146, v146, v157, v157
    v_fma_f32 v147, v147, v157, v157
    v_fma_f32 v148, v148, v157, v157
    v_fma_f32 v149, v149, v157, v157
    v_fma_f32 v150, v150, v157, v157
    v_mfma_f32_32x32x16_bf16 v[58:73], v[120:123], a[48:51], v[58:73]
    ds_read_b128 v[112:115], v240 offset:18432
    s_add_u32 m0, s44, 81920
    s_add_u32 s42, s21, 225280
    buffer_load_dwordx4 v2, s[8:11], s42 offen offset:0 sc1 lds
    v_fma_f32 v151, v151, v157, v157
    s_waitcnt lgkmcnt(4)
    v_mfma_f32_32x32x16_bf16 v[58:73], v[92:95], a[52:55], v[58:73]
    ds_read_b128 v[116:119], v240 offset:19456
    v_rcp_f32 v144, v144
    v_rcp_f32 v145, v145
    v_mul_f32 v10, v10, v144
    v_mfma_f32_32x32x16_bf16 v[58:73], v[96:99], a[56:59], v[58:73]
    s_waitcnt vmcnt(16)
    s_barrier
    ds_read_b128 v[120:123], v2 offset:0
    buffer_load_dwordx4 v2, s[8:11], s42 offen offset:1024 sc1 lds
    v_rcp_f32 v146, v146
    v_mul_f32_e64 v11, v11, v145
    s_waitcnt lgkmcnt(4)
    v_mfma_f32_32x32x16_bf16 v[58:73], v[100:103], a[60:63], v[58:73]
    ds_read_b128 v[92:95], v2 offset:1024
    v_rcp_f32 v147, v147
    v_mul_f32 v12, v12, v146
    v_rcp_f32_e64 v148, v148
    v_mfma_f32_32x32x16_bf16 v[58:73], v[104:107], a[64:67], v[58:73]
    ds_read_b128 v[96:99], v2 offset:2048
    v_mul_f32 v13, v13, v147
    v_rcp_f32 v149, v149
    v_mul_f32 v14, v14, v148
    s_waitcnt lgkmcnt(4)
    v_mfma_f32_32x32x16_bf16 v[58:73], v[108:111], a[68:71], v[58:73]
    ds_read_b128 v[100:103], v2 offset:3072
    buffer_load_dwordx4 v2, s[8:11], s42 offen offset:2048 sc1 lds
    v_rcp_f32 v150, v150
    v_mul_f32 v15, v15, v149
    v_mfma_f32_32x32x16_bf16 v[58:73], v[112:115], a[72:75], v[58:73]
    ds_read_b128 v[104:107], v2 offset:4096
    v_rcp_f32 v151, v151
    v_mul_f32 v16, v16, v150
    v_cvt_pk_bf16_f32 v18, v10, v11
    v_mul_f32 v17, v17, v151
    s_waitcnt lgkmcnt(4)
    v_mfma_f32_32x32x16_bf16 v[58:73], v[116:119], a[76:79], v[58:73]
    ds_read_b128 v[108:111], v2 offset:5120
    buffer_load_dwordx4 v2, s[8:11], s42 offen offset:3072 sc1 lds
    v_cvt_pk_bf16_f32 v19, v12, v13
    v_cvt_pk_bf16_f32 v20, v14, v15
    v_cvt_pk_bf16_f32 v21, v16, v17
    v_mfma_f32_32x32x16_bf16 v[58:73], v[120:123], a[80:83], v[58:73]
    ds_read_b128 v[112:115], v2 offset:6144
    buffer_store_dwordx4 v[18:21], v244, s[8:11], s63 offen offset:0 sc1
    v_mul_f32 v144, v156, v26
    v_mul_f32 v145, v156, v27
    v_mul_f32 v146, v156, v28
    s_waitcnt lgkmcnt(4)
    v_mfma_f32_32x32x16_bf16 v[58:73], v[92:95], a[84:87], v[58:73]
    ds_read_b128 v[116:119], v2 offset:7168
    v_mul_f32 v147, v156, v29
    v_mul_f32 v148, v156, v30
    v_mul_f32 v149, v156, v31
    v_mul_f32 v150, v156, v32
    v_mul_f32_e64 v151, v156, v33
    v_mfma_f32_32x32x16_bf16 v[58:73], v[96:99], a[88:91], v[58:73]
    ds_read_b128 v[120:123], v2 offset:8192
    s_add_u32 m0, s44, 86016
    s_add_u32 s42, s21, 229376
    buffer_load_dwordx4 v2, s[8:11], s42 offen offset:0 sc1 lds
    s_waitcnt lgkmcnt(4)
    v_mfma_f32_32x32x16_bf16 v[58:73], v[100:103], a[92:95], v[58:73]
    ds_read_b128 v[92:95], v2 offset:9216
    v_exp_f32 v144, v144
    v_mul_f32 v26, v26, v34
    v_exp_f32 v145, v145
    v_mfma_f32_32x32x16_bf16 v[58:73], v[104:107], a[96:99], v[58:73]
    ds_read_b128 v[96:99], v2 offset:10240
    s_add_u32 m0, s44, 102400
    s_add_u32 s42, s3, 245760
    buffer_load_dwordx4 v2, s[8:11], s42 offen offset:0 sc1 lds
    v_mul_f32 v27, v27, v35
    s_waitcnt lgkmcnt(4)
    v_mfma_f32_32x32x16_bf16 v[58:73], v[108:111], a[100:103], v[58:73]
    ds_read_b128 v[100:103], v2 offset:11264
    v_exp_f32 v146, v146
    v_mul_f32 v28, v28, v36
    v_exp_f32_e64 v147, v147
    v_mfma_f32_32x32x16_bf16 v[58:73], v[112:115], a[104:107], v[58:73]
    ds_read_b128 v[104:107], v2 offset:12288
    buffer_load_dwordx4 v2, s[8:11], s42 offen offset:1024 sc1 lds
    v_mul_f32 v29, v29, v37
    v_exp_f32_e64 v148, v148
    s_waitcnt lgkmcnt(4)
    v_mfma_f32_32x32x16_bf16 v[58:73], v[116:119], a[108:111], v[58:73]
    ds_read_b128 v[108:111], v2 offset:13312
    v_mul_f32 v30, v30, v38
    v_exp_f32 v149, v149
    v_mul_f32_e64 v31, v31, v39
    v_mfma_f32_32x32x16_bf16 v[58:73], v[120:123], a[112:115], v[58:73]
    ds_read_b128 v[112:115], v2 offset:14336
    v_exp_f32 v150, v150
    v_mul_f32 v32, v32, v40
    v_exp_f32 v151, v151
    s_waitcnt lgkmcnt(4)
    v_mfma_f32_32x32x16_bf16 v[58:73], v[92:95], a[116:119], v[58:73]
    ds_read_b128 v[116:119], v2 offset:15360
    buffer_load_dwordx4 v2, s[8:11], s42 offen offset:2048 sc1 lds
    v_mul_f32_e64 v33, v33, v41
    v_fma_f32 v144, v144, v157, v157
    v_fma_f32 v145, v145, v157, v157
    v_mfma_f32_32x32x16_bf16 v[58:73], v[96:99], a[120:123], v[58:73]
    ds_read_b128 v[120:123], v2 offset:16384
    v_fma_f32 v146, v146, v157, v157
    v_fma_f32 v147, v147, v157, v157
    v_fma_f32 v148, v148, v157, v157
    v_fma_f32 v149, v149, v157, v157
    v_fma_f32 v150, v150, v157, v157
    s_waitcnt lgkmcnt(4)
    v_mfma_f32_32x32x16_bf16 v[58:73], v[100:103], a[124:127], v[58:73]
    ds_read_b128 v[92:95], v2 offset:17408
    buffer_load_dwordx4 v2, s[8:11], s42 offen offset:3072 sc1 lds
    v_fma_f32 v151, v151, v157, v157
    v_rcp_f32 v144, v144
    v_mfma_f32_32x32x16_bf16 v[58:73], v[104:107], a[128:131], v[58:73]
    ds_read_b128 v[96:99], v2 offset:18432
    v_rcp_f32 v145, v145
    v_mul_f32 v26, v26, v144
    v_rcp_f32 v146, v146
    s_waitcnt lgkmcnt(4)
    v_mfma_f32_32x32x16_bf16 v[58:73], v[108:111], a[132:135], v[58:73]
    ds_read_b128 v[100:103], v2 offset:19456
    v_mul_f32_e64 v27, v27, v145
    v_rcp_f32_e64 v147, v147
    v_mul_f32_e64 v28, v28, v146
    v_mfma_f32_32x32x16_bf16 v[58:73], v[112:115], a[136:139], v[58:73]
    ds_read_b128 v[104:107], v240 offset:23552
    s_add_u32 m0, s44, 106496
    s_add_u32 s42, s3, 249856
    buffer_load_dwordx4 v2, s[8:11], s42 offen offset:0 sc1 lds
    s_waitcnt lgkmcnt(4)
    v_mfma_f32_32x32x16_bf16 v[58:73], v[116:119], a[140:143], v[58:73]
    s_waitcnt vmcnt(21)
    s_barrier
    ds_read_b128 v[108:111], v2 offset:20480
    v_rcp_f32 v148, v148
    v_mul_f32 v29, v29, v147
    v_rcp_f32 v149, v149
    v_mfma_f32_32x32x16_bf16 v[58:73], v[120:123], a[144:147], v[58:73]
    ds_read_b128 v[112:115], v2 offset:21504
    s_add_u32 m0, s44, 122880
    s_add_u32 s42, s3, 266240
    buffer_load_dwordx4 v2, s[8:11], s42 offen offset:0 sc1 lds
    v_mul_f32 v30, v30, v148
    s_waitcnt lgkmcnt(4)
    v_mfma_f32_32x32x16_bf16 v[58:73], v[92:95], a[148:151], v[58:73]
    ds_read_b128 v[116:119], v2 offset:22528
    v_rcp_f32 v150, v150
    v_mul_f32 v31, v31, v149
    v_rcp_f32_e64 v151, v151
    v_mfma_f32_32x32x16_bf16 v[58:73], v[96:99], a[152:155], v[58:73]
    ds_read_b128 v[120:123], v2 offset:23552
    buffer_load_dwordx4 v2, s[8:11], s42 offen offset:1024 sc1 lds
    v_mul_f32_e64 v32, v32, v150
    v_cvt_pk_bf16_f32 v34, v26, v27
    v_mul_f32 v33, v33, v151
    s_waitcnt lgkmcnt(4)
    v_mfma_f32_32x32x16_bf16 v[58:73], v[100:103], a[156:159], v[58:73]
    ds_read_b128 v[92:95], v2 offset:24576
    v_cvt_pk_bf16_f32 v35, v28, v29
    v_cvt_pk_bf16_f32 v36, v30, v31
    v_cvt_pk_bf16_f32 v37, v32, v33
    v_mul_f32 v144, v156, v42
    v_mul_f32 v145, v156, v43
    v_mfma_f32_32x32x16_bf16 v[58:73], v[104:107], v[152:155], v[58:73]
    ds_read_b128 v[96:99], v2 offset:25600
    buffer_store_dwordx4 v[34:37], v244, s[8:11], s63 offen offset:512 sc1
    v_mul_f32 v146, v156, v44
    v_mul_f32 v147, v156, v45
    v_mul_f32 v148, v156, v46
    s_waitcnt lgkmcnt(4)
    v_mfma_f32_32x32x16_bf16 v[10:25], v[108:111], a[0:3], 0
    ds_read_b128 v[100:103], v2 offset:26624
    buffer_load_dwordx4 v2, s[8:11], s42 offen offset:2048 sc1 lds
    v_mul_f32 v149, v156, v47
    v_mul_f32 v150, v156, v48
    v_mul_f32 v151, v156, v49
    v_mfma_f32_32x32x16_bf16 v[10:25], v[112:115], a[4:7], v[10:25]
    ds_read_b128 v[104:107], v2 offset:27648
    v_exp_f32 v144, v144
    v_mul_f32 v42, v42, v50
    v_exp_f32 v145, v145
    s_waitcnt lgkmcnt(4)
    v_mfma_f32_32x32x16_bf16 v[10:25], v[116:119], a[8:11], v[10:25]
    ds_read_b128 v[108:111], v2 offset:28672
    buffer_load_dwordx4 v2, s[8:11], s42 offen offset:3072 sc1 lds
    v_mul_f32 v43, v43, v51
    v_exp_f32 v146, v146
    v_mfma_f32_32x32x16_bf16 v[10:25], v[120:123], a[12:15], v[10:25]
    ds_read_b128 v[112:115], v2 offset:29696
    v_mul_f32 v44, v44, v52
    v_exp_f32 v147, v147
    v_mul_f32 v45, v45, v53
    s_waitcnt lgkmcnt(4)
    v_mfma_f32_32x32x16_bf16 v[10:25], v[92:95], a[16:19], v[10:25]
    ds_read_b128 v[116:119], v2 offset:30720
    v_exp_f32 v148, v148
    v_mul_f32 v46, v46, v54
    v_exp_f32 v149, v149
    v_mfma_f32_32x32x16_bf16 v[10:25], v[96:99], a[20:23], v[10:25]
    ds_read_b128 v[120:123], v2 offset:31744
    s_add_u32 m0, s44, 126976
    s_add_u32 s42, s3, 270336
    buffer_load_dwordx4 v2, s[8:11], s42 offen offset:0 sc1 lds
    v_mul_f32 v47, v47, v55
    s_waitcnt lgkmcnt(4)
    v_mfma_f32_32x32x16_bf16 v[10:25], v[100:103], a[24:27], v[10:25]
    ds_read_b128 v[92:95], v2 offset:32768
    v_exp_f32 v150, v150
    v_mul_f32 v48, v48, v56
    v_exp_f32_e64 v151, v151
    v_mfma_f32_32x32x16_bf16 v[10:25], v[104:107], a[28:31], v[10:25]
    ds_read_b128 v[96:99], v2 offset:33792
    buffer_load_dwordx4 v[158:161], v5, s[8:11], s43 offen offset:0 sc1
    v_mul_f32 v49, v49, v57
    v_fma_f32 v144, v144, v157, v157
    v_fma_f32 v145, v145, v157, v157
    s_waitcnt lgkmcnt(4)
    v_mfma_f32_32x32x16_bf16 v[10:25], v[108:111], a[32:35], v[10:25]
    ds_read_b128 v[100:103], v2 offset:34816
    v_fma_f32 v146, v146, v157, v157
    v_fma_f32 v147, v147, v157, v157
    v_fma_f32 v148, v148, v157, v157
    v_fma_f32 v149, v149, v157, v157
    v_fma_f32 v150, v150, v157, v157
    v_mfma_f32_32x32x16_bf16 v[10:25], v[112:115], a[36:39], v[10:25]
    ds_read_b128 v[104:107], v2 offset:35840
    s_add_u32 s43, s26, 5120
    buffer_load_dwordx4 v[162:165], v2, s[8:11], s43 offen offset:0 sc1
    v_fma_f32 v151, v151, v157, v157
    s_waitcnt lgkmcnt(4)
    v_mfma_f32_32x32x16_bf16 v[10:25], v[116:119], a[40:43], v[10:25]
    ds_read_b128 v[108:111], v2 offset:36864
    v_rcp_f32 v144, v144
    v_rcp_f32 v145, v145
    v_mul_f32 v42, v42, v144
    v_mfma_f32_32x32x16_bf16 v[10:25], v[120:123], a[44:47], v[10:25]
    ds_read_b128 v[112:115], v2 offset:37888
    v_rcp_f32 v146, v146
    v_mul_f32 v43, v43, v145
    v_rcp_f32 v147, v147
    s_waitcnt lgkmcnt(4)
    v_mfma_f32_32x32x16_bf16 v[10:25], v[92:95], a[48:51], v[10:25]
    ds_read_b128 v[116:119], v2 offset:38912
    buffer_load_dwordx4 v[166:169], v2, s[8:11], s43 offen offset:1024 sc1
    v_mul_f32 v44, v44, v146
    v_rcp_f32 v148, v148
    v_mfma_f32_32x32x16_bf16 v[10:25], v[96:99], a[52:55], v[10:25]
    ds_read_b128 v[120:123], v2 offset:39936
    v_mul_f32 v45, v45, v147
    v_rcp_f32 v149, v149
    v_mul_f32 v46, v46, v148
    s_waitcnt lgkmcnt(4)
    v_mfma_f32_32x32x16_bf16 v[10:25], v[100:103], a[56:59], v[10:25]
    s_waitcnt vmcnt(25)
    s_barrier
    ds_read_b128 v[92:95], v2 offset:40960
    buffer_load_dwordx4 v[170:173], v2, s[8:11], s43 offen offset:2048 sc1
    v_rcp_f32 v150, v150
    v_mul_f32 v47, v47, v149
    v_mfma_f32_32x32x16_bf16 v[10:25], v[104:107], a[60:63], v[10:25]
    ds_read_b128 v[96:99], v2 offset:41984
    v_rcp_f32 v151, v151
    v_mul_f32 v48, v48, v150
    v_cvt_pk_bf16_f32 v50, v42, v43
    v_mul_f32 v49, v49, v151
    s_waitcnt lgkmcnt(4)
    v_mfma_f32_32x32x16_bf16 v[10:25], v[108:111], a[64:67], v[10:25]
    ds_read_b128 v[100:103], v2 offset:43008
    v_cvt_pk_bf16_f32 v51, v44, v45
    v_cvt_pk_bf16_f32 v52, v46, v47
    v_cvt_pk_bf16_f32 v53, v48, v49
    v_mul_f32 v144, v156, v58
    v_mul_f32 v145, v156, v59
    v_mfma_f32_32x32x16_bf16 v[10:25], v[112:115], a[68:71], v[10:25]
    ds_read_b128 v[104:107], v2 offset:44032
    buffer_store_dwordx4 v[50:53], v244, s[8:11], s63 offen offset:1024 sc1
    v_mul_f32 v146, v156, v60
    v_mul_f32 v147, v156, v61
    v_mul_f32_e64 v148, v156, v62
    s_waitcnt lgkmcnt(4)
    v_mfma_f32_32x32x16_bf16 v[10:25], v[116:119], a[72:75], v[10:25]
    ds_read_b128 v[108:111], v2 offset:45056
    s_add_u32 m0, s44, 0
    s_add_u32 s42, s28, 5120
    buffer_load_dwordx4 v2, s[8:11], s42 offen offset:0 sc1 lds
    v_mul_f32_e64 v149, v156, v63
    v_mfma_f32_32x32x16_bf16 v[10:25], v[120:123], a[76:79], v[10:25]
    ds_read_b128 v[112:115], v2 offset:46080
    s_waitcnt vmcnt(9)
    s_mov_b64 exec, 0xf
    buffer_store_dword v6, v7, s[8:11], s65 offen offset:0 sc1
    s_mov_b64 exec, -1
    v_mul_f32 v150, v156, v64
    s_waitcnt lgkmcnt(4)
    v_mfma_f32_32x32x16_bf16 v[10:25], v[92:95], a[80:83], v[10:25]
    ds_read_b128 v[116:119], v2 offset:47104
    buffer_load_dwordx4 v2, s[8:11], s42 offen offset:1024 sc1 lds
    v_mul_f32 v151, v156, v65
    v_exp_f32 v144, v144
    v_mfma_f32_32x32x16_bf16 v[10:25], v[96:99], a[84:87], v[10:25]
    ds_read_b128 v[120:123], v2 offset:48128
    v_mul_f32 v58, v58, v66
    v_exp_f32 v145, v145
    v_mul_f32 v59, v59, v67
    s_waitcnt lgkmcnt(4)
    v_mfma_f32_32x32x16_bf16 v[10:25], v[100:103], a[88:91], v[10:25]
    ds_read_b128 v[92:95], v2 offset:49152
    buffer_load_dwordx4 v2, s[8:11], s42 offen offset:2048 sc1 lds
    v_exp_f32 v146, v146
    v_mul_f32 v60, v60, v68
    v_mfma_f32_32x32x16_bf16 v[10:25], v[104:107], a[92:95], v[10:25]
    ds_read_b128 v[96:99], v2 offset:50176
    v_exp_f32 v147, v147
    v_mul_f32 v61, v61, v69
    v_exp_f32 v148, v148
    s_waitcnt lgkmcnt(4)
    v_mfma_f32_32x32x16_bf16 v[10:25], v[108:111], a[96:99], v[10:25]
    ds_read_b128 v[100:103], v2 offset:51200
    v_mul_f32 v62, v62, v70
    v_exp_f32 v149, v149
    v_mul_f32 v63, v63, v71
    v_mfma_f32_32x32x16_bf16 v[10:25], v[112:115], a[100:103], v[10:25]
    ds_read_b128 v[104:107], v2 offset:52224
    buffer_load_dwordx4 v2, s[8:11], s42 offen offset:3072 sc1 lds
    v_exp_f32 v150, v150
    v_mul_f32 v64, v64, v72
    s_waitcnt lgkmcnt(4)
    v_mfma_f32_32x32x16_bf16 v[10:25], v[116:119], a[104:107], v[10:25]
    ds_read_b128 v[108:111], v2 offset:53248
    v_exp_f32 v151, v151
    v_mul_f32 v65, v65, v73
    v_fma_f32 v144, v144, v157, v157
    v_fma_f32 v145, v145, v157, v157
    v_mfma_f32_32x32x16_bf16 v[10:25], v[120:123], a[108:111], v[10:25]
    ds_read_b128 v[112:115], v2 offset:54272
    s_add_u32 m0, s44, 4096
    s_add_u32 s42, s28, 9216
    buffer_load_dwordx4 v2, s[8:11], s42 offen offset:0 sc1 lds
    v_fma_f32 v146, v146, v157, v157
    s_waitcnt lgkmcnt(4)
    v_mfma_f32_32x32x16_bf16 v[10:25], v[92:95], a[112:115], v[10:25]
    ds_read_b128 v[116:119], v2 offset:55296
    v_fma_f32 v147, v147, v157, v157
    v_fma_f32 v148, v148, v157, v157
    v_fma_f32 v149, v149, v157, v157
    v_fma_f32 v150, v150, v157, v157
    v_fma_f32 v151, v151, v157, v157
    v_mfma_f32_32x32x16_bf16 v[10:25], v[96:99], a[116:119], v[10:25]
    ds_read_b128 v[120:123], v2 offset:56320
    v_rcp_f32 v144, v144
    v_rcp_f32 v145, v145
    v_mul_f32 v58, v58, v144
    s_waitcnt lgkmcnt(4)
    v_mfma_f32_32x32x16_bf16 v[10:25], v[100:103], a[120:123], v[10:25]
    ds_read_b128 v[92:95], v2 offset:57344
    buffer_load_dwordx4 v[174:177], v2, s[8:11], s43 offen offset:3072 sc1
    v_rcp_f32 v146, v146
    v_mul_f32 v59, v59, v145
    v_mfma_f32_32x32x16_bf16 v[10:25], v[104:107], a[124:127], v[10:25]
    ds_read_b128 v[96:99], v2 offset:58368
    v_rcp_f32 v147, v147
    v_mul_f32 v60, v60, v146
    v_rcp_f32 v148, v148
    s_waitcnt lgkmcnt(4)
    v_mfma_f32_32x32x16_bf16 v[10:25], v[108:111], a[128:131], v[10:25]
    ds_read_b128 v[100:103], v2 offset:59392
    buffer_load_dwordx4 v[188:191], v5, s[8:11], s43 offen offset:0 sc1
    v_mul_f32 v61, v61, v147
    v_rcp_f32 v149, v149
    v_mfma_f32_32x32x16_bf16 v[10:25], v[112:115], a[132:135], v[10:25]
    ds_read_b128 v[104:107], v2 offset:60416
    v_mul_f32 v62, v62, v148
    v_rcp_f32 v150, v150
    v_mul_f32 v63, v63, v149
    s_waitcnt lgkmcnt(4)
    v_mfma_f32_32x32x16_bf16 v[10:25], v[116:119], a[136:139], v[10:25]
    ds_read_b128 v[108:111], v240 offset:24576
    s_add_u32 s43, s27, 5120
    buffer_load_dwordx4 v[192:195], v2, s[8:11], s43 offen offset:0 sc1
    v_rcp_f32_e64 v151, v151
    v_mfma_f32_32x32x16_bf16 v[10:25], v[120:123], a[140:143], v[10:25]
    s_barrier
    ds_read_b128 v[112:115], v239 offset:0
    v_mul_f32 v64, v64, v150
    v_cvt_pk_bf16_f32 v66, v58, v59
    v_mul_f32 v65, v65, v151
    v_cvt_pk_bf16_f32 v67, v60, v61
    v_cvt_pk_bf16_f32 v68, v62, v63
    s_waitcnt lgkmcnt(4)
    v_mfma_f32_32x32x16_bf16 v[10:25], v[92:95], a[144:147], v[10:25]
    ds_read_b128 v[116:119], v239 offset:1024
    v_cvt_pk_bf16_f32 v69, v64, v65
    v_mfma_f32_32x32x16_bf16 v[10:25], v[96:99], a[148:151], v[10:25]
    ds_read_b128 v[120:123], v239 offset:2048
    buffer_store_dwordx4 v[66:69], v244, s[8:11], s63 offen offset:1536 sc1
    s_waitcnt lgkmcnt(4)
    v_mfma_f32_32x32x16_bf16 v[10:25], v[100:103], a[152:155], v[10:25]
    ds_read_b128 v[92:95], v239 offset:3072
    s_add_u32 m0, s44, 20480
    s_add_u32 s42, s25, 10240
    buffer_load_dwordx4 v2, s[8:11], s42 offen offset:0 sc1 lds
    v_mfma_f32_32x32x16_bf16 v[10:25], v[104:107], a[156:159], v[10:25]
    ds_read_b128 v[96:99], v239 offset:4096
    s_waitcnt lgkmcnt(4)
    v_mfma_f32_32x32x16_bf16 v[10:25], v[108:111], v[152:155], v[10:25]
    ds_read_b128 v[100:103], v239 offset:5120
    buffer_load_dwordx4 v2, s[8:11], s42 offen offset:1024 sc1 lds
    v_mfma_f32_32x32x16_bf16 v[26:41], v[112:115], a[0:3], 0
    ds_read_b128 v[104:107], v239 offset:6144
    s_waitcnt lgkmcnt(4)
    v_mfma_f32_32x32x16_bf16 v[26:41], v[116:119], a[4:7], v[26:41]
    ds_read_b128 v[108:111], v239 offset:7168
    buffer_load_dwordx4 v2, s[8:11], s42 offen offset:2048 sc1 lds
    v_mfma_f32_32x32x16_bf16 v[26:41], v[120:123], a[8:11], v[26:41]
    ds_read_b128 v[112:115], v239 offset:8192
    s_waitcnt lgkmcnt(4)
    v_mfma_f32_32x32x16_bf16 v[26:41], v[92:95], a[12:15], v[26:41]
    ds_read_b128 v[116:119], v239 offset:9216
    v_mfma_f32_32x32x16_bf16 v[26:41], v[96:99], a[16:19], v[26:41]
    ds_read_b128 v[120:123], v239 offset:10240
    buffer_load_dwordx4 v2, s[8:11], s42 offen offset:3072 sc1 lds
    v_mul_f32 v144, v156, v10
    v_mul_f32 v145, v156, v11
    v_mul_f32 v146, v156, v12
    s_waitcnt lgkmcnt(4)
    v_mfma_f32_32x32x16_bf16 v[26:41], v[100:103], a[20:23], v[26:41]
    ds_read_b128 v[92:95], v239 offset:11264
    v_mul_f32 v147, v156, v13
    v_mul_f32 v148, v156, v14
    v_mul_f32 v149, v156, v15
    v_mul_f32 v150, v156, v16
    v_mul_f32_e64 v151, v156, v17
    v_mfma_f32_32x32x16_bf16 v[26:41], v[104:107], a[24:27], v[26:41]
    ds_read_b128 v[96:99], v239 offset:12288
    s_add_u32 m0, s44, 24576
    s_add_u32 s42, s25, 14336
    buffer_load_dwordx4 v2, s[8:11], s42 offen offset:0 sc1 lds
    s_waitcnt lgkmcnt(4)
    v_mfma_f32_32x32x16_bf16 v[26:41], v[108:111], a[28:31], v[26:41]
    ds_read_b128 v[100:103], v239 offset:13312
    v_exp_f32 v144, v144
    v_mul_f32 v10, v10, v18
    v_exp_f32 v145, v145
    v_mfma_f32_32x32x16_bf16 v[26:41], v[112:115], a[32:35], v[26:41]
    ds_read_b128 v[104:107], v239 offset:14336
    v_mul_f32 v11, v11, v19
    v_exp_f32 v146, v146
    v_mul_f32 v12, v12, v20
    s_waitcnt lgkmcnt(4)
    v_mfma_f32_32x32x16_bf16 v[26:41], v[116:119], a[36:39], v[26:41]
    ds_read_b128 v[108:111], v239 offset:15360
    buffer_load_dwordx4 v[196:199], v2, s[8:11], s43 offen offset:1024 sc1
    v_exp_f32 v147, v147
    v_mul_f32 v13, v13, v21
    v_mfma_f32_32x32x16_bf16 v[26:41], v[120:123], a[40:43], v[26:41]
    ds_read_b128 v[112:115], v239 offset:16384
    v_exp_f32 v148, v148
    v_mul_f32 v14, v14, v22
    v_exp_f32 v149, v149
    s_waitcnt lgkmcnt(4)
    v_mfma_f32_32x32x16_bf16 v[26:41], v[92:95], a[44:47], v[26:41]
    ds_read_b128 v[116:119], v239 offset:17408
    buffer_load_dwordx4 v[200:203], v2, s[8:11], s43 offen offset:2048 sc1
    v_mul_f32 v15, v15, v23
    v_exp_f32 v150, v150
    v_mfma_f32_32x32x16_bf16 v[26:41], v[96:99], a[48:51], v[26:41]
    ds_read_b128 v[120:123], v239 offset:18432
    v_mul_f32 v16, v16, v24
    v_exp_f32 v151, v151
    v_mul_f32 v17, v17, v25
    v_fma_f32 v144, v144, v157, v157
    s_waitcnt lgkmcnt(4)
    v_mfma_f32_32x32x16_bf16 v[26:41], v[100:103], a[52:55], v[26:41]
    ds_read_b128 v[92:95], v239 offset:19456
    buffer_load_dwordx4 v[204:207], v2, s[8:11], s43 offen offset:3072 sc1
    v_fma_f32 v145, v145, v157, v157
    v_fma_f32 v146, v146, v157, v157
    v_fma_f32 v147, v147, v157, v157
    v_mfma_f32_32x32x16_bf16 v[26:41], v[104:107], a[56:59], v[26:41]
    s_barrier
    ds_read_b128 v[96:99], v239 offset:20480
    v_fma_f32 v148, v148, v157, v157
    v_fma_f32 v149, v149, v157, v157
    v_fma_f32 v150, v150, v157, v157
    v_fma_f32 v151, v151, v157, v157
    s_waitcnt lgkmcnt(4)
    v_mfma_f32_32x32x16_bf16 v[26:41], v[108:111], a[60:63], v[26:41]
    ds_read_b128 v[100:103], v239 offset:21504
    v_rcp_f32 v144, v144
    v_rcp_f32 v145, v145
    v_mul_f32_e64 v10, v10, v144
    v_mfma_f32_32x32x16_bf16 v[26:41], v[112:115], a[64:67], v[26:41]
    ds_read_b128 v[104:107], v239 offset:22528
    s_waitcnt vmcnt(8)
    s_mov_b64 exec, 0xf
    buffer_store_dword v6, v7, s[8:11], s65 offen offset:512 sc1
    s_mov_b64 exec, -1
    s_waitcnt lgkmcnt(4)
    v_mfma_f32_32x32x16_bf16 v[26:41], v[116:119], a[68:71], v[26:41]
    ds_read_b128 v[108:111], v239 offset:23552
    s_mov_b32 exec_hi, 0x0
    buffer_load_dword v8, v245, s[8:11], s66 offen offset:0 sc1
    s_mov_b64 exec, -1
    v_mfma_f32_32x32x16_bf16 v[26:41], v[120:123], a[72:75], v[26:41]
    ds_read_b128 v[112:115], v239 offset:24576
    s_add_u32 m0, s44, 40960
    s_add_u32 s42, s26, 10240
    buffer_load_dwordx4 v2, s[8:11], s42 offen offset:0 sc1 lds
    s_waitcnt lgkmcnt(4)
    v_mfma_f32_32x32x16_bf16 v[26:41], v[92:95], a[76:79], v[26:41]
    ds_read_b128 v[116:119], v239 offset:25600
    v_rcp_f32 v146, v146
    v_mul_f32 v11, v11, v145
    v_rcp_f32 v147, v147
    v_mfma_f32_32x32x16_bf16 v[26:41], v[96:99], a[80:83], v[26:41]
    ds_read_b128 v[120:123], v239 offset:26624
    buffer_load_dwordx4 v2, s[8:11], s42 offen offset:1024 sc1 lds
    v_mul_f32 v12, v12, v146
    v_rcp_f32 v148, v148
    s_waitcnt lgkmcnt(4)
    v_mfma_f32_32x32x16_bf16 v[26:41], v[100:103], a[84:87], v[26:41]
    ds_read_b128 v[92:95], v239 offset:27648
    v_mul_f32 v13, v13, v147
    v_rcp_f32 v149, v149
    v_mul_f32 v14, v14, v148
    v_mfma_f32_32x32x16_bf16 v[26:41], v[104:107], a[88:91], v[26:41]
    ds_read_b128 v[96:99], v239 offset:28672
    buffer_load_dwordx4 v2, s[8:11], s42 offen offset:2048 sc1 lds
    v_rcp_f32 v150, v150
    v_mul_f32 v15, v15, v149
    s_waitcnt lgkmcnt(4)
    v_mfma_f32_32x32x16_bf16 v[26:41], v[108:111], a[92:95], v[26:41]
    ds_read_b128 v[100:103], v239 offset:29696
    v_rcp_f32 v151, v151
    v_mul_f32 v16, v16, v150
    v_cvt_pk_bf16_f32 v18, v10, v11
    v_mul_f32_e64 v17, v17, v151
    v_mfma_f32_32x32x16_bf16 v[26:41], v[112:115], a[96:99], v[26:41]
    ds_read_b128 v[104:107], v239 offset:30720
    v_cvt_pk_bf16_f32 v19, v12, v13
    v_cvt_pk_bf16_f32 v20, v14, v15
    v_cvt_pk_bf16_f32 v21, v16, v17
    s_waitcnt lgkmcnt(4)
    v_mfma_f32_32x32x16_bf16 v[26:41], v[116:119], a[100:103], v[26:41]
    ds_read_b128 v[108:111], v239 offset:31744
    buffer_store_dwordx4 v[18:21], v244, s[8:11], s63 offen offset:2048 sc1
    v_mfma_f32_32x32x16_bf16 v[26:41], v[120:123], a[104:107], v[26:41]
    ds_read_b128 v[112:115], v239 offset:32768
    buffer_load_dwordx4 v2, s[8:11], s42 offen offset:3072 sc1 lds
    s_waitcnt lgkmcnt(4)
    v_mfma_f32_32x32x16_bf16 v[26:41], v[92:95], a[108:111], v[26:41]
    ds_read_b128 v[116:119], v239 offset:33792
    v_mfma_f32_32x32x16_bf16 v[26:41], v[96:99], a[112:115], v[26:41]
    ds_read_b128 v[120:123], v239 offset:34816
    s_add_u32 m0, s44, 45056
    s_add_u32 s42, s26, 14336
    buffer_load_dwordx4 v2, s[8:11], s42 offen offset:0 sc1 lds
    s_waitcnt lgkmcnt(4)
    v_mfma_f32_32x32x16_bf16 v[26:41], v[100:103], a[116:119], v[26:41]
    ds_read_b128 v[92:95], v239 offset:35840
    v_mfma_f32_32x32x16_bf16 v[26:41], v[104:107], a[120:123], v[26:41]
    ds_read_b128 v[96:99], v239 offset:36864
    buffer_load_dwordx4 v[58:61], v5, s[8:11], s43 offen offset:0 sc1
    s_waitcnt lgkmcnt(4)
    v_mfma_f32_32x32x16_bf16 v[26:41], v[108:111], a[124:127], v[26:41]
    ds_read_b128 v[100:103], v239 offset:37888
    v_mfma_f32_32x32x16_bf16 v[26:41], v[112:115], a[128:131], v[26:41]
    ds_read_b128 v[104:107], v239 offset:38912
    s_waitcnt lgkmcnt(4)
    v_mfma_f32_32x32x16_bf16 v[26:41], v[116:119], a[132:135], v[26:41]
    ds_read_b128 v[108:111], v239 offset:39936
    v_mfma_f32_32x32x16_bf16 v[26:41], v[120:123], a[136:139], v[26:41]
    ds_read_b128 v[112:115], v240 offset:25600
    s_waitcnt lgkmcnt(4)
    v_mfma_f32_32x32x16_bf16 v[26:41], v[92:95], a[140:143], v[26:41]
    s_barrier
    ds_read_b128 v[116:119], v239 offset:40960
    v_mfma_f32_32x32x16_bf16 v[26:41], v[96:99], a[144:147], v[26:41]
    ds_read_b128 v[120:123], v239 offset:41984
    s_add_u32 m0, s44, 61440
    s_add_u32 s42, s27, 10240
    buffer_load_dwordx4 v2, s[8:11], s42 offen offset:0 sc1 lds
    s_waitcnt lgkmcnt(4)
    v_mfma_f32_32x32x16_bf16 v[26:41], v[100:103], a[148:151], v[26:41]
    ds_read_b128 v[92:95], v239 offset:43008
    s_waitcnt vmcnt(8)
    v_cmp_ne_u32 vcc, s45, v8
    s_nop 0
    s_and_b32 vcc_lo, vcc_lo, 0xffffffff
    s_cbranch_scc1 Ls_a0
Lr_a0:
    v_mfma_f32_32x32x16_bf16 v[26:41], v[104:107], a[152:155], v[26:41]
    ds_read_b128 v[96:99], v239 offset:44032
    buffer_load_dwordx4 v[62:65], v209, s[8:11], s31 offen offset:0 sc1
    s_waitcnt lgkmcnt(4)
    v_mfma_f32_32x32x16_bf16 v[26:41], v[108:111], a[156:159], v[26:41]
    ds_read_b128 v[100:103], v239 offset:45056
    v_mfma_f32_32x32x16_bf16 v[26:41], v[112:115], v[152:155], v[26:41]
    ds_read_b128 v[104:107], v239 offset:46080
    buffer_load_dwordx4 v[66:69], v210, s[8:11], s31 offen offset:0 sc1
    s_waitcnt lgkmcnt(4)
    v_mfma_f32_32x32x16_bf16 v[42:57], v[116:119], a[0:3], 0
    ds_read_b128 v[108:111], v239 offset:47104
    v_mfma_f32_32x32x16_bf16 v[42:57], v[120:123], a[4:7], v[42:57]
    ds_read_b128 v[112:115], v239 offset:48128
    s_waitcnt lgkmcnt(4)
    v_mfma_f32_32x32x16_bf16 v[42:57], v[92:95], a[8:11], v[42:57]
    ds_read_b128 v[116:119], v239 offset:49152
    buffer_load_dwordx4 a[0:3], v211, s[8:11], s31 offen offset:0 sc1
    v_mfma_f32_32x32x16_bf16 v[42:57], v[96:99], a[12:15], v[42:57]
    ds_read_b128 v[120:123], v239 offset:50176
    s_waitcnt lgkmcnt(4)
    v_mfma_f32_32x32x16_bf16 v[42:57], v[100:103], a[16:19], v[42:57]
    ds_read_b128 v[92:95], v239 offset:51200
    buffer_load_dwordx4 a[4:7], v208, s[8:11], s31 offen offset:0 sc1
    v_mul_f32 v144, v156, v26
    v_mul_f32 v145, v156, v27
    v_mul_f32 v146, v156, v28
    v_mfma_f32_32x32x16_bf16 v[42:57], v[104:107], a[20:23], v[42:57]
    ds_read_b128 v[96:99], v239 offset:52224
    v_mul_f32 v147, v156, v29
    v_mul_f32 v148, v156, v30
    v_mul_f32 v149, v156, v31
    v_mul_f32 v150, v156, v32
    v_mul_f32 v151, v156, v33
    s_waitcnt lgkmcnt(4)
    v_mfma_f32_32x32x16_bf16 v[42:57], v[108:111], a[24:27], v[42:57]
    ds_read_b128 v[100:103], v239 offset:53248
    v_exp_f32 v144, v144
    v_mul_f32 v26, v26, v34
    v_exp_f32 v145, v145
    v_mfma_f32_32x32x16_bf16 v[42:57], v[112:115], a[28:31], v[42:57]
    ds_read_b128 v[104:107], v239 offset:54272
    buffer_load_dwordx4 a[8:11], v209, s[8:11], s32 offen offset:0 sc1
    v_mul_f32 v27, v27, v35
    v_exp_f32 v146, v146
    s_waitcnt lgkmcnt(4)
    v_mfma_f32_32x32x16_bf16 v[42:57], v[116:119], a[32:35], v[42:57]
    ds_read_b128 v[108:111], v239 offset:55296
    v_mul_f32 v28, v28, v36
    v_exp_f32 v147, v147
    v_mul_f32 v29, v29, v37
    v_mfma_f32_32x32x16_bf16 v[42:57], v[120:123], a[36:39], v[42:57]
    ds_read_b128 v[112:115], v239 offset:56320
    buffer_load_dwordx4 a[12:15], v210, s[8:11], s32 offen offset:0 sc1
    v_exp_f32 v148, v148
    v_mul_f32 v30, v30, v38
    s_waitcnt lgkmcnt(4)
    v_mfma_f32_32x32x16_bf16 v[42:57], v[92:95], a[40:43], v[42:57]
    ds_read_b128 v[116:119], v239 offset:57344
    v_exp_f32 v149, v149
    v_mul_f32 v31, v31, v39
    v_exp_f32 v150, v150
    v_mfma_f32_32x32x16_bf16 v[42:57], v[96:99], a[44:47], v[42:57]
    ds_read_b128 v[120:123], v239 offset:58368
    buffer_load_dwordx4 a[16:19], v211, s[8:11], s32 offen offset:0 sc1
    v_mul_f32 v32, v32, v40
    v_exp_f32 v151, v151
    s_waitcnt lgkmcnt(4)
    v_mfma_f32_32x32x16_bf16 v[42:57], v[100:103], a[48:51], v[42:57]
    ds_read_b128 v[92:95], v239 offset:59392
    s_mov_b32 exec_hi, 0x0
    buffer_load_dword v8, v245, s[8:11], s66 offen offset:512 sc1
    s_mov_b64 exec, -1
    v_mul_f32 v33, v33, v41
    v_mfma_f32_32x32x16_bf16 v[42:57], v[104:107], a[52:55], v[42:57]
    ds_read_b128 v[96:99], v239 offset:60416
    v_fma_f32 v144, v144, v157, v157
    v_fma_f32 v145, v145, v157, v157
    v_fma_f32 v146, v146, v157, v157
    v_fma_f32 v147, v147, v157, v157
    v_fma_f32 v148, v148, v157, v157
    s_waitcnt lgkmcnt(4)
    v_mfma_f32_32x32x16_bf16 v[42:57], v[108:111], a[56:59], v[42:57]
    s_barrier
    ds_read_b128 v[100:103], v240 offset:0
    buffer_load_dwordx4 a[20:23], v208, s[8:11], s32 offen offset:0 sc1
    v_fma_f32 v149, v149, v157, v157
    v_fma_f32 v150, v150, v157, v157
    v_fma_f32 v151, v151, v157, v157
    v_mfma_f32_32x32x16_bf16 v[42:57], v[112:115], a[60:63], v[42:57]
    ds_read_b128 v[104:107], v240 offset:1024
    v_rcp_f32 v144, v144
    v_rcp_f32 v145, v145
    v_mul_f32 v26, v26, v144
    s_waitcnt lgkmcnt(4)
    v_mfma_f32_32x32x16_bf16 v[42:57], v[116:119], a[64:67], v[42:57]
    ds_read_b128 v[108:111], v240 offset:2048
    buffer_load_dwordx4 a[24:27], v209, s[8:11], s33 offen offset:0 sc1
    v_rcp_f32 v146, v146
    v_mul_f32 v27, v27, v145
    v_mfma_f32_32x32x16_bf16 v[42:57], v[120:123], a[68:71], v[42:57]
    ds_read_b128 v[112:115], v240 offset:3072
    v_rcp_f32 v147, v147
    v_mul_f32 v28, v28, v146
    v_rcp_f32 v148, v148
    s_waitcnt lgkmcnt(4)
    v_mfma_f32_32x32x16_bf16 v[42:57], v[92:95], a[72:75], v[42:57]
    ds_read_b128 v[116:119], v240 offset:4096
    v_mul_f32 v29, v29, v147
    v_rcp_f32 v149, v149
    v_mul_f32_e64 v30, v30, v148
    v_mfma_f32_32x32x16_bf16 v[42:57], v[96:99], a[76:79], v[42:57]
    ds_read_b128 v[120:123], v240 offset:5120
    buffer_load_dwordx4 a[28:31], v210, s[8:11], s33 offen offset:0 sc1
    v_rcp_f32 v150, v150
    v_mul_f32 v31, v31, v149
    s_waitcnt lgkmcnt(4)
    v_mfma_f32_32x32x16_bf16 v[42:57], v[100:103], a[80:83], v[42:57]
    ds_read_b128 v[92:95], v240 offset:6144
    v_rcp_f32 v151, v151
    v_mul_f32_e64 v32, v32, v150
    v_cvt_pk_bf16_f32 v34, v26, v27
    v_mul_f32 v33, v33, v151
    v_mfma_f32_32x32x16_bf16 v[42:57], v[104:107], a[84:87], v[42:57]
    ds_read_b128 v[96:99], v240 offset:7168
    buffer_load_dwordx4 a[32:35], v211, s[8:11], s33 offen offset:0 sc1
    v_cvt_pk_bf16_f32 v35, v28, v29
    v_cvt_pk_bf16_f32 v36, v30, v31
    v_cvt_pk_bf16_f32 v37, v32, v33
    s_waitcnt lgkmcnt(4)
    v_mfma_f32_32x32x16_bf16 v[42:57], v[108:111], a[88:91], v[42:57]
    ds_read_b128 v[100:103], v240 offset:8192
    buffer_store_dwordx4 v[34:37], v244, s[8:11], s63 offen offset:2560 sc1
    v_mfma_f32_32x32x16_bf16 v[42:57], v[112:115], a[92:95], v[42:57]
    ds_read_b128 v[104:107], v240 offset:9216
    buffer_load_dwordx4 a[36:39], v208, s[8:11], s33 offen offset:0 sc1
    s_waitcnt lgkmcnt(4)
    v_mfma_f32_32x32x16_bf16 v[42:57], v[116:119], a[96:99], v[42:57]
    ds_read_b128 v[108:111], v240 offset:10240
    v_mfma_f32_32x32x16_bf16 v[42:57], v[120:123], a[100:103], v[42:57]
    ds_read_b128 v[112:115], v240 offset:11264
    s_waitcnt lgkmcnt(4)
    v_mfma_f32_32x32x16_bf16 v[42:57], v[92:95], a[104:107], v[42:57]
    ds_read_b128 v[116:119], v240 offset:12288
    buffer_load_dwordx4 a[40:43], v209, s[8:11], s36 offen offset:0 sc1
    v_mfma_f32_32x32x16_bf16 v[42:57], v[96:99], a[108:111], v[42:57]
    ds_read_b128 v[120:123], v240 offset:13312
    s_waitcnt lgkmcnt(4)
    v_mfma_f32_32x32x16_bf16 v[42:57], v[100:103], a[112:115], v[42:57]
    ds_read_b128 v[92:95], v240 offset:14336
    buffer_load_dwordx4 a[44:47], v210, s[8:11], s36 offen offset:0 sc1
    v_mfma_f32_32x32x16_bf16 v[42:57], v[104:107], a[116:119], v[42:57]
    ds_read_b128 v[96:99], v240 offset:15360
    s_waitcnt lgkmcnt(4)
    v_mfma_f32_32x32x16_bf16 v[42:57], v[108:111], a[120:123], v[42:57]
    ds_read_b128 v[100:103], v240 offset:16384
    v_mfma_f32_32x32x16_bf16 v[42:57], v[112:115], a[124:127], v[42:57]
    ds_read_b128 v[104:107], v240 offset:17408
    buffer_load_dwordx4 a[48:51], v211, s[8:11], s36 offen offset:0 sc1
    s_waitcnt lgkmcnt(4)
    v_mfma_f32_32x32x16_bf16 v[42:57], v[116:119], a[128:131], v[42:57]
    ds_read_b128 v[108:111], v240 offset:18432
    s_waitcnt vmcnt(9)
    v_cmp_ne_u32_e64 vcc, s45, v8
    s_nop 0
    s_and_b32 vcc_lo, vcc_lo, 0xffffffff
    s_cbranch_scc1 Ls_a1
Lr_a1:
    v_mfma_f32_32x32x16_bf16 v[42:57], v[120:123], a[132:135], v[42:57]
    ds_read_b128 v[112:115], v240 offset:19456
    buffer_load_dwordx4 a[52:55], v208, s[8:11], s36 offen offset:0 sc1
    s_waitcnt lgkmcnt(4)
    v_mfma_f32_32x32x16_bf16 v[42:57], v[92:95], a[136:139], v[42:57]
    ds_read_b128 v[116:119], v240 offset:26624
    v_mfma_f32_32x32x16_bf16 v[42:57], v[96:99], a[140:143], v[42:57]
    buffer_load_dwordx4 a[56:59], v209, s[8:11], s31 offen offset:1024 sc1
    s_waitcnt lgkmcnt(3)
    v_mfma_f32_32x32x16_bf16 v[42:57], v[100:103], a[144:147], v[42:57]
    v_mfma_f32_32x32x16_bf16 v[42:57], v[104:107], a[148:151], v[42:57]
    s_waitcnt lgkmcnt(1)
    v_mfma_f32_32x32x16_bf16 v[42:57], v[108:111], a[152:155], v[42:57]
    buffer_load_dwordx4 a[60:63], v210, s[8:11], s31 offen offset:1024 sc1
    v_mfma_f32_32x32x16_bf16 v[42:57], v[112:115], a[156:159], v[42:57]
    s_waitcnt lgkmcnt(0)
    v_mfma_f32_32x32x16_bf16 v[42:57], v[116:119], v[152:155], v[42:57]
    buffer_load_dwordx4 a[64:67], v211, s[8:11], s31 offen offset:1024 sc1
    v_mfma_f32_16x16x32_bf16 a[100:103], a[160:163], v[62:65], 0
    v_mfma_f32_16x16x32_bf16 a[120:123], a[160:163], v[66:69], 0
    v_mfma_f32_16x16x32_bf16 a[140:143], a[160:163], a[0:3], 0
    s_waitcnt vmcnt(8)
    s_mov_b64 exec, 0xf
    buffer_store_dword v6, v7, s[8:11], s65 offen offset:1024 sc1
    s_mov_b64 exec, -1
    v_mfma_f32_16x16x32_bf16 v[124:127], a[160:163], a[4:7], 0
    v_mfma_f32_16x16x32_bf16 a[104:107], a[164:167], v[62:65], 0
    buffer_load_dwordx4 a[68:71], v208, s[8:11], s31 offen offset:1024 sc1
    v_mfma_f32_16x16x32_bf16 a[124:127], a[164:167], v[66:69], 0
    v_mfma_f32_16x16x32_bf16 a[144:147], a[164:167], a[0:3], 0
    buffer_load_dwordx4 a[72:75], v209, s[8:11], s32 offen offset:1024 sc1
    v_mfma_f32_16x16x32_bf16 v[128:131], a[164:167], a[4:7], 0
    v_mfma_f32_16x16x32_bf16 a[108:111], a[168:171], v[62:65], 0
    v_mul_f32 v144, v156, v42
    v_mul_f32 v145, v156, v43
    v_mfma_f32_16x16x32_bf16 a[128:131], a[168:171], v[66:69], 0
    v_mul_f32 v146, v156, v44
    v_mul_f32 v147, v156, v45
    v_mul_f32 v148, v156, v46
    v_mfma_f32_16x16x32_bf16 a[148:151], a[168:171], a[0:3], 0
    buffer_load_dwordx4 a[76:79], v210, s[8:11], s32 offen offset:1024 sc1
    v_mul_f32 v149, v156, v47
    v_mfma_f32_16x16x32_bf16 v[132:135], a[168:171], a[4:7], 0
    v_mul_f32 v150, v156, v48
    v_mul_f32 v151, v156, v49
    v_mfma_f32_16x16x32_bf16 a[112:115], a[172:175], v[62:65], 0
    buffer_load_dwordx4 a[80:83], v211, s[8:11], s32 offen offset:1024 sc1
    v_exp_f32 v144, v144
    v_mfma_f32_16x16x32_bf16 a[132:135], a[172:175], v[66:69], 0
    v_mul_f32 v42, v42, v50
    v_mfma_f32_16x16x32_bf16 a[152:155], a[172:175], a[0:3], 0
    v_exp_f32_e64 v145, v145
    v_mfma_f32_16x16x32_bf16 v[136:139], a[172:175], a[4:7], 0
    v_mul_f32 v43, v43, v51
    v_exp_f32 v146, v146
    v_mfma_f32_16x16x32_bf16 a[116:119], a[176:179], v[62:65], 0
    buffer_load_dwordx4 a[84:87], v208, s[8:11], s32 offen offset:1024 sc1
    v_mul_f32 v44, v44, v52
    v_mfma_f32_16x16x32_bf16 a[136:139], a[176:179], v[66:69], 0
    v_exp_f32 v147, v147
    v_mul_f32_e64 v45, v45, v53
    v_mfma_f32_16x16x32_bf16 a[156:159], a[176:179], a[0:3], 0
    buffer_load_dwordx4 v2, s[8:11], s42 offen offset:1024 sc1 lds
    v_exp_f32 v148, v148
    v_mfma_f32_16x16x32_bf16 v[140:143], a[176:179], a[4:7], 0
    v_mul_f32 v46, v46, v54
    v_mfma_f32_16x16x32_bf16 a[100:103], a[180:183], a[8:11], a[100:103]
    v_exp_f32 v149, v149
    v_mfma_f32_16x16x32_bf16 a[120:123], a[180:183], a[12:15], a[120:123]
    v_mul_f32 v47, v47, v55
    v_exp_f32_e64 v150, v150
    v_mfma_f32_16x16x32_bf16 a[140:143], a[180:183], a[16:19], a[140:143]
    buffer_load_dwordx4 v2, s[8:11], s42 offen offset:2048 sc1 lds
    v_mul_f32 v48, v48, v56
    v_mfma_f32_16x16x32_bf16 v[124:127], a[180:183], a[20:23], v[124:127]
    v_exp_f32 v151, v151
    v_mul_f32_e64 v49, v49, v57
    v_mfma_f32_16x16x32_bf16 a[104:107], a[184:187], a[8:11], a[104:107]
    buffer_load_dwordx4 v2, s[8:11], s42 offen offset:3072 sc1 lds
    v_fma_f32 v144, v144, v157, v157
    v_fma_f32 v145, v145, v157, v157
    v_mfma_f32_16x16x32_bf16 a[124:127], a[184:187], a[12:15], a[124:127]
    v_fma_f32 v146, v146, v157, v157
    v_fma_f32 v147, v147, v157, v157
    v_mfma_f32_16x16x32_bf16 a[144:147], a[184:187], a[16:19], a[144:147]
    v_fma_f32 v148, v148, v157, v157
    v_fma_f32 v149, v149, v157, v157
    v_mfma_f32_16x16x32_bf16 v[128:131], a[184:187], a[20:23], v[128:131]
    v_fma_f32 v150, v150, v157, v157
    v_fma_f32 v151, v151, v157, v157
    v_mfma_f32_16x16x32_bf16 a[108:111], a[188:191], a[8:11], a[108:111]
    s_add_u32 m0, s44, 65536
    s_add_u32 s42, s27, 14336
    buffer_load_dwordx4 v2, s[8:11], s42 offen offset:0 sc1 lds
    v_mfma_f32_16x16x32_bf16 a[128:131], a[188:191], a[12:15], a[128:131]
    v_rcp_f32_e64 v144, v144
    v_mfma_f32_16x16x32_bf16 a[148:151], a[188:191], a[16:19], a[148:151]
    buffer_load_dwordx4 a[88:91], v209, s[8:11], s33 offen offset:1024 sc1
    v_rcp_f32 v145, v145
    v_mfma_f32_16x16x32_bf16 v[132:135], a[188:191], a[20:23], v[132:135]
    v_mul_f32 v42, v42, v144
    v_mfma_f32_16x16x32_bf16 a[112:115], a[192:195], a[8:11], a[112:115]
    v_rcp_f32 v146, v146
    v_mfma_f32_16x16x32_bf16 a[132:135], a[192:195], a[12:15], a[132:135]
    v_mul_f32 v43, v43, v145
    v_rcp_f32_e64 v147, v147
    v_mfma_f32_16x16x32_bf16 a[152:155], a[192:195], a[16:19], a[152:155]
    buffer_load_dwordx4 a[92:95], v210, s[8:11], s33 offen offset:1024 sc1
    v_mul_f32_e64 v44, v44, v146
    v_mfma_f32_16x16x32_bf16 v[136:139], a[192:195], a[20:23], v[136:139]
    v_rcp_f32_e64 v148, v148
    v_mul_f32_e64 v45, v45, v147
    v_mfma_f32_16x16x32_bf16 a[116:119], a[196:199], a[8:11], a[116:119]
    buffer_load_dwordx4 a[96:99], v211, s[8:11], s33 offen offset:1024 sc1
    v_rcp_f32_e64 v149, v149
    v_mfma_f32_16x16x32_bf16 a[136:139], a[196:199], a[12:15], a[136:139]
    v_mul_f32_e64 v46, v46, v148
    v_mfma_f32_16x16x32_bf16 a[156:159], a[196:199], a[16:19], a[156:159]
    v_rcp_f32_e64 v150, v150
    v_mfma_f32_16x16x32_bf16 v[140:143], a[196:199], a[20:23], v[140:143]
    v_mul_f32_e64 v47, v47, v149
    v_rcp_f32_e64 v151, v151
    v_mfma_f32_16x16x32_bf16 a[100:103], a[200:203], a[24:27], a[100:103]
    buffer_load_dwordx4 v[70:73], v208, s[8:11], s33 offen offset:1024 sc1
    v_mul_f32_e64 v48, v48, v150
    v_cvt_pk_bf16_f32 v50, v42, v43
    v_mfma_f32_16x16x32_bf16 a[120:123], a[200:203], a[28:31], a[120:123]
    v_mul_f32 v49, v49, v151
    v_cvt_pk_bf16_f32 v51, v44, v45
    v_mfma_f32_16x16x32_bf16 a[140:143], a[200:203], a[32:35], a[140:143]
    s_add_u32 m0, s44, 81920
    s_add_u32 s42, s28, 10240
    buffer_load_dwordx4 v2, s[8:11], s42 offen offset:0 sc1 lds
    v_cvt_pk_bf16_f32 v52, v46, v47
    s_waitcnt vmcnt(22)
    v_mfma_f32_16x16x32_bf16 v[124:127], a[200:203], a[36:39], v[124:127]
    v_cvt_pk_bf16_f32 v53, v48, v49
    v_mfma_f32_16x16x32_bf16 a[104:107], a[204:207], a[24:27], a[104:107]
    buffer_store_dwordx4 v[50:53], v244, s[8:11], s64 offen offset:0 sc1
    v_mfma_f32_16x16x32_bf16 a[124:127], a[204:207], a[28:31], a[124:127]
    v_mfma_f32_16x16x32_bf16 a[144:147], a[204:207], a[32:35], a[144:147]
    buffer_load_dwordx4 v2, s[8:11], s42 offen offset:1024 sc1 lds
    v_mfma_f32_16x16x32_bf16 v[128:131], a[204:207], a[36:39], v[128:131]
    v_mfma_f32_16x16x32_bf16 a[108:111], a[208:211], a[24:27], a[108:111]
    buffer_load_dwordx4 v2, s[8:11], s42 offen offset:2048 sc1 lds
    v_mfma_f32_16x16x32_bf16 a[128:131], a[208:211], a[28:31], a[128:131]
    v_mfma_f32_16x16x32_bf16 a[148:151], a[208:211], a[32:35], a[148:151]
    v_mfma_f32_16x16x32_bf16 v[132:135], a[208:211], a[36:39], v[132:135]
    v_mfma_f32_16x16x32_bf16 a[112:115], a[212:215], a[24:27], a[112:115]
    buffer_load_dwordx4 v2, s[8:11], s42 offen offset:3072 sc1 lds
    v_mfma_f32_16x16x32_bf16 a[132:135], a[212:215], a[28:31], a[132:135]
    v_mfma_f32_16x16x32_bf16 a[152:155], a[212:215], a[32:35], a[152:155]
    s_add_u32 m0, s44, 86016
    s_add_u32 s42, s28, 14336
    buffer_load_dwordx4 v2, s[8:11], s42 offen offset:0 sc1 lds
    v_mfma_f32_16x16x32_bf16 v[136:139], a[212:215], a[36:39], v[136:139]
    v_mfma_f32_16x16x32_bf16 a[116:119], a[216:219], a[24:27], a[116:119]
    v_mfma_f32_16x16x32_bf16 a[136:139], a[216:219], a[28:31], a[136:139]
    v_mfma_f32_16x16x32_bf16 a[156:159], a[216:219], a[32:35], a[156:159]
    buffer_load_dwordx4 v[10:13], v209, s[8:11], s36 offen offset:1024 sc1
    v_mfma_f32_16x16x32_bf16 v[140:143], a[216:219], a[36:39], v[140:143]
    s_waitcnt vmcnt(27)
    v_mfma_f32_16x16x32_bf16 a[100:103], a[220:223], a[40:43], a[100:103]
    buffer_load_dwordx4 v[14:17], v210, s[8:11], s36 offen offset:1024 sc1
    s_waitcnt vmcnt(27)
    v_mfma_f32_16x16x32_bf16 a[120:123], a[220:223], a[44:47], a[120:123]
    s_waitcnt vmcnt(26)
    v_mfma_f32_16x16x32_bf16 a[140:143], a[220:223], a[48:51], a[140:143]
    s_waitcnt vmcnt(25)
    v_mfma_f32_16x16x32_bf16 v[124:127], a[220:223], a[52:55], v[124:127]
    v_mfma_f32_16x16x32_bf16 a[104:107], a[224:227], a[40:43], a[104:107]
    buffer_load_dwordx4 v[18:21], v211, s[8:11], s36 offen offset:1024 sc1
    v_mfma_f32_16x16x32_bf16 a[124:127], a[224:227], a[44:47], a[124:127]
    v_mfma_f32_16x16x32_bf16 a[144:147], a[224:227], a[48:51], a[144:147]
    buffer_load_dwordx4 v[22:25], v208, s[8:11], s36 offen offset:1024 sc1
    v_mfma_f32_16x16x32_bf16 v[128:131], a[224:227], a[52:55], v[128:131]
    v_mfma_f32_16x16x32_bf16 a[108:111], a[228:231], a[40:43], a[108:111]
    v_mfma_f32_16x16x32_bf16 a[128:131], a[228:231], a[44:47], a[128:131]
    v_mfma_f32_16x16x32_bf16 a[148:151], a[228:231], a[48:51], a[148:151]
    v_mfma_f32_16x16x32_bf16 v[132:135], a[228:231], a[52:55], v[132:135]
    v_mfma_f32_16x16x32_bf16 a[112:115], a[232:235], a[40:43], a[112:115]
    v_mfma_f32_16x16x32_bf16 a[132:135], a[232:235], a[44:47], a[132:135]
    v_mfma_f32_16x16x32_bf16 a[152:155], a[232:235], a[48:51], a[152:155]
    v_mfma_f32_16x16x32_bf16 v[136:139], a[232:235], a[52:55], v[136:139]
    v_mfma_f32_16x16x32_bf16 a[116:119], a[236:239], a[40:43], a[116:119]
    v_mfma_f32_16x16x32_bf16 a[136:139], a[236:239], a[44:47], a[136:139]
    v_mfma_f32_16x16x32_bf16 a[156:159], a[236:239], a[48:51], a[156:159]
    v_mfma_f32_16x16x32_bf16 v[140:143], a[236:239], a[52:55], v[140:143]
    s_waitcnt vmcnt(26)
    v_mfma_f32_16x16x32_bf16 a[100:103], a[240:243], a[56:59], a[100:103]
    s_mov_b32 exec_hi, 0x0
    buffer_load_dword v8, v245, s[8:11], s66 offen offset:1024 sc1
    s_mov_b64 exec, -1
    s_waitcnt vmcnt(26)
    s_nop 0
    v_mfma_f32_16x16x32_bf16 a[120:123], a[240:243], a[60:63], a[120:123]
    s_waitcnt vmcnt(25)
    v_mfma_f32_16x16x32_bf16 a[140:143], a[240:243], a[64:67], a[140:143]
    s_waitcnt vmcnt(23)
    v_mfma_f32_16x16x32_bf16 v[124:127], a[240:243], a[68:71], v[124:127]
    v_mfma_f32_16x16x32_bf16 a[104:107], a[244:247], a[56:59], a[104:107]
    s_waitcnt vmcnt(9)
    s_mov_b64 exec, 0xf
    buffer_store_dword v6, v7, s[8:11], s65 offen offset:1536 sc1
    s_mov_b64 exec, -1
    v_mfma_f32_16x16x32_bf16 a[124:127], a[244:247], a[60:63], a[124:127]
    v_mfma_f32_16x16x32_bf16 a[144:147], a[244:247], a[64:67], a[144:147]
    v_mfma_f32_16x16x32_bf16 v[128:131], a[244:247], a[68:71], v[128:131]
    v_mfma_f32_16x16x32_bf16 a[108:111], a[248:251], a[56:59], a[108:111]
    v_mfma_f32_16x16x32_bf16 a[128:131], a[248:251], a[60:63], a[128:131]
    v_mfma_f32_16x16x32_bf16 a[148:151], a[248:251], a[64:67], a[148:151]
    v_mfma_f32_16x16x32_bf16 v[132:135], a[248:251], a[68:71], v[132:135]
    v_mfma_f32_16x16x32_bf16 a[112:115], a[252:255], a[56:59], a[112:115]
    v_mfma_f32_16x16x32_bf16 a[132:135], a[252:255], a[60:63], a[132:135]
    v_mfma_f32_16x16x32_bf16 a[152:155], a[252:255], a[64:67], a[152:155]
    v_mfma_f32_16x16x32_bf16 v[136:139], a[252:255], a[68:71], v[136:139]
    v_mfma_f32_16x16x32_bf16 a[116:119], v[158:161], a[56:59], a[116:119]
    v_mfma_f32_16x16x32_bf16 a[136:139], v[158:161], a[60:63], a[136:139]
    v_mfma_f32_16x16x32_bf16 a[156:159], v[158:161], a[64:67], a[156:159]
    v_mfma_f32_16x16x32_bf16 v[140:143], v[158:161], a[68:71], v[140:143]
    v_mfma_f32_16x16x32_bf16 a[100:103], v[162:165], a[72:75], a[100:103]
    v_mfma_f32_16x16x32_bf16 a[120:123], v[162:165], a[76:79], a[120:123]
    v_mfma_f32_16x16x32_bf16 a[140:143], v[162:165], a[80:83], a[140:143]
    v_mfma_f32_16x16x32_bf16 v[124:127], v[162:165], a[84:87], v[124:127]
    v_mfma_f32_16x16x32_bf16 a[104:107], v[166:169], a[72:75], a[104:107]
    v_mfma_f32_16x16x32_bf16 a[124:127], v[166:169], a[76:79], a[124:127]
    v_mfma_f32_16x16x32_bf16 a[144:147], v[166:169], a[80:83], a[144:147]
    v_mfma_f32_16x16x32_bf16 v[128:131], v[166:169], a[84:87], v[128:131]
    v_mfma_f32_16x16x32_bf16 a[108:111], v[170:173], a[72:75], a[108:111]
    v_mfma_f32_16x16x32_bf16 a[128:131], v[170:173], a[76:79], a[128:131]
    v_mfma_f32_16x16x32_bf16 a[148:151], v[170:173], a[80:83], a[148:151]
    v_mfma_f32_16x16x32_bf16 v[132:135], v[170:173], a[84:87], v[132:135]
    v_mfma_f32_16x16x32_bf16 a[112:115], v[174:177], a[72:75], a[112:115]
    v_mfma_f32_16x16x32_bf16 a[132:135], v[174:177], a[76:79], a[132:135]
    v_mfma_f32_16x16x32_bf16 a[152:155], v[174:177], a[80:83], a[152:155]
    v_mfma_f32_16x16x32_bf16 v[136:139], v[174:177], a[84:87], v[136:139]
    v_mfma_f32_16x16x32_bf16 a[116:119], v[188:191], a[72:75], a[116:119]
    s_waitcnt vmcnt(1)
    v_cmp_ne_u32_e64 vcc, s45, v8
    s_nop 0
    s_and_b32 vcc_lo, vcc_lo, 0xffffffff
    s_cbranch_scc1 Ls_a2
Lr_a2:
    v_mfma_f32_16x16x32_bf16 a[136:139], v[188:191], a[76:79], a[136:139]
    v_mfma_f32_16x16x32_bf16 a[156:159], v[188:191], a[80:83], a[156:159]
    buffer_load_dwordx4 v[158:161], v209, s[8:11], s31 offen offset:2048 sc1
    v_mfma_f32_16x16x32_bf16 v[140:143], v[188:191], a[84:87], v[140:143]
    v_mfma_f32_16x16x32_bf16 a[100:103], v[192:195], a[88:91], a[100:103]
    buffer_load_dwordx4 v[162:165], v210, s[8:11], s31 offen offset:2048 sc1
    v_mfma_f32_16x16x32_bf16 a[120:123], v[192:195], a[92:95], a[120:123]
    v_mfma_f32_16x16x32_bf16 a[140:143], v[192:195], a[96:99], a[140:143]
    buffer_load_dwordx4 v[166:169], v211, s[8:11], s31 offen offset:2048 sc1
    v_mfma_f32_16x16x32_bf16 v[124:127], v[192:195], v[70:73], v[124:127]
    v_mfma_f32_16x16x32_bf16 a[104:107], v[196:199], a[88:91], a[104:107]
    ds_read_b128 v[26:29], v246 offset:0
    buffer_load_dwordx4 v[170:173], v208, s[8:11], s31 offen offset:2048 sc1
    v_mfma_f32_16x16x32_bf16 a[124:127], v[196:199], a[92:95], a[124:127]
    v_mfma_f32_16x16x32_bf16 a[144:147], v[196:199], a[96:99], a[144:147]
    buffer_load_dwordx4 v[174:177], v209, s[8:11], s32 offen offset:2048 sc1
    v_mfma_f32_16x16x32_bf16 v[128:131], v[196:199], v[70:73], v[128:131]
    v_mfma_f32_16x16x32_bf16 a[108:111], v[200:203], a[88:91], a[108:111]
    ds_read_b128 v[30:33], v246 offset:1024
    buffer_load_dwordx4 v[188:191], v210, s[8:11], s32 offen offset:2048 sc1
    v_mfma_f32_16x16x32_bf16 a[128:131], v[200:203], a[92:95], a[128:131]
    v_mfma_f32_16x16x32_bf16 a[148:151], v[200:203], a[96:99], a[148:151]
    buffer_load_dwordx4 v[192:195], v211, s[8:11], s32 offen offset:2048 sc1
    v_mfma_f32_16x16x32_bf16 v[132:135], v[200:203], v[70:73], v[132:135]
    v_mfma_f32_16x16x32_bf16 a[112:115], v[204:207], a[88:91], a[112:115]
    ds_read_b128 v[34:37], v246 offset:2048
    buffer_load_dwordx4 v[196:199], v208, s[8:11], s32 offen offset:2048 sc1
    v_mfma_f32_16x16x32_bf16 a[132:135], v[204:207], a[92:95], a[132:135]
    v_mfma_f32_16x16x32_bf16 a[152:155], v[204:207], a[96:99], a[152:155]
    v_mfma_f32_16x16x32_bf16 v[136:139], v[204:207], v[70:73], v[136:139]
    v_mfma_f32_16x16x32_bf16 a[116:119], v[58:61], a[88:91], a[116:119]
    ds_read_b128 v[38:41], v246 offset:3072
    v_mfma_f32_16x16x32_bf16 a[136:139], v[58:61], a[92:95], a[136:139]
    v_mfma_f32_16x16x32_bf16 a[156:159], v[58:61], a[96:99], a[156:159]
    v_mfma_f32_16x16x32_bf16 v[140:143], v[58:61], v[70:73], v[140:143]
    s_waitcnt lgkmcnt(3)
    v_mfma_f32_16x16x32_bf16 a[100:103], v[26:29], v[10:13], a[100:103]
    ds_read_b128 a[160:163], v246 offset:4096
    v_mfma_f32_16x16x32_bf16 a[120:123], v[26:29], v[14:17], a[120:123]
    v_mfma_f32_16x16x32_bf16 a[140:143], v[26:29], v[18:21], a[140:143]
    buffer_load_dwordx4 v[200:203], v209, s[8:11], s33 offen offset:2048 sc1
    v_mfma_f32_16x16x32_bf16 v[124:127], v[26:29], v[22:25], v[124:127]
    s_waitcnt lgkmcnt(3)
    v_mfma_f32_16x16x32_bf16 a[104:107], v[30:33], v[10:13], a[104:107]
    ds_read_b128 a[164:167], v246 offset:20480
    buffer_load_dwordx4 v[204:207], v210, s[8:11], s33 offen offset:2048 sc1
    v_mfma_f32_16x16x32_bf16 a[124:127], v[30:33], v[14:17], a[124:127]
    v_mfma_f32_16x16x32_bf16 a[144:147], v[30:33], v[18:21], a[144:147]
    buffer_load_dwordx4 a[168:171], v211, s[8:11], s33 offen offset:2048 sc1
    v_mfma_f32_16x16x32_bf16 v[128:131], v[30:33], v[22:25], v[128:131]
    s_waitcnt lgkmcnt(3)
    v_mfma_f32_16x16x32_bf16 a[108:111], v[34:37], v[10:13], a[108:111]
    ds_read_b128 a[172:175], v246 offset:21504
    buffer_load_dwordx4 v[62:65], v208, s[8:11], s33 offen offset:2048 sc1
    v_mfma_f32_16x16x32_bf16 a[128:131], v[34:37], v[14:17], a[128:131]
    v_mfma_f32_16x16x32_bf16 a[148:151], v[34:37], v[18:21], a[148:151]
    v_mfma_f32_16x16x32_bf16 v[132:135], v[34:37], v[22:25], v[132:135]
    s_waitcnt lgkmcnt(3)
    v_mfma_f32_16x16x32_bf16 a[112:115], v[38:41], v[10:13], a[112:115]
    ds_read_b128 v[66:69], v246 offset:22528
    v_mfma_f32_16x16x32_bf16 a[132:135], v[38:41], v[14:17], a[132:135]
    v_mfma_f32_16x16x32_bf16 a[152:155], v[38:41], v[18:21], a[152:155]
    buffer_load_dwordx4 a[0:3], v209, s[8:11], s36 offen offset:2048 sc1
    v_mfma_f32_16x16x32_bf16 v[136:139], v[38:41], v[22:25], v[136:139]
    s_waitcnt lgkmcnt(3)
    v_mfma_f32_16x16x32_bf16 a[116:119], a[160:163], v[10:13], a[116:119]
    ds_read_b128 a[176:179], v246 offset:23552
    buffer_load_dwordx4 a[4:7], v210, s[8:11], s36 offen offset:2048 sc1
    v_mfma_f32_16x16x32_bf16 a[136:139], a[160:163], v[14:17], a[136:139]
    v_mfma_f32_16x16x32_bf16 a[156:159], a[160:163], v[18:21], a[156:159]
    v_mfma_f32_16x16x32_bf16 v[140:143], a[160:163], v[22:25], v[140:143]
    s_waitcnt vmcnt(13) lgkmcnt(3)
    v_mfma_f32_16x16x32_bf16 a[100:103], a[164:167], v[158:161], a[100:103]
    ds_read_b128 a[180:183], v246 offset:24576
    buffer_load_dwordx4 v[92:95], v211, s[8:11], s36 offen offset:2048 sc1
    s_waitcnt vmcnt(13)
    v_mfma_f32_16x16x32_bf16 a[120:123], a[164:167], v[162:165], a[120:123]
    s_waitcnt vmcnt(12)
    v_mfma_f32_16x16x32_bf16 a[140:143], a[164:167], v[166:169], a[140:143]
    s_mov_b32 exec_hi, 0x0
    buffer_load_dword v8, v245, s[8:11], s66 offen offset:1536 sc1
    s_mov_b64 exec, -1
    s_waitcnt vmcnt(12)
    v_mfma_f32_16x16x32_bf16 v[124:127], a[164:167], v[170:173], v[124:127]
    s_waitcnt lgkmcnt(3)
    v_mfma_f32_16x16x32_bf16 a[104:107], a[172:175], v[158:161], a[104:107]
    ds_read_b128 v[96:99], v246 offset:40960
    buffer_load_dwordx4 v[100:103], v208, s[8:11], s36 offen offset:2048 sc1
    v_mfma_f32_16x16x32_bf16 a[124:127], a[172:175], v[162:165], a[124:127]
    v_mfma_f32_16x16x32_bf16 a[144:147], a[172:175], v[166:169], a[144:147]
    v_mfma_f32_16x16x32_bf16 v[128:131], a[172:175], v[170:173], v[128:131]
    s_waitcnt lgkmcnt(3)
    v_mfma_f32_16x16x32_bf16 a[108:111], v[66:69], v[158:161], a[108:111]
    ds_read_b128 v[104:107], v246 offset:41984
    v_mfma_f32_16x16x32_bf16 a[128:131], v[66:69], v[162:165], a[128:131]
    v_mfma_f32_16x16x32_bf16 a[148:151], v[66:69], v[166:169], a[148:151]
    v_mfma_f32_16x16x32_bf16 v[132:135], v[66:69], v[170:173], v[132:135]
    s_waitcnt lgkmcnt(3)
    v_mfma_f32_16x16x32_bf16 a[112:115], a[176:179], v[158:161], a[112:115]
    ds_read_b128 v[108:111], v246 offset:43008
    v_mfma_f32_16x16x32_bf16 a[132:135], a[176:179], v[162:165], a[132:135]
    v_mfma_f32_16x16x32_bf16 a[152:155], a[176:179], v[166:169], a[152:155]
    v_mfma_f32_16x16x32_bf16 v[136:139], a[176:179], v[170:173], v[136:139]
    s_waitcnt lgkmcnt(3)
    v_mfma_f32_16x16x32_bf16 a[116:119], a[180:183], v[158:161], a[116:119]
    ds_read_b128 v[112:115], v246 offset:44032
    v_mfma_f32_16x16x32_bf16 a[136:139], a[180:183], v[162:165], a[136:139]
    v_mfma_f32_16x16x32_bf16 a[156:159], a[180:183], v[166:169], a[156:159]
    v_mfma_f32_16x16x32_bf16 v[140:143], a[180:183], v[170:173], v[140:143]
    s_waitcnt vmcnt(12) lgkmcnt(3)
    v_mfma_f32_16x16x32_bf16 a[100:103], v[96:99], v[174:177], a[100:103]
    ds_read_b128 v[116:119], v246 offset:45056
    s_waitcnt vmcnt(11)
    v_mfma_f32_16x16x32_bf16 a[120:123], v[96:99], v[188:191], a[120:123]
    s_waitcnt vmcnt(10)
    v_mfma_f32_16x16x32_bf16 a[140:143], v[96:99], v[192:195], a[140:143]
    s_waitcnt vmcnt(9)
    v_mfma_f32_16x16x32_bf16 v[124:127], v[96:99], v[196:199], v[124:127]
    s_waitcnt lgkmcnt(3)
    v_mfma_f32_16x16x32_bf16 a[104:107], v[104:107], v[174:177], a[104:107]
    ds_read_b128 v[120:123], v247 offset:0
    v_mfma_f32_16x16x32_bf16 a[124:127], v[104:107], v[188:191], a[124:127]
    v_mfma_f32_16x16x32_bf16 a[144:147], v[104:107], v[192:195], a[144:147]
    v_mfma_f32_16x16x32_bf16 v[128:131], v[104:107], v[196:199], v[128:131]
    s_waitcnt lgkmcnt(3)
    v_mfma_f32_16x16x32_bf16 a[108:111], v[108:111], v[174:177], a[108:111]
    ds_read_b128 a[184:187], v247 offset:1024
    v_mfma_f32_16x16x32_bf16 a[128:131], v[108:111], v[188:191], a[128:131]
    v_mfma_f32_16x16x32_bf16 a[148:151], v[108:111], v[192:195], a[148:151]
    v_mfma_f32_16x16x32_bf16 v[132:135], v[108:111], v[196:199], v[132:135]
    s_waitcnt lgkmcnt(3)
    v_mfma_f32_16x16x32_bf16 a[112:115], v[112:115], v[174:177], a[112:115]
    ds_read_b128 a[188:191], v247 offset:2048
    v_mfma_f32_16x16x32_bf16 a[132:135], v[112:115], v[188:191], a[132:135]
    v_mfma_f32_16x16x32_bf16 a[152:155], v[112:115], v[192:195], a[152:155]
    v_mfma_f32_16x16x32_bf16 v[136:139], v[112:115], v[196:199], v[136:139]
    s_waitcnt lgkmcnt(3)
    v_mfma_f32_16x16x32_bf16 a[116:119], v[116:119], v[174:177], a[116:119]
    ds_read_b128 a[192:195], v247 offset:3072
    v_mfma_f32_16x16x32_bf16 a[136:139], v[116:119], v[188:191], a[136:139]
    v_mfma_f32_16x16x32_bf16 a[156:159], v[116:119], v[192:195], a[156:159]
    s_waitcnt vmcnt(1)
    v_cmp_ne_u32_e64 vcc, s45, v8
    s_nop 0
    s_and_b32 vcc_lo, vcc_lo, 0xffffffff
    s_cbranch_scc1 Ls_a3
Lr_a3:
    v_mfma_f32_16x16x32_bf16 v[140:143], v[116:119], v[196:199], v[140:143]
    s_waitcnt lgkmcnt(3)
    v_mfma_f32_16x16x32_bf16 a[100:103], v[120:123], v[200:203], a[100:103]
    ds_read_b128 a[8:11], v247 offset:4096
    buffer_load_dwordx4 a[12:15], v210, s[8:11], s37 offen offset:0 sc1
    v_mfma_f32_16x16x32_bf16 a[120:123], v[120:123], v[204:207], a[120:123]
    v_mfma_f32_16x16x32_bf16 a[140:143], v[120:123], a[168:171], a[140:143]
    buffer_load_dwordx4 a[16:19], v211, s[8:11], s37 offen offset:0 sc1
    v_mfma_f32_16x16x32_bf16 v[124:127], v[120:123], v[62:65], v[124:127]
    s_waitcnt lgkmcnt(3)
    v_mfma_f32_16x16x32_bf16 a[104:107], a[184:187], v[200:203], a[104:107]
    ds_read_b128 a[196:199], v247 offset:20480
    buffer_load_dwordx4 a[20:23], v209, s[8:11], s37 offen offset:0 sc1
    v_mfma_f32_16x16x32_bf16 a[124:127], a[184:187], v[204:207], a[124:127]
    v_mfma_f32_16x16x32_bf16 a[144:147], a[184:187], a[168:171], a[144:147]
    buffer_load_dwordx4 v[42:45], v208, s[8:11], s37 offen offset:0 sc1
    v_mfma_f32_16x16x32_bf16 v[128:131], a[184:187], v[62:65], v[128:131]
    s_waitcnt lgkmcnt(3)
    v_mfma_f32_16x16x32_bf16 a[108:111], a[188:191], v[200:203], a[108:111]
    ds_read_b128 v[46:49], v247 offset:21504
    buffer_load_dwordx4 v[50:53], v209, s[8:11], s55 offen offset:0 sc1
    v_mfma_f32_16x16x32_bf16 a[128:131], a[188:191], v[204:207], a[128:131]
    v_mfma_f32_16x16x32_bf16 a[148:151], a[188:191], a[168:171], a[148:151]
    buffer_load_dwordx4 v[54:57], v208, s[8:11], s55 offen offset:0 sc1
    v_mfma_f32_16x16x32_bf16 v[132:135], a[188:191], v[62:65], v[132:135]
    s_waitcnt lgkmcnt(3)
    v_mfma_f32_16x16x32_bf16 a[112:115], a[192:195], v[200:203], a[112:115]
    ds_read_b128 a[200:203], v247 offset:22528
    v_mfma_f32_16x16x32_bf16 a[132:135], a[192:195], v[204:207], a[132:135]
    v_mfma_f32_16x16x32_bf16 a[152:155], a[192:195], a[168:171], a[152:155]
    v_mfma_f32_16x16x32_bf16 v[136:139], a[192:195], v[62:65], v[136:139]
    s_waitcnt lgkmcnt(3)
    v_mfma_f32_16x16x32_bf16 a[116:119], a[8:11], v[200:203], a[116:119]
    ds_read_b128 a[204:207], v247 offset:23552
    v_mfma_f32_16x16x32_bf16 a[136:139], a[8:11], v[204:207], a[136:139]
    v_mfma_f32_16x16x32_bf16 a[156:159], a[8:11], a[168:171], a[156:159]
    v_mfma_f32_16x16x32_bf16 v[140:143], a[8:11], v[62:65], v[140:143]
    s_waitcnt lgkmcnt(3)
    v_mfma_f32_16x16x32_bf16 a[100:103], a[196:199], a[0:3], a[100:103]
    ds_read_b128 a[208:211], v247 offset:24576
    v_mfma_f32_16x16x32_bf16 a[120:123], a[196:199], a[4:7], a[120:123]
    v_mfma_f32_16x16x32_bf16 a[140:143], a[196:199], v[92:95], a[140:143]
    s_waitcnt vmcnt(6)
    v_mfma_f32_16x16x32_bf16 v[124:127], a[196:199], v[100:103], v[124:127]
    s_waitcnt lgkmcnt(3)
    v_mfma_f32_16x16x32_bf16 a[104:107], v[46:49], a[0:3], a[104:107]
    v_mfma_f32_16x16x32_bf16 a[124:127], v[46:49], a[4:7], a[124:127]
    v_mfma_f32_16x16x32_bf16 a[144:147], v[46:49], v[92:95], a[144:147]
    v_mfma_f32_16x16x32_bf16 v[128:131], v[46:49], v[100:103], v[128:131]
    s_waitcnt lgkmcnt(2)
    v_mfma_f32_16x16x32_bf16 a[108:111], a[200:203], a[0:3], a[108:111]
    v_mfma_f32_16x16x32_bf16 a[128:131], a[200:203], a[4:7], a[128:131]
    v_mfma_f32_16x16x32_bf16 a[148:151], a[200:203], v[92:95], a[148:151]
    v_lshlrev_b32 v188, 16, v178
    v_lshlrev_b32 v190, 16, v179
    v_mfma_f32_16x16x32_bf16 v[132:135], a[200:203], v[100:103], v[132:135]
    v_lshlrev_b32 v192, 16, v180
    v_lshlrev_b32 v194, 16, v181
    v_lshlrev_b32 v196, 16, v182
    s_waitcnt lgkmcnt(1)
    v_mfma_f32_16x16x32_bf16 a[112:115], a[204:207], a[0:3], a[112:115]
    v_lshlrev_b32_e64 v198, 16, v183
    v_lshlrev_b32_e64 v200, 16, v184
    v_mfma_f32_16x16x32_bf16 a[132:135], a[204:207], a[4:7], a[132:135]
    v_lshlrev_b32_e64 v202, 16, v185
    v_lshlrev_b32_e64 v204, 16, v186
    v_lshlrev_b32 v206, 16, v187
    v_mfma_f32_16x16x32_bf16 a[152:155], a[204:207], v[92:95], a[152:155]
    v_and_b32 v189, 0xffff0000, v178
    v_and_b32 v191, 0xffff0000, v179
    v_mfma_f32_16x16x32_bf16 v[136:139], a[204:207], v[100:103], v[136:139]
    v_and_b32 v193, 0xffff0000, v180
    v_and_b32 v195, 0xffff0000, v181
    v_and_b32 v197, 0xffff0000, v182
    s_waitcnt lgkmcnt(0)
    v_mfma_f32_16x16x32_bf16 a[116:119], a[208:211], a[0:3], a[116:119]
    v_and_b32 v199, 0xffff0000, v183
    v_and_b32 v201, 0xffff0000, v184
    v_mfma_f32_16x16x32_bf16 a[136:139], a[208:211], a[4:7], a[136:139]
    v_and_b32 v203, 0xffff0000, v185
    v_and_b32 v205, 0xffff0000, v186
    v_and_b32 v207, 0xffff0000, v187
    v_mfma_f32_16x16x32_bf16 a[156:159], a[208:211], v[92:95], a[156:159]
    ds_read_b128 v[158:161], v216 offset:640
    ds_read_b128 v[162:165], v216 offset:656
    v_mfma_f32_16x16x32_bf16 v[140:143], a[208:211], v[100:103], v[140:143]
    ds_read_b128 v[166:169], v216 offset:768
    ds_read_b128 v[170:173], v216 offset:784
    ds_read_b128 v[174:177], v217 offset:896
    s_barrier
    s_waitcnt vmcnt(5)
    v_mfma_f32_16x16x32_bf16 a[120:123], v[74:77], a[12:15], a[120:123]
    v_mfma_f32_16x16x32_bf16 a[124:127], v[78:81], a[12:15], a[124:127]
    v_mfma_f32_16x16x32_bf16 a[128:131], v[82:85], a[12:15], a[128:131]
    v_mfma_f32_16x16x32_bf16 a[132:135], v[86:89], a[12:15], a[132:135]
    v_mfma_f32_16x16x32_bf16 a[136:139], v[222:225], a[12:15], a[136:139]
    s_waitcnt vmcnt(4)
    v_mfma_f32_16x16x32_bf16 a[140:143], v[74:77], a[16:19], a[140:143]
    v_mfma_f32_16x16x32_bf16 a[144:147], v[78:81], a[16:19], a[144:147]
    v_mfma_f32_16x16x32_bf16 a[148:151], v[82:85], a[16:19], a[148:151]
    v_mfma_f32_16x16x32_bf16 a[152:155], v[86:89], a[16:19], a[152:155]
    ds_write_b128 v221, a[120:123] offset:0
    v_mfma_f32_16x16x32_bf16 a[156:159], v[222:225], a[16:19], a[156:159]
    s_waitcnt vmcnt(3)
    v_mfma_f32_16x16x32_bf16 a[100:103], v[74:77], a[20:23], a[100:103]
    ds_write_b128 v221, a[124:127] offset:1024
    v_mfma_f32_16x16x32_bf16 a[104:107], v[78:81], a[20:23], a[104:107]
    v_mfma_f32_16x16x32_bf16 a[108:111], v[82:85], a[20:23], a[108:111]
    ds_write_b128 v221, a[128:131] offset:2048
    v_mfma_f32_16x16x32_bf16 a[112:115], v[86:89], a[20:23], a[112:115]
    v_mfma_f32_16x16x32_bf16 a[116:119], v[222:225], a[20:23], a[116:119]
    ds_write_b128 v221, a[132:135] offset:3072
    s_waitcnt vmcnt(1)
    v_mfma_f32_16x16x32_bf16 a[100:103], v[226:229], v[50:53], a[100:103]
    v_mfma_f32_16x16x32_bf16 a[104:107], v[230:233], v[50:53], a[104:107]
    ds_write_b128 v221, a[136:139] offset:4096
    v_mfma_f32_16x16x32_bf16 a[108:111], v[234:237], v[50:53], a[108:111]
    v_mfma_f32_16x16x32_bf16 a[112:115], v[248:251], v[50:53], a[112:115]
    ds_write_b128 v238, a[140:143] offset:0
    v_mfma_f32_16x16x32_bf16 a[116:119], v[252:255], v[50:53], a[116:119]
    v_mfma_f32_16x16x32_bf16 v[124:127], v[74:77], v[42:45], v[124:127]
    ds_write_b128 v238, a[144:147] offset:1024
    v_mfma_f32_16x16x32_bf16 v[128:131], v[78:81], v[42:45], v[128:131]
    v_mfma_f32_16x16x32_bf16 v[132:135], v[82:85], v[42:45], v[132:135]
    ds_write_b128 v238, a[148:151] offset:2048
    v_mfma_f32_16x16x32_bf16 v[136:139], v[86:89], v[42:45], v[136:139]
    v_mfma_f32_16x16x32_bf16 v[140:143], v[222:225], v[42:45], v[140:143]
    ds_write_b128 v238, a[152:155] offset:3072
    s_waitcnt vmcnt(0)
    v_mfma_f32_16x16x32_bf16 v[124:127], v[226:229], v[54:57], v[124:127]
    v_mfma_f32_16x16x32_bf16 v[128:131], v[230:233], v[54:57], v[128:131]
    ds_write_b128 v238, a[156:159] offset:4096
    v_mfma_f32_16x16x32_bf16 v[132:135], v[234:237], v[54:57], v[132:135]
    v_mfma_f32_16x16x32_bf16 v[136:139], v[248:251], v[54:57], v[136:139]
    ds_write_b128 v220, a[100:103] offset:0
    v_mfma_f32_16x16x32_bf16 v[140:143], v[252:255], v[54:57], v[140:143]
    ds_write_b128 v220, a[104:107] offset:1024
    ds_write_b128 v220, a[108:111] offset:2048
    ds_write_b128 v220, a[112:115] offset:3072
    ds_write_b128 v220, a[116:119] offset:4096
    s_waitcnt lgkmcnt(0)
    s_barrier
    ds_read_b128 v[10:13], v218 offset:0
    ds_read_b128 v[30:33], v218 offset:5120
    ds_read_b128 v[50:53], v218 offset:10240
    ds_read_b128 v[14:17], v218 offset:1024
    ds_read_b128 v[34:37], v218 offset:6144
    ds_read_b128 v[54:57], v218 offset:11264
    ds_read_b128 v[18:21], v218 offset:2048
    ds_read_b128 v[38:41], v218 offset:7168
    ds_read_b128 v[58:61], v218 offset:12288
    ds_read_b128 v[22:25], v218 offset:3072
    ds_read_b128 v[42:45], v218 offset:8192
    ds_read_b128 v[62:65], v218 offset:13312
    ds_read_b128 v[26:29], v218 offset:4096
    ds_read_b128 v[46:49], v218 offset:9216
    ds_read_b128 v[66:69], v218 offset:14336
    s_waitcnt lgkmcnt(14)
    v_pk_add_f32 v[124:125], v[124:125], v[10:11]
    s_waitcnt lgkmcnt(12)
    v_pk_add_f32 v[30:31], v[30:31], v[50:51]
    v_pk_add_f32 v[126:127], v[126:127], v[12:13]
    v_pk_add_f32 v[32:33], v[32:33], v[52:53]
    s_waitcnt lgkmcnt(11)
    v_pk_add_f32 v[128:129], v[128:129], v[14:15]
    s_waitcnt lgkmcnt(9)
    v_pk_add_f32 v[34:35], v[34:35], v[54:55]
    v_pk_add_f32 v[130:131], v[130:131], v[16:17]
    v_pk_add_f32 v[36:37], v[36:37], v[56:57]
    v_pk_add_f32 v[124:125], v[124:125], v[30:31]
    v_pk_add_f32 v[126:127], v[126:127], v[32:33]
    v_pk_add_f32 v[128:129], v[128:129], v[34:35]
    v_pk_add_f32 v[130:131], v[130:131], v[36:37]
    v_pk_fma_f32 v[188:189], v[124:125], v[158:159], v[188:189]
    v_pk_fma_f32 v[190:191], v[126:127], v[160:161], v[190:191]
    v_pk_fma_f32 v[192:193], v[128:129], v[162:163], v[192:193]
    v_pk_fma_f32 v[194:195], v[130:131], v[164:165], v[194:195]
    v_cvt_pk_bf16_f32 v178, v188, v189
    v_cvt_pk_bf16_f32 v179, v190, v191
    v_cvt_pk_bf16_f32 v180, v192, v193
    v_cvt_pk_bf16_f32 v181, v194, v195
    buffer_store_dwordx4 v[178:181], v212, s[12:15], s51 offen
    s_waitcnt lgkmcnt(8)
    v_pk_add_f32 v[132:133], v[132:133], v[18:19]
    s_waitcnt lgkmcnt(6)
    v_pk_add_f32 v[38:39], v[38:39], v[58:59]
    v_pk_add_f32 v[134:135], v[134:135], v[20:21]
    v_pk_add_f32 v[40:41], v[40:41], v[60:61]
    s_waitcnt lgkmcnt(5)
    v_pk_add_f32 v[136:137], v[136:137], v[22:23]
    s_waitcnt lgkmcnt(3)
    v_pk_add_f32 v[42:43], v[42:43], v[62:63]
    v_pk_add_f32 v[138:139], v[138:139], v[24:25]
    v_pk_add_f32 v[44:45], v[44:45], v[64:65]
    v_pk_add_f32 v[132:133], v[132:133], v[38:39]
    v_pk_add_f32 v[134:135], v[134:135], v[40:41]
    v_pk_add_f32 v[136:137], v[136:137], v[42:43]
    v_pk_add_f32 v[138:139], v[138:139], v[44:45]
    v_pk_fma_f32 v[196:197], v[132:133], v[166:167], v[196:197]
    v_pk_fma_f32 v[198:199], v[134:135], v[168:169], v[198:199]
    v_pk_fma_f32 v[200:201], v[136:137], v[170:171], v[200:201]
    v_pk_fma_f32 v[202:203], v[138:139], v[172:173], v[202:203]
    v_cvt_pk_bf16_f32 v182, v196, v197
    v_cvt_pk_bf16_f32 v183, v198, v199
    v_cvt_pk_bf16_f32 v184, v200, v201
    v_cvt_pk_bf16_f32 v185, v202, v203
    buffer_store_dwordx4 v[182:185], v212, s[12:15], s51 offen offset:64
    s_waitcnt lgkmcnt(2)
    v_pk_add_f32 v[140:141], v[140:141], v[26:27]
    s_waitcnt lgkmcnt(0)
    v_pk_add_f32 v[46:47], v[46:47], v[66:67]
    v_pk_add_f32 v[142:143], v[142:143], v[28:29]
    v_pk_add_f32 v[48:49], v[48:49], v[68:69]
    v_pk_add_f32 v[140:141], v[140:141], v[46:47]
    v_pk_add_f32 v[142:143], v[142:143], v[48:49]
    v_pk_fma_f32 v[204:205], v[140:141], v[174:175], v[204:205]
    v_pk_fma_f32 v[206:207], v[142:143], v[176:177], v[206:207]
    v_cvt_pk_bf16_f32 v186, v204, v205
    v_cvt_pk_bf16_f32 v187, v206, v207
    buffer_store_dwordx2 v[186:187], v213, s[12:15], s51 offen offset:128
Lk_end:
    s_endpgm
Ls_T:
    s_mov_b32 s47, 0
Lp_T:
    buffer_load_dwordx4 v[190:193], v184, s[8:11], s73 offen sc1
    s_waitcnt vmcnt(0)
    s_add_u32 s47, s47, 1
    s_cmp_gt_u32 s47, 0x40000
    s_cbranch_scc1 Lr_T
    v_cmp_ne_u32_e64 vcc, s45, v191
    v_cmp_ne_u32 s[74:75], s45, v193
    s_nop 0
    s_or_b64 vcc, vcc, s[74:75]
    s_cbranch_scc1 Lp_T
    s_branch Lr_T
Ls_A:
    s_mov_b32 s47, 0
    s_mov_b64 exec, 0x3ff
    buffer_load_dword v8, v10, s[8:11], s84 offen offset:0 sc1
    s_mov_b64 exec, -1
    s_sleep 5
Lp_A:
    s_mov_b64 exec, 0x3ff
    buffer_load_dword v9, v10, s[8:11], s84 offen offset:0 sc1
    s_mov_b64 exec, -1
    s_waitcnt vmcnt(1)
    v_cmp_ne_u32 vcc, s45, v8
    s_nop 0
    s_and_b32 vcc_lo, vcc_lo, 0x3ff
    s_cbranch_scc0 Lr_A
    s_mov_b64 exec, 0x3ff
    buffer_load_dword v8, v10, s[8:11], s84 offen offset:0 sc1
    s_mov_b64 exec, -1
    s_waitcnt vmcnt(1)
    s_add_u32 s47, s47, 1
    s_cmp_gt_u32 s47, 0x40000
    s_cbranch_scc1 Lr_A
    v_cmp_ne_u32_e64 vcc, s45, v9
    s_nop 0
    s_and_b32 vcc_lo, vcc_lo, 0x3ff
    s_cbranch_scc1 Lp_A
    s_branch Lr_A
L1_d:
    ds_read_b64_tr_b16 a[192:193], v63 offset:0
    ds_read_b64_tr_b16 a[194:195], v63 offset:2560
    ds_read_b64_tr_b16 a[196:197], v63 offset:8
    ds_read_b64_tr_b16 a[198:199], v63 offset:2568
    ds_read_b64_tr_b16 a[200:201], v63 offset:64
    ds_read_b64_tr_b16 a[202:203], v63 offset:2624
    ds_read_b64_tr_b16 a[204:205], v63 offset:72
    ds_read_b64_tr_b16 a[206:207], v63 offset:2632
    ds_read_b64_tr_b16 a[208:209], v64 offset:128
    ds_read_b64_tr_b16 a[210:211], v64 offset:2688
    s_branch L1_e
Ls_S:
    s_mov_b32 s47, 0
Lp_S:
    s_sleep 8
    s_mov_b32 exec_hi, 0xffffffff
    buffer_load_dword v8, v10, s[8:11], s84 offen offset:0 sc1
    s_mov_b64 exec, -1
    s_waitcnt vmcnt(0)
    s_add_u32 s47, s47, 1
    s_cmp_gt_u32 s47, 0x40000
    s_cbranch_scc1 Lr_S
    v_cmp_ne_u32 vcc, s45, v8
    s_nop 0
    s_and_b32 vcc_hi, vcc_hi, 0xffffffff
    s_or_b32 vcc_lo, vcc_lo, vcc_hi
    s_cbranch_scc1 Lp_S
    s_branch Lr_S
Ls_S1:
    s_mov_b32 s47, 0
    s_mov_b32 exec_hi, 0x1f
    buffer_load_dword v8, v73, s[8:11], s72 offen offset:0 sc1
    s_mov_b64 exec, -1
    s_sleep 5
Lp_S1:
    s_mov_b32 exec_hi, 0x1f
    buffer_load_dword v9, v73, s[8:11], s72 offen offset:0 sc1
    s_mov_b64 exec, -1
    s_waitcnt vmcnt(1)
    v_cmp_ne_u32 vcc, s45, v8
    s_nop 0
    s_and_b32 vcc_hi, vcc_hi, 0x1f
    s_or_b32 vcc_lo, vcc_lo, vcc_hi
    s_cbranch_scc0 Lr_S1
    s_mov_b32 exec_hi, 0x1f
    buffer_load_dword v8, v73, s[8:11], s72 offen offset:0 sc1
    s_mov_b64 exec, -1
    s_waitcnt vmcnt(1)
    s_add_u32 s47, s47, 1
    s_cmp_gt_u32 s47, 0x40000
    s_cbranch_scc1 Lr_S1
    v_cmp_ne_u32_e64 vcc, s45, v9
    s_nop 0
    s_and_b32 vcc_hi, vcc_hi, 0x1f
    s_or_b32 vcc_lo, vcc_lo, vcc_hi
    s_cbranch_scc1 Lp_S1
    s_branch Lr_S1
Lsw01:
    v_swap_b32 v222, v60
    v_swap_b32 v223, v61
    v_swap_b32 v224, v62
    v_swap_b32 v225, v63
    v_swap_b32 v226, v64
    v_swap_b32 v227, v65
    v_swap_b32 v228, v66
    v_swap_b32 v229, v67
    v_swap_b32 v230, v68
    v_swap_b32 v231, v69
    v_swap_b32 v232, v70
    v_swap_b32 v233, v71
    v_swap_b32 v234, v72
    s_branch Lsr01
Lsw02:
    v_swap_b32 v222, v60
    v_swap_b32 v223, v61
    v_swap_b32 v224, v62
    v_swap_b32 v225, v63
    v_swap_b32 v226, v64
    v_swap_b32 v227, v65
    v_swap_b32 v228, v66
    v_swap_b32 v229, v67
    v_swap_b32 v230, v68
    v_swap_b32 v231, v69
    v_swap_b32 v232, v70
    v_swap_b32 v233, v71
    v_swap_b32 v234, v72
    s_branch Lsr02
Lsw03:
    v_swap_b32 v222, v60
    v_swap_b32 v223, v61
    v_swap_b32 v224, v62
    v_swap_b32 v225, v63
    v_swap_b32 v226, v64
    v_swap_b32 v227, v65
    v_swap_b32 v228, v66
    v_swap_b32 v229, v67
    v_swap_b32 v230, v68
    v_swap_b32 v231, v69
    v_swap_b32 v232, v70
    v_swap_b32 v233, v71
    v_swap_b32 v234, v72
    s_branch Lsr03
Lsw04:
    v_swap_b32 v222, v60
    v_swap_b32 v223, v61
    v_swap_b32 v224, v62
    v_swap_b32 v225, v63
    v_swap_b32 v226, v64
    v_swap_b32 v227, v65
    v_swap_b32 v228, v66
    v_swap_b32 v229, v67
    v_swap_b32 v230, v68
    v_swap_b32 v231, v69
    v_swap_b32 v232, v70
    v_swap_b32 v233, v71
    v_swap_b32 v234, v72
    s_branch Lsr04
Ls_kv:
    s_mov_b32 s47, 0
    s_mov_b64 exec, 0x1
    buffer_load_dword v8, v7, s[8:11], s1 offen offset:0 sc1
    s_mov_b64 exec, -1
    s_sleep 5
Lp_kv:
    s_mov_b64 exec, 0x1
    buffer_load_dword v9, v7, s[8:11], s1 offen offset:0 sc1
    s_mov_b64 exec, -1
    s_waitcnt vmcnt(1)
    v_cmp_ne_u32_e64 vcc, s45, v8
    s_nop 0
    s_and_b32 vcc_lo, vcc_lo, 0x1
    s_cbranch_scc0 Lr_kv
    s_mov_b64 exec, 0x1
    buffer_load_dword v8, v7, s[8:11], s1 offen offset:0 sc1
    s_mov_b64 exec, -1
    s_waitcnt vmcnt(1)
    s_add_u32 s47, s47, 1
    s_cmp_gt_u32 s47, 0x40000
    s_cbranch_scc1 Lr_kv
    v_cmp_ne_u32 vcc, s45, v9
    s_nop 0
    s_and_b32 vcc_lo, vcc_lo, 0x1
    s_cbranch_scc1 Lp_kv
    s_branch Lr_kv
Ls_S2:
    s_mov_b32 s47, 0
Lp_S2:
    s_sleep 8
    s_mov_b32 exec_hi, 0xffffffff
    buffer_load_dword v8, v10, s[8:11], s84 offen offset:0 sc1
    s_mov_b64 exec, -1
    s_waitcnt vmcnt(0)
    s_add_u32 s47, s47, 1
    s_cmp_gt_u32 s47, 0x40000
    s_cbranch_scc1 Lr_S2
    v_cmp_ne_u32 vcc, s45, v8
    s_nop 0
    s_and_b32 vcc_hi, vcc_hi, 0xffffffff
    s_or_b32 vcc_lo, vcc_lo, vcc_hi
    s_cbranch_scc1 Lp_S2
    s_branch Lr_S2
Lsw11:
    v_swap_b32 v222, v60
    v_swap_b32 v223, v61
    v_swap_b32 v224, v62
    v_swap_b32 v225, v63
    v_swap_b32 v226, v64
    v_swap_b32 v227, v65
    v_swap_b32 v228, v66
    v_swap_b32 v229, v67
    v_swap_b32 v230, v68
    v_swap_b32 v231, v69
    v_swap_b32 v232, v70
    v_swap_b32 v233, v71
    v_swap_b32 v234, v72
    s_branch Lsr11
Lsw12:
    v_swap_b32 v222, v60
    v_swap_b32 v223, v61
    v_swap_b32 v224, v62
    v_swap_b32 v225, v63
    v_swap_b32 v226, v64
    v_swap_b32 v227, v65
    v_swap_b32 v228, v66
    v_swap_b32 v229, v67
    v_swap_b32 v230, v68
    v_swap_b32 v231, v69
    v_swap_b32 v232, v70
    v_swap_b32 v233, v71
    v_swap_b32 v234, v72
    s_branch Lsr12
Lsw13:
    v_swap_b32 v222, v60
    v_swap_b32 v223, v61
    v_swap_b32 v224, v62
    v_swap_b32 v225, v63
    v_swap_b32 v226, v64
    v_swap_b32 v227, v65
    v_swap_b32 v228, v66
    v_swap_b32 v229, v67
    v_swap_b32 v230, v68
    v_swap_b32 v231, v69
    v_swap_b32 v232, v70
    v_swap_b32 v233, v71
    v_swap_b32 v234, v72
    s_branch Lsr13
Lsw14:
    v_swap_b32 v222, v60
    v_swap_b32 v223, v61
    v_swap_b32 v224, v62
    v_swap_b32 v225, v63
    v_swap_b32 v226, v64
    v_swap_b32 v227, v65
    v_swap_b32 v228, v66
    v_swap_b32 v229, v67
    v_swap_b32 v230, v68
    v_swap_b32 v231, v69
    v_swap_b32 v232, v70
    v_swap_b32 v233, v71
    v_swap_b32 v234, v72
    s_branch Lsr14
Ls_o:
    s_mov_b32 s47, 0
    s_mov_b32 exec_hi, 0x0
    buffer_load_dword v8, v245, s[8:11], s66 offen offset:0 sc1
    s_mov_b64 exec, -1
    s_sleep 5
Lp_o:
    s_mov_b32 exec_hi, 0x0
    buffer_load_dword v9, v245, s[8:11], s66 offen offset:0 sc1
    s_mov_b64 exec, -1
    s_waitcnt vmcnt(1)
    v_cmp_ne_u32 vcc, s45, v8
    s_nop 0
    s_and_b32 vcc_lo, vcc_lo, 0xffffffff
    s_cbranch_scc0 Lr_o
    s_mov_b32 exec_hi, 0x0
    buffer_load_dword v8, v245, s[8:11], s66 offen offset:0 sc1
    s_mov_b64 exec, -1
    s_waitcnt vmcnt(1)
    s_add_u32 s47, s47, 1
    s_cmp_gt_u32 s47, 0x40000
    s_cbranch_scc1 Lr_o
    v_cmp_ne_u32_e64 vcc, s45, v9
    s_nop 0
    s_and_b32 vcc_lo, vcc_lo, 0xffffffff
    s_cbranch_scc1 Lp_o
    s_branch Lr_o
Ls_x:
    s_mov_b32 s47, 0
    s_mov_b64 exec, 0xffff
    buffer_load_dword v8, v245, s[8:11], s67 offen offset:0 sc1
    s_mov_b64 exec, -1
    s_sleep 5
Lp_x:
    s_mov_b64 exec, 0xffff
    buffer_load_dword v9, v245, s[8:11], s67 offen offset:0 sc1
    s_mov_b64 exec, -1
    s_waitcnt vmcnt(1)
    v_cmp_ne_u32 vcc, s45, v8
    s_nop 0
    s_and_b32 vcc_lo, vcc_lo, 0xffff
    s_cbranch_scc0 Lr_x
    s_mov_b64 exec, 0xffff
    buffer_load_dword v8, v245, s[8:11], s67 offen offset:0 sc1
    s_mov_b64 exec, -1
    s_waitcnt vmcnt(1)
    s_add_u32 s47, s47, 1
    s_cmp_gt_u32 s47, 0x40000
    s_cbranch_scc1 Lr_x
    v_cmp_ne_u32 vcc, s45, v9
    s_nop 0
    s_and_b32 vcc_lo, vcc_lo, 0xffff
    s_cbranch_scc1 Lp_x
    s_branch Lr_x
Ls_a0:
    s_mov_b32 s47, 0
Lp_a0:
    s_sleep 8
    s_mov_b32 exec_hi, 0x0
    buffer_load_dword v8, v245, s[8:11], s66 offen offset:0 sc1
    s_mov_b64 exec, -1
    s_waitcnt vmcnt(0)
    s_add_u32 s47, s47, 1
    s_cmp_gt_u32 s47, 0x40000
    s_cbranch_scc1 Lr_a0
    v_cmp_ne_u32 vcc, s45, v8
    s_nop 0
    s_and_b32 vcc_lo, vcc_lo, 0xffffffff
    s_cbranch_scc1 Lp_a0
    s_branch Lr_a0
Ls_a1:
    s_mov_b32 s47, 0
Lp_a1:
    s_sleep 8
    s_mov_b32 exec_hi, 0x0
    buffer_load_dword v8, v245, s[8:11], s66 offen offset:512 sc1
    s_mov_b64 exec, -1
    s_waitcnt vmcnt(0)
    s_add_u32 s47, s47, 1
    s_cmp_gt_u32 s47, 0x40000
    s_cbranch_scc1 Lr_a1
    v_cmp_ne_u32 vcc, s45, v8
    s_nop 0
    s_and_b32 vcc_lo, vcc_lo, 0xffffffff
    s_cbranch_scc1 Lp_a1
    s_branch Lr_a1
Ls_a2:
    s_mov_b32 s47, 0
Lp_a2:
    s_sleep 8
    s_mov_b32 exec_hi, 0x0
    buffer_load_dword v8, v245, s[8:11], s66 offen offset:1024 sc1
    s_mov_b64 exec, -1
    s_waitcnt vmcnt(0)
    s_add_u32 s47, s47, 1
    s_cmp_gt_u32 s47, 0x40000
    s_cbranch_scc1 Lr_a2
    v_cmp_ne_u32 vcc, s45, v8
    s_nop 0
    s_and_b32 vcc_lo, vcc_lo, 0xffffffff
    s_cbranch_scc1 Lp_a2
    s_branch Lr_a2
Ls_a3:
    s_mov_b32 s47, 0
Lp_a3:
    s_sleep 8
    s_mov_b32 exec_hi, 0x0
    buffer_load_dword v8, v245, s[8:11], s66 offen offset:1536 sc1
    s_mov_b64 exec, -1
    s_waitcnt vmcnt(0)
    s_add_u32 s47, s47, 1
    s_cmp_gt_u32 s47, 0x40000
    s_cbranch_scc1 Lr_a3
    v_cmp_ne_u32 vcc, s45, v8
    s_nop 0
    s_and_b32 vcc_lo, vcc_lo, 0xffffffff
    s_cbranch_scc1 Lp_a3
    s_branch Lr_a3
Lcode_end:
.section .rodata,"a"
.p2align 6
.amdhsa_kernel adaLN_cond__sliding_block__swiglu_ffn__prompt_kernel
  .amdhsa_next_free_vgpr 512
  .amdhsa_next_free_sgpr 102
  .amdhsa_accum_offset 256
  .amdhsa_group_segment_fixed_size 0
  .amdhsa_kernarg_size 96
  .amdhsa_user_sgpr_count 2
  .amdhsa_user_sgpr_kernarg_segment_ptr 1
  .amdhsa_system_sgpr_workgroup_id_x 1
  .amdhsa_float_denorm_mode_32 3
.end_amdhsa_kernel
```
